```python
import torch

def _softmax(x, axis=-1):
    return torch.softmax(x, dim=axis)
def _gelu(x):
    return torch.nn.functional.gelu(x, approximate="tanh")
def _silu(x):
    return torch.nn.functional.silu(x)
def _sigmoid(x):
    return torch.sigmoid(x)
def _layernorm(x, axis=-1, eps=1e-5):
    m = x.mean(dim=axis, keepdim=True)
    v = x.var(dim=axis, keepdim=True, unbiased=False)
    return (x - m) / torch.sqrt(v + eps)
def _scatter_add(tgt, idx, src, axis=0):
    return tgt.clone().index_add_(axis, idx, src)
def _segment_sum(src, seg, n):
    out = torch.zeros((n,) + src.shape[1:], dtype=src.dtype)
    return out.index_add_(0, seg, src)
def _pad(x, pw):
    flat = tuple(v for pair in reversed(pw) for v in pair)
    return torch.nn.functional.pad(x, flat)

kernel_name = 'concat_heads__compressed_kv_cla__ssm_conv_s5__prompt'

def setup_inputs():

    _w = (lambda a: (lambda t: t.to(torch.bfloat16) if t.is_floating_point() else t)(torch.as_tensor(a)))
    def _A_setup():
        B, H, Sq, Sk, D, M = 1, 32, 2048, 2048, 128, 512
        Dc = 4 * D
        return {
            "x": _w((lambda *s: torch.randn(*s, dtype=torch.bfloat16) * 3.2)(B, Sq, M)),
            "c_kv": _w((lambda *s: torch.randn(*s, dtype=torch.bfloat16) * 0.1)(B, Sk, Dc)),
            "w_q": _w((lambda *s: torch.randn(*s, dtype=torch.bfloat16) * 6.4)(M, H, D) * (M ** -0.5)),
            "w_uk": _w((lambda *s: torch.randn(*s, dtype=torch.bfloat16) * 6.4)(Dc, H, D) * (Dc ** -0.5)),
            "w_uv": _w((lambda *s: torch.randn(*s, dtype=torch.bfloat16) * 0.1)(Dc, H, D) * (Dc ** -0.5)),
            "w_o": _w((lambda *s: torch.randn(*s, dtype=torch.bfloat16) * 0.1)(H, D, M) * ((H * D) ** -0.5)),
        }
    _A_in = _A_setup()

    def _B_setup():
        B, S, D = 1, 2048, 512
        P = D
        Lambda_re = -0.5 * (lambda _x: torch.exp(torch.as_tensor(_x)))((lambda *s: torch.randn(*s, dtype=torch.bfloat16) * 0.2)(P))
        Lambda_im = (lambda *s: torch.randn(*s, dtype=torch.bfloat16) * 0.4)(P) * 1.0
        B_re = (lambda *s: torch.randn(*s, dtype=torch.bfloat16) * 0.2)(P, D) * (D ** -0.5)
        B_im = (lambda *s: torch.randn(*s, dtype=torch.bfloat16) * 0.2)(P, D) * (D ** -0.5)
        C_re = (lambda *s: torch.randn(*s, dtype=torch.bfloat16) * 0.2)(D, P) * (P ** -0.5)
        C_im = (lambda *s: torch.randn(*s, dtype=torch.bfloat16) * 0.2)(D, P) * (P ** -0.5)
        log_dt = (lambda *s: torch.randn(*s, dtype=torch.bfloat16) * 0.2)(P) * 0.3 - 2.0
        Dskip = (lambda *s: torch.randn(*s, dtype=torch.bfloat16) * 0.05)(D)
        return {
            "x": _w((lambda *s: torch.randn(*s, dtype=torch.bfloat16) * 0.05)(B, S, D)),
            "Lambda_re": _w(Lambda_re),
            "Lambda_im": _w(Lambda_im),
            "B_re": _w(B_re),
            "B_im": _w(B_im),
            "C_re": _w(C_re),
            "C_im": _w(C_im),
            "log_dt": _w(log_dt),
            "Dskip": _w(Dskip),
        }
    _B_in = _B_setup()

    return {
        "A_x": _A_in["x"],
        "A_c_kv": _A_in["c_kv"],
        "A_w_q": _A_in["w_q"],
        "A_w_uk": _A_in["w_uk"],
        "A_w_uv": _A_in["w_uv"],
        "A_w_o": _A_in["w_o"],
        "B_x": _B_in["x"],
        "B_Lambda_re": _B_in["Lambda_re"],
        "B_Lambda_im": _B_in["Lambda_im"],
        "B_B_re": _B_in["B_re"],
        "B_B_im": _B_in["B_im"],
        "B_C_re": _B_in["C_re"],
        "B_C_im": _B_in["C_im"],
        "B_log_dt": _B_in["log_dt"],
        "B_Dskip": _B_in["Dskip"],
    }

def reference(A_x, A_c_kv, A_w_q, A_w_uk, A_w_uv, A_w_o, B_x, B_Lambda_re, B_Lambda_im, B_B_re, B_B_im, B_C_re, B_C_im, B_log_dt, B_Dskip):
    def _A_ref(x, c_kv, w_q, w_uk, w_uv, w_o):
        B, Sq, M = x.shape[0], x.shape[1], x.shape[2]
        Sk = c_kv.shape[1]
        H, D = w_q.shape[1], w_q.shape[2]
        q = torch.einsum("bqm,mhd->bhqd", x, w_q)
        k = torch.einsum("bkc,chd->bhkd", c_kv, w_uk)
        v = torch.einsum("bkc,chd->bhkd", c_kv, w_uv)
        scores = torch.einsum("bhqd,bhkd->bhqk", q, k) * (D ** -0.5)
        off = Sk - Sq
        qi = torch.arange(Sq)[:, None]
        kj = torch.arange(Sk)[None, :]
        cmask = kj <= (qi + off)
        scores = torch.where(cmask[None, None], scores, -1e9)
        p = _softmax(scores, axis=-1)
        ctx = torch.einsum("bhqk,bhkd->bhqd", p, v)
        return torch.einsum("bhqd,hdm->bqm", ctx, w_o)

    def _B_ref(x, Lambda_re, Lambda_im, B_re, B_im, C_re, C_im, log_dt, Dskip):
        Bsz, L, H = x.shape
        Lam = Lambda_re + 1j * Lambda_im
        Bmat = B_re + 1j * B_im
        Cmat = C_re + 1j * C_im
        dt = torch.exp(log_dt)
        Lam_bar = torch.exp(dt * Lam)
        B_bar = ((Lam_bar - 1.0) / Lam)[:, None] * Bmat
        Bu = torch.einsum("bld,pd->blp", x + 0j, B_bar)
        h = torch.zeros_like(Bu[:, 0, :])
        hs = []
        for t in range(L):
            h = Lam_bar[None, :] * h + Bu[:, t, :]
            hs.append(h)
        hseq = torch.stack(hs, 1)
        y = 2.0 * torch.einsum("blp,dp->bld", hseq, Cmat).real + x * Dskip[None, None, :]
        return y

    a = _A_ref(A_x, A_c_kv, A_w_q, A_w_uk, A_w_uv, A_w_o)
    b = _B_ref(B_x, B_Lambda_re, B_Lambda_im, B_B_re, B_B_im, B_C_re, B_C_im, B_log_dt, B_Dskip)
    return torch.concatenate([a, b], axis=-1)
```

```asm
; @launch kernel=proj_kernel grid=(256,1,1) block=(512,1,1) lds=163840
; @launch kernel=attn_kernel grid=(256,1,1) block=(512,1,1) lds=163840
; @launch kernel=outp_kernel grid=(256,1,1) block=(512,1,1) lds=163840
.amdgcn_target "amdgcn-amd-amdhsa--gfx950"
.text
.globl proj_kernel
.p2align 8
.type proj_kernel,@function
proj_kernel:
    s_cmp_ge_u32 s2, 256
    s_cbranch_scc1 L_k1_end
    s_load_dwordx16 s[8:23], s[0:1], 0
    s_load_dwordx4 s[24:27], s[0:1], 72
    s_load_dwordx2 s[28:29], s[0:1], 136
    s_load_dwordx4 s[76:79], s[0:1], 88
    v_and_b32 v1, 63, v0
    v_lshrrev_b32 v2, 6, v0
    s_nop 0
    v_readfirstlane_b32 s3, v2
    v_and_b32 v2, 31, v1
    v_lshrrev_b32 v3, 5, v1
    v_and_b32 v4, 15, v1
    v_lshrrev_b32 v5, 4, v1
    v_lshlrev_b32 v14, 4, v1
    s_and_b32 s65, s2, 7
    s_lshl_b32 s65, s65, 2
    s_lshr_b32 s66, s2, 3
    s_and_b32 s66, s66, 3
    s_add_u32 s5, s65, s66
    s_lshr_b32 s4, s2, 5
    s_and_b32 s71, s2, 15
    s_lshr_b32 s72, s2, 4
    v_lshrrev_b32 v32, 3, v1
    v_lshlrev_b32 v32, 10, v32
    v_and_b32 v33, 7, v1
    v_xor_b32 v34, v33, v5
    v_xor_b32 v35, 4, v34
    v_lshl_add_u32 v8, v34, 4, v32
    v_lshl_add_u32 v9, v35, 4, v32
    v_add_u32 v10, 14336, v8
    v_add_u32 v11, 21504, v9
    s_and_b32 s65, s3, 1
    s_cmp_eq_u32 s65, 1
    s_cselect_b64 vcc, -1, 0
    v_cndmask_b32 v13, v8, v9, vcc
    v_add_u32 v9, 7168, v9
    v_lshrrev_b32 v32, 2, v1
    v_and_b32 v32, 3, v32
    v_xor_b32 v32, v32, v5
    v_lshlrev_b32 v32, 6, v32
    v_lshl_add_u32 v32, v5, 13, v32
    v_and_b32 v33, 3, v1
    v_lshl_add_u32 v12, v33, 4, v32
    v_lshrrev_b32 v32, 1, v2
    v_and_b32 v32, 7, v32
    v_add_u32 v33, 0, v3
    v_xor_b32 v33, v33, v32
    v_lshlrev_b32 v33, 4, v33
    v_lshl_add_u32 v24, v2, 7, v33
    v_add_u32 v33, 2, v3
    v_xor_b32 v33, v33, v32
    v_lshlrev_b32 v33, 4, v33
    v_lshl_add_u32 v25, v2, 7, v33
    v_add_u32 v33, 4, v3
    v_xor_b32 v33, v33, v32
    v_lshlrev_b32 v33, 4, v33
    v_lshl_add_u32 v26, v2, 7, v33
    v_add_u32 v33, 6, v3
    v_xor_b32 v33, v33, v32
    v_lshlrev_b32 v33, 4, v33
    v_lshl_add_u32 v27, v2, 7, v33
    v_lshrrev_b32 v34, 2, v4
    v_lshl_add_u32 v35, v3, 3, v34
    v_lshlrev_b32 v35, 8, v35
    v_and_b32 v36, 1, v5
    v_lshl_add_u32 v35, v36, 5, v35
    v_and_b32 v36, 3, v4
    v_lshl_add_u32 v35, v36, 3, v35
    s_lshr_b32 s65, s3, 1
    s_and_b32 s65, s65, 1
    s_lshl_b32 s65, s65, 1
    s_lshr_b32 s66, s3, 2
    s_lshl_b32 s66, s66, 14
    s_add_u32 s66, s66, 32768
    v_add_u32 v36, 0, v34
    v_xor_b32 v36, s65, v36
    v_lshl_add_u32 v36, v36, 6, v35
    v_add_u32 v20, s66, v36
    v_add_u32 v36, 0, v34
    v_xor_b32 v36, s65, v36
    v_xor_b32 v36, 1, v36
    v_lshl_add_u32 v36, v36, 6, v35
    v_add_u32 v21, s66, v36
    s_lshr_b32 s65, s3, 2
    s_lshl_b32 s65, s65, 1
    v_xor_b32 v36, s65, v34
    v_lshl_add_u32 v36, v36, 6, v35
    v_add_u32 v22, 0x8000, v36
    v_xor_b32 v36, s65, v34
    v_xor_b32 v36, 1, v36
    v_lshl_add_u32 v36, v36, 6, v35
    v_add_u32 v23, 0x8000, v36
    s_and_b32 s65, s3, 1
    s_lshl_b32 s65, s65, 14
    s_and_b32 s66, s3, 3
    s_lshl_b32 s66, s66, 13
    v_add_u32 v16, s65, v24
    v_add_u32 v28, s66, v24
    v_add_u32 v17, s65, v25
    v_add_u32 v29, s66, v25
    v_add_u32 v18, s65, v26
    v_add_u32 v30, s66, v26
    v_add_u32 v19, s65, v27
    v_add_u32 v31, s66, v27
    v_lshlrev_b32 v36, 4, v3
    v_lshl_add_u32 v15, v2, 13, v36
    v_mov_b32 v128, 0
    v_mov_b32 v129, 0
    v_mov_b32 v130, 0
    v_mov_b32 v131, 0
    v_mov_b32 v132, 0
    v_mov_b32 v133, 0
    v_mov_b32 v134, 0
    v_mov_b32 v135, 0
    v_mov_b32 v136, 0
    v_mov_b32 v137, 0
    v_mov_b32 v138, 0
    v_mov_b32 v139, 0
    v_mov_b32 v140, 0
    v_mov_b32 v141, 0
    v_mov_b32 v142, 0
    v_mov_b32 v143, 0
    v_mov_b32 v144, 0
    v_mov_b32 v145, 0
    v_mov_b32 v146, 0
    v_mov_b32 v147, 0
    v_mov_b32 v148, 0
    v_mov_b32 v149, 0
    v_mov_b32 v150, 0
    v_mov_b32 v151, 0
    v_mov_b32 v152, 0
    v_mov_b32 v153, 0
    v_mov_b32 v154, 0
    v_mov_b32 v155, 0
    v_mov_b32 v156, 0
    v_mov_b32 v157, 0
    v_mov_b32 v158, 0
    v_mov_b32 v159, 0
    v_mov_b32 v160, 0
    v_mov_b32 v161, 0
    v_mov_b32 v162, 0
    v_mov_b32 v163, 0
    v_mov_b32 v164, 0
    v_mov_b32 v165, 0
    v_mov_b32 v166, 0
    v_mov_b32 v167, 0
    v_mov_b32 v168, 0
    v_mov_b32 v169, 0
    v_mov_b32 v170, 0
    v_mov_b32 v171, 0
    v_mov_b32 v172, 0
    v_mov_b32 v173, 0
    v_mov_b32 v174, 0
    v_mov_b32 v175, 0
    v_mov_b32 v176, 0
    v_mov_b32 v177, 0
    v_mov_b32 v178, 0
    v_mov_b32 v179, 0
    v_mov_b32 v180, 0
    v_mov_b32 v181, 0
    v_mov_b32 v182, 0
    v_mov_b32 v183, 0
    v_mov_b32 v184, 0
    v_mov_b32 v185, 0
    v_mov_b32 v186, 0
    v_mov_b32 v187, 0
    v_mov_b32 v188, 0
    v_mov_b32 v189, 0
    v_mov_b32 v190, 0
    v_mov_b32 v191, 0
    v_mov_b32 v192, 0
    v_mov_b32 v193, 0
    v_mov_b32 v194, 0
    v_mov_b32 v195, 0
    v_mov_b32 v196, 0
    v_mov_b32 v197, 0
    v_mov_b32 v198, 0
    v_mov_b32 v199, 0
    v_mov_b32 v200, 0
    v_mov_b32 v201, 0
    v_mov_b32 v202, 0
    v_mov_b32 v203, 0
    v_mov_b32 v204, 0
    v_mov_b32 v205, 0
    v_mov_b32 v206, 0
    v_mov_b32 v207, 0
    v_mov_b32 v208, 0
    v_mov_b32 v209, 0
    v_mov_b32 v210, 0
    v_mov_b32 v211, 0
    v_mov_b32 v212, 0
    v_mov_b32 v213, 0
    v_mov_b32 v214, 0
    v_mov_b32 v215, 0
    v_mov_b32 v216, 0
    v_mov_b32 v217, 0
    v_mov_b32 v218, 0
    v_mov_b32 v219, 0
    v_mov_b32 v220, 0
    v_mov_b32 v221, 0
    v_mov_b32 v222, 0
    v_mov_b32 v223, 0
    v_mov_b32 v224, 0
    v_mov_b32 v225, 0
    v_mov_b32 v226, 0
    v_mov_b32 v227, 0
    v_mov_b32 v228, 0
    v_mov_b32 v229, 0
    v_mov_b32 v230, 0
    v_mov_b32 v231, 0
    v_mov_b32 v232, 0
    v_mov_b32 v233, 0
    v_mov_b32 v234, 0
    v_mov_b32 v235, 0
    v_mov_b32 v236, 0
    v_mov_b32 v237, 0
    v_mov_b32 v238, 0
    v_mov_b32 v239, 0
    v_mov_b32 v240, 0
    v_mov_b32 v241, 0
    v_mov_b32 v242, 0
    v_mov_b32 v243, 0
    v_mov_b32 v244, 0
    v_mov_b32 v245, 0
    v_mov_b32 v246, 0
    v_mov_b32 v247, 0
    v_mov_b32 v248, 0
    v_mov_b32 v249, 0
    v_mov_b32 v250, 0
    v_mov_b32 v251, 0
    v_mov_b32 v252, 0
    v_mov_b32 v253, 0
    v_mov_b32 v254, 0
    v_mov_b32 v255, 0
    v_mov_b32 v112, 0
    v_mov_b32 v113, 0
    v_mov_b32 v114, 0
    v_mov_b32 v115, 0
    v_mov_b32 v116, 0
    v_mov_b32 v117, 0
    v_mov_b32 v118, 0
    v_mov_b32 v119, 0
    v_mov_b32 v120, 0
    v_mov_b32 v121, 0
    v_mov_b32 v122, 0
    v_mov_b32 v123, 0
    v_mov_b32 v124, 0
    v_mov_b32 v125, 0
    v_mov_b32 v126, 0
    v_mov_b32 v127, 0
    s_waitcnt lgkmcnt(0)
    s_mov_b32 s36, s8
    s_mov_b32 s37, s9
    s_mov_b32 s38, 0x200000
    s_mov_b32 s39, 0x00020000
    s_mov_b32 s32, s10
    s_mov_b32 s33, s11
    s_mov_b32 s34, 0x200000
    s_mov_b32 s35, 0x00020000
    s_mov_b32 s44, s12
    s_mov_b32 s45, s13
    s_mov_b32 s46, 0x400000
    s_mov_b32 s47, 0x00020000
    s_cmp_lt_u32 s3, 4
    s_cselect_b32 s40, s14, s16
    s_cselect_b32 s41, s15, s17
    s_mov_b32 s42, 0x400000
    s_mov_b32 s43, 0x00020000
    s_mov_b32 s48, s20
    s_mov_b32 s49, s21
    s_mov_b32 s50, 0x200000
    s_mov_b32 s51, 0x00020000
    s_and_b32 s65, s72, 1
    s_cmp_eq_u32 s65, 0
    s_cselect_b32 s52, s24, s26
    s_cselect_b32 s53, s25, s27
    s_mov_b32 s54, 0x80000
    s_mov_b32 s55, 0x00020000
    s_mov_b32 s56, s28
    s_mov_b32 s57, s29
    s_mov_b32 s58, 0x10000000
    s_mov_b32 s59, 0x00020000
    s_cmp_lt_u32 s3, 4
    s_cbranch_scc1 L_k1_nocf
    s_lshl_b32 s65, s2, 2
    s_add_u32 s65, s65, s3
    s_sub_u32 s65, s65, 4
    s_lshl_b32 s75, s65, 10
    s_add_u32 s75, s75, 0x4c00000
    s_and_b32 s66, s65, 63
    s_lshl_b32 s66, s66, 4
    s_lshr_b32 s65, s65, 6
    s_lshl_b32 s65, s65, 15
    s_add_u32 s65, s65, s66
    v_lshlrev_b32 v6, 3, v3
    v_lshl_add_u32 v6, v2, 10, v6
    s_mov_b32 s28, s76
    s_mov_b32 s29, s77
    s_mov_b32 s30, 0x80000
    s_mov_b32 s31, 0x00020000
    buffer_load_dwordx2 v[96:97], v6, s[28:31], s65 offen
    s_mov_b32 s28, s78
    s_mov_b32 s29, s79
    s_nop 0
    buffer_load_dwordx2 v[98:99], v6, s[28:31], s65 offen
L_k1_nocf:
    s_lshl_b32 s60, s4, 18
    s_lshl_b32 s65, s3, 15
    s_add_u32 s60, s60, s65
    s_mov_b32 s67, s60
    s_and_b32 s65, s3, 3
    s_lshl_b32 s65, s65, 17
    s_lshl_b32 s66, s5, 8
    s_add_u32 s61, s65, s66
    s_lshl_b32 s65, s3, 16
    s_add_u32 s68, s65, s66
    s_lshl_b32 s69, s71, 17
    s_lshl_b32 s65, s3, 14
    s_add_u32 s69, s69, s65
    s_lshr_b32 s65, s72, 1
    s_lshl_b32 s70, s65, 16
    s_lshl_b32 s65, s3, 13
    s_add_u32 s70, s70, s65
    s_lshl_b32 s62, s3, 12
    s_add_u32 s63, s62, 32768
    s_mov_b32 m0, s62
    s_nop 0
    buffer_load_dwordx4 v8, s[32:35], s60 offen offset:0 lds
    buffer_load_dwordx4 v9, s[32:35], s60 offen offset:1024 lds
    buffer_load_dwordx4 v10, s[32:35], s60 offen offset:2048 lds
    buffer_load_dwordx4 v11, s[32:35], s60 offen offset:3072 lds
    s_mov_b32 m0, s63
    s_add_u32 s74, s61, 0
    buffer_load_dwordx4 v12, s[40:43], s74 offen offset:0 lds
    s_add_u32 s74, s61, 31744
    buffer_load_dwordx4 v12, s[40:43], s74 offen offset:1024 lds
    s_add_u32 s74, s61, 63488
    buffer_load_dwordx4 v12, s[40:43], s74 offen offset:2048 lds
    s_add_u32 s74, s61, 95232
    buffer_load_dwordx4 v12, s[40:43], s74 offen offset:3072 lds
    s_add_u32 s60, s60, 128
    s_add_u32 s61, s61, 524288
    s_xor_b32 s62, s62, 0x10000
    s_xor_b32 s63, s63, 0x10000
    s_mov_b32 m0, s62
    s_nop 0
    buffer_load_dwordx4 v8, s[32:35], s60 offen offset:0 lds
    buffer_load_dwordx4 v9, s[32:35], s60 offen offset:1024 lds
    buffer_load_dwordx4 v10, s[32:35], s60 offen offset:2048 lds
    buffer_load_dwordx4 v11, s[32:35], s60 offen offset:3072 lds
    s_mov_b32 m0, s63
    s_add_u32 s74, s61, 0
    buffer_load_dwordx4 v12, s[40:43], s74 offen offset:0 lds
    s_add_u32 s74, s61, 31744
    buffer_load_dwordx4 v12, s[40:43], s74 offen offset:1024 lds
    s_add_u32 s74, s61, 63488
    buffer_load_dwordx4 v12, s[40:43], s74 offen offset:2048 lds
    s_add_u32 s74, s61, 95232
    buffer_load_dwordx4 v12, s[40:43], s74 offen offset:3072 lds
    s_add_u32 s60, s60, 128
    s_add_u32 s61, s61, 524288
    s_xor_b32 s62, s62, 0x10000
    s_xor_b32 s63, s63, 0x10000
    s_lshl_b32 s74, s3, 11
    s_add_u32 s74, s74, 131072
    s_mov_b32 m0, s74
    s_add_u32 s74, s69, 0
    buffer_load_dwordx4 v8, s[48:51], s74 offen offset:0 lds
    s_add_u32 s74, s69, 0
    buffer_load_dwordx4 v9, s[48:51], s74 offen offset:1024 lds
    s_lshl_b32 s74, s3, 10
    s_add_u32 s74, s74, 147456
    s_mov_b32 m0, s74
    s_add_u32 s74, s70, 0
    buffer_load_dwordx4 v13, s[52:55], s74 offen lds
    s_and_b32 s6, s3, 3
    s_lshl_b32 s6, s6, 12
    s_lshr_b32 s7, s3, 2
    s_lshl_b32 s7, s7, 12
    s_add_u32 s7, s7, 16384
    s_waitcnt vmcnt(11)
    s_barrier
    s_cmp_lt_u32 s3, 4
    s_cbranch_scc1 L_k1_nocf2
    v_swap_b32 v97, v98
    buffer_store_dwordx4 v[96:99], v14, s[56:59], s75 offen sc1
    s_nop 1
L_k1_nocf2:
    s_cmp_lt_u32 s3, 4
    s_cbranch_scc0 L_k1_vtype
    ds_read_b128 v[64:67], v16
    ds_read_b64_tr_b16 v[96:97], v20 offset:0
    ds_read_b64_tr_b16 v[98:99], v20 offset:1024
    ds_read_b64_tr_b16 v[100:101], v21 offset:0
    ds_read_b64_tr_b16 v[102:103], v21 offset:1024
    ds_read_b128 v[68:71], v16 offset:4096
    ds_read_b128 v[72:75], v16 offset:8192
    ds_read_b128 v[76:79], v16 offset:12288
    ds_read_b128 v[80:83], v17
    ds_read_b64_tr_b16 v[104:105], v20 offset:4096
    ds_read_b64_tr_b16 v[106:107], v20 offset:5120
    ds_read_b64_tr_b16 v[108:109], v21 offset:4096
    ds_read_b64_tr_b16 v[110:111], v21 offset:5120
    ds_read_b128 v[84:87], v17 offset:4096
    ds_read_b128 v[88:91], v17 offset:8192
    ds_read_b128 v[92:95], v17 offset:12288
    s_waitcnt lgkmcnt(15)
    s_waitcnt lgkmcnt(13)
    v_mfma_f32_32x32x16_bf16 v[128:143], v[96:99], v[64:67], v[128:143]
    s_waitcnt lgkmcnt(11)
    v_mfma_f32_32x32x16_bf16 v[144:159], v[100:103], v[64:67], v[144:159]
    s_waitcnt lgkmcnt(10)
    v_mfma_f32_32x32x16_bf16 v[160:175], v[96:99], v[68:71], v[160:175]
    v_mfma_f32_32x32x16_bf16 v[176:191], v[100:103], v[68:71], v[176:191]
    s_waitcnt lgkmcnt(9)
    v_mfma_f32_32x32x16_bf16 v[192:207], v[96:99], v[72:75], v[192:207]
    v_mfma_f32_32x32x16_bf16 v[208:223], v[100:103], v[72:75], v[208:223]
    s_waitcnt lgkmcnt(8)
    v_mfma_f32_32x32x16_bf16 v[224:239], v[96:99], v[76:79], v[224:239]
    v_mfma_f32_32x32x16_bf16 v[240:255], v[100:103], v[76:79], v[240:255]
    ds_read_b128 v[64:67], v18
    ds_read_b64_tr_b16 v[96:97], v20 offset:8192
    ds_read_b64_tr_b16 v[98:99], v20 offset:9216
    ds_read_b64_tr_b16 v[100:101], v21 offset:8192
    ds_read_b64_tr_b16 v[102:103], v21 offset:9216
    ds_read_b128 v[68:71], v18 offset:4096
    ds_read_b128 v[72:75], v18 offset:8192
    ds_read_b128 v[76:79], v18 offset:12288
    s_waitcnt lgkmcnt(15)
    s_waitcnt lgkmcnt(13)
    v_mfma_f32_32x32x16_bf16 v[128:143], v[104:107], v[80:83], v[128:143]
    s_waitcnt lgkmcnt(11)
    v_mfma_f32_32x32x16_bf16 v[144:159], v[108:111], v[80:83], v[144:159]
    s_waitcnt lgkmcnt(10)
    v_mfma_f32_32x32x16_bf16 v[160:175], v[104:107], v[84:87], v[160:175]
    v_mfma_f32_32x32x16_bf16 v[176:191], v[108:111], v[84:87], v[176:191]
    s_waitcnt lgkmcnt(9)
    v_mfma_f32_32x32x16_bf16 v[192:207], v[104:107], v[88:91], v[192:207]
    v_mfma_f32_32x32x16_bf16 v[208:223], v[108:111], v[88:91], v[208:223]
    s_waitcnt lgkmcnt(8)
    v_mfma_f32_32x32x16_bf16 v[224:239], v[104:107], v[92:95], v[224:239]
    v_mfma_f32_32x32x16_bf16 v[240:255], v[108:111], v[92:95], v[240:255]
    ds_read_b128 v[80:83], v19
    ds_read_b64_tr_b16 v[104:105], v20 offset:12288
    ds_read_b64_tr_b16 v[106:107], v20 offset:13312
    ds_read_b64_tr_b16 v[108:109], v21 offset:12288
    ds_read_b64_tr_b16 v[110:111], v21 offset:13312
    ds_read_b128 v[84:87], v19 offset:4096
    ds_read_b128 v[88:91], v19 offset:8192
    ds_read_b128 v[92:95], v19 offset:12288
    s_waitcnt lgkmcnt(15)
    s_waitcnt lgkmcnt(13)
    v_mfma_f32_32x32x16_bf16 v[128:143], v[96:99], v[64:67], v[128:143]
    s_waitcnt lgkmcnt(11)
    v_mfma_f32_32x32x16_bf16 v[144:159], v[100:103], v[64:67], v[144:159]
    s_waitcnt lgkmcnt(10)
    v_mfma_f32_32x32x16_bf16 v[160:175], v[96:99], v[68:71], v[160:175]
    v_mfma_f32_32x32x16_bf16 v[176:191], v[100:103], v[68:71], v[176:191]
    s_waitcnt lgkmcnt(9)
    v_mfma_f32_32x32x16_bf16 v[192:207], v[96:99], v[72:75], v[192:207]
    v_mfma_f32_32x32x16_bf16 v[208:223], v[100:103], v[72:75], v[208:223]
    s_waitcnt lgkmcnt(8)
    v_mfma_f32_32x32x16_bf16 v[224:239], v[96:99], v[76:79], v[224:239]
    v_mfma_f32_32x32x16_bf16 v[240:255], v[100:103], v[76:79], v[240:255]
    s_waitcnt lgkmcnt(0)
    s_waitcnt vmcnt(0)
    s_barrier
    v_xor_b32 v16, 0x10000, v16
    v_xor_b32 v17, 0x10000, v17
    v_xor_b32 v18, 0x10000, v18
    v_xor_b32 v19, 0x10000, v19
    v_xor_b32 v20, 0x10000, v20
    v_xor_b32 v21, 0x10000, v21
    ds_read_b128 v[64:67], v16
    ds_read_b64_tr_b16 v[96:97], v20 offset:0
    ds_read_b64_tr_b16 v[98:99], v20 offset:1024
    ds_read_b64_tr_b16 v[100:101], v21 offset:0
    ds_read_b64_tr_b16 v[102:103], v21 offset:1024
    ds_read_b128 v[68:71], v16 offset:4096
    ds_read_b128 v[72:75], v16 offset:8192
    ds_read_b128 v[76:79], v16 offset:12288
    v_mfma_f32_32x32x16_bf16 v[128:143], v[104:107], v[80:83], v[128:143]
    v_mfma_f32_32x32x16_bf16 v[144:159], v[108:111], v[80:83], v[144:159]
    s_mov_b32 m0, s62
    s_nop 0
    buffer_load_dwordx4 v8, s[32:35], s60 offen offset:0 lds
    v_mfma_f32_32x32x16_bf16 v[160:175], v[104:107], v[84:87], v[160:175]
    v_mfma_f32_32x32x16_bf16 v[176:191], v[108:111], v[84:87], v[176:191]
    buffer_load_dwordx4 v9, s[32:35], s60 offen offset:1024 lds
    v_mfma_f32_32x32x16_bf16 v[192:207], v[104:107], v[88:91], v[192:207]
    v_mfma_f32_32x32x16_bf16 v[208:223], v[108:111], v[88:91], v[208:223]
    buffer_load_dwordx4 v10, s[32:35], s60 offen offset:2048 lds
    v_mfma_f32_32x32x16_bf16 v[224:239], v[104:107], v[92:95], v[224:239]
    v_mfma_f32_32x32x16_bf16 v[240:255], v[108:111], v[92:95], v[240:255]
    buffer_load_dwordx4 v11, s[32:35], s60 offen offset:3072 lds
    ds_read_b128 v[80:83], v17
    ds_read_b64_tr_b16 v[104:105], v20 offset:4096
    ds_read_b64_tr_b16 v[106:107], v20 offset:5120
    ds_read_b64_tr_b16 v[108:109], v21 offset:4096
    ds_read_b64_tr_b16 v[110:111], v21 offset:5120
    ds_read_b128 v[84:87], v17 offset:4096
    ds_read_b128 v[88:91], v17 offset:8192
    ds_read_b128 v[92:95], v17 offset:12288
    s_waitcnt lgkmcnt(15)
    s_waitcnt lgkmcnt(13)
    v_mfma_f32_32x32x16_bf16 v[128:143], v[96:99], v[64:67], v[128:143]
    s_waitcnt lgkmcnt(11)
    v_mfma_f32_32x32x16_bf16 v[144:159], v[100:103], v[64:67], v[144:159]
    s_mov_b32 m0, s63
    s_add_u32 s74, s61, 0
    buffer_load_dwordx4 v12, s[40:43], s74 offen offset:0 lds
    s_waitcnt lgkmcnt(10)
    v_mfma_f32_32x32x16_bf16 v[160:175], v[96:99], v[68:71], v[160:175]
    v_mfma_f32_32x32x16_bf16 v[176:191], v[100:103], v[68:71], v[176:191]
    s_add_u32 s74, s61, 31744
    buffer_load_dwordx4 v12, s[40:43], s74 offen offset:1024 lds
    s_waitcnt lgkmcnt(9)
    v_mfma_f32_32x32x16_bf16 v[192:207], v[96:99], v[72:75], v[192:207]
    v_mfma_f32_32x32x16_bf16 v[208:223], v[100:103], v[72:75], v[208:223]
    s_add_u32 s74, s61, 63488
    buffer_load_dwordx4 v12, s[40:43], s74 offen offset:2048 lds
    s_waitcnt lgkmcnt(8)
    v_mfma_f32_32x32x16_bf16 v[224:239], v[96:99], v[76:79], v[224:239]
    v_mfma_f32_32x32x16_bf16 v[240:255], v[100:103], v[76:79], v[240:255]
    s_add_u32 s74, s61, 95232
    buffer_load_dwordx4 v12, s[40:43], s74 offen offset:3072 lds
    s_add_u32 s60, s60, 128
    s_add_u32 s61, s61, 524288
    s_xor_b32 s62, s62, 0x10000
    s_xor_b32 s63, s63, 0x10000
    ds_read_b128 v[64:67], v18
    ds_read_b64_tr_b16 v[96:97], v20 offset:8192
    ds_read_b64_tr_b16 v[98:99], v20 offset:9216
    ds_read_b64_tr_b16 v[100:101], v21 offset:8192
    ds_read_b64_tr_b16 v[102:103], v21 offset:9216
    ds_read_b128 v[68:71], v18 offset:4096
    ds_read_b128 v[72:75], v18 offset:8192
    ds_read_b128 v[76:79], v18 offset:12288
    s_waitcnt lgkmcnt(15)
    s_waitcnt lgkmcnt(13)
    v_mfma_f32_32x32x16_bf16 v[128:143], v[104:107], v[80:83], v[128:143]
    s_waitcnt lgkmcnt(11)
    v_mfma_f32_32x32x16_bf16 v[144:159], v[108:111], v[80:83], v[144:159]
    s_waitcnt lgkmcnt(10)
    v_mfma_f32_32x32x16_bf16 v[160:175], v[104:107], v[84:87], v[160:175]
    v_mfma_f32_32x32x16_bf16 v[176:191], v[108:111], v[84:87], v[176:191]
    s_waitcnt lgkmcnt(9)
    v_mfma_f32_32x32x16_bf16 v[192:207], v[104:107], v[88:91], v[192:207]
    v_mfma_f32_32x32x16_bf16 v[208:223], v[108:111], v[88:91], v[208:223]
    s_waitcnt lgkmcnt(8)
    v_mfma_f32_32x32x16_bf16 v[224:239], v[104:107], v[92:95], v[224:239]
    v_mfma_f32_32x32x16_bf16 v[240:255], v[108:111], v[92:95], v[240:255]
    ds_read_b128 v[80:83], v19
    ds_read_b64_tr_b16 v[104:105], v20 offset:12288
    ds_read_b64_tr_b16 v[106:107], v20 offset:13312
    ds_read_b64_tr_b16 v[108:109], v21 offset:12288
    ds_read_b64_tr_b16 v[110:111], v21 offset:13312
    ds_read_b128 v[84:87], v19 offset:4096
    ds_read_b128 v[88:91], v19 offset:8192
    ds_read_b128 v[92:95], v19 offset:12288
    s_waitcnt lgkmcnt(15)
    s_waitcnt lgkmcnt(13)
    v_mfma_f32_32x32x16_bf16 v[128:143], v[96:99], v[64:67], v[128:143]
    s_waitcnt lgkmcnt(11)
    v_mfma_f32_32x32x16_bf16 v[144:159], v[100:103], v[64:67], v[144:159]
    s_waitcnt lgkmcnt(10)
    v_mfma_f32_32x32x16_bf16 v[160:175], v[96:99], v[68:71], v[160:175]
    v_mfma_f32_32x32x16_bf16 v[176:191], v[100:103], v[68:71], v[176:191]
    s_waitcnt lgkmcnt(9)
    v_mfma_f32_32x32x16_bf16 v[192:207], v[96:99], v[72:75], v[192:207]
    v_mfma_f32_32x32x16_bf16 v[208:223], v[100:103], v[72:75], v[208:223]
    s_waitcnt lgkmcnt(8)
    v_mfma_f32_32x32x16_bf16 v[224:239], v[96:99], v[76:79], v[224:239]
    v_mfma_f32_32x32x16_bf16 v[240:255], v[100:103], v[76:79], v[240:255]
    s_waitcnt lgkmcnt(0)
    s_waitcnt vmcnt(0)
    s_barrier
    v_xor_b32 v16, 0x10000, v16
    v_xor_b32 v17, 0x10000, v17
    v_xor_b32 v18, 0x10000, v18
    v_xor_b32 v19, 0x10000, v19
    v_xor_b32 v20, 0x10000, v20
    v_xor_b32 v21, 0x10000, v21
    ds_read_b128 v[64:67], v16
    ds_read_b64_tr_b16 v[96:97], v20 offset:0
    ds_read_b64_tr_b16 v[98:99], v20 offset:1024
    ds_read_b64_tr_b16 v[100:101], v21 offset:0
    ds_read_b64_tr_b16 v[102:103], v21 offset:1024
    ds_read_b128 v[68:71], v16 offset:4096
    ds_read_b128 v[72:75], v16 offset:8192
    ds_read_b128 v[76:79], v16 offset:12288
    v_mfma_f32_32x32x16_bf16 v[128:143], v[104:107], v[80:83], v[128:143]
    v_mfma_f32_32x32x16_bf16 v[144:159], v[108:111], v[80:83], v[144:159]
    s_mov_b32 m0, s62
    s_nop 0
    buffer_load_dwordx4 v8, s[32:35], s60 offen offset:0 lds
    v_mfma_f32_32x32x16_bf16 v[160:175], v[104:107], v[84:87], v[160:175]
    v_mfma_f32_32x32x16_bf16 v[176:191], v[108:111], v[84:87], v[176:191]
    buffer_load_dwordx4 v9, s[32:35], s60 offen offset:1024 lds
    v_mfma_f32_32x32x16_bf16 v[192:207], v[104:107], v[88:91], v[192:207]
    v_mfma_f32_32x32x16_bf16 v[208:223], v[108:111], v[88:91], v[208:223]
    buffer_load_dwordx4 v10, s[32:35], s60 offen offset:2048 lds
    v_mfma_f32_32x32x16_bf16 v[224:239], v[104:107], v[92:95], v[224:239]
    v_mfma_f32_32x32x16_bf16 v[240:255], v[108:111], v[92:95], v[240:255]
    buffer_load_dwordx4 v11, s[32:35], s60 offen offset:3072 lds
    ds_read_b128 v[80:83], v17
    ds_read_b64_tr_b16 v[104:105], v20 offset:4096
    ds_read_b64_tr_b16 v[106:107], v20 offset:5120
    ds_read_b64_tr_b16 v[108:109], v21 offset:4096
    ds_read_b64_tr_b16 v[110:111], v21 offset:5120
    ds_read_b128 v[84:87], v17 offset:4096
    ds_read_b128 v[88:91], v17 offset:8192
    ds_read_b128 v[92:95], v17 offset:12288
    s_waitcnt lgkmcnt(15)
    s_waitcnt lgkmcnt(13)
    v_mfma_f32_32x32x16_bf16 v[128:143], v[96:99], v[64:67], v[128:143]
    s_waitcnt lgkmcnt(11)
    v_mfma_f32_32x32x16_bf16 v[144:159], v[100:103], v[64:67], v[144:159]
    s_mov_b32 m0, s63
    s_add_u32 s74, s61, 0
    buffer_load_dwordx4 v12, s[40:43], s74 offen offset:0 lds
    s_waitcnt lgkmcnt(10)
    v_mfma_f32_32x32x16_bf16 v[160:175], v[96:99], v[68:71], v[160:175]
    v_mfma_f32_32x32x16_bf16 v[176:191], v[100:103], v[68:71], v[176:191]
    s_add_u32 s74, s61, 31744
    buffer_load_dwordx4 v12, s[40:43], s74 offen offset:1024 lds
    s_waitcnt lgkmcnt(9)
    v_mfma_f32_32x32x16_bf16 v[192:207], v[96:99], v[72:75], v[192:207]
    v_mfma_f32_32x32x16_bf16 v[208:223], v[100:103], v[72:75], v[208:223]
    s_add_u32 s74, s61, 63488
    buffer_load_dwordx4 v12, s[40:43], s74 offen offset:2048 lds
    s_waitcnt lgkmcnt(8)
    v_mfma_f32_32x32x16_bf16 v[224:239], v[96:99], v[76:79], v[224:239]
    v_mfma_f32_32x32x16_bf16 v[240:255], v[100:103], v[76:79], v[240:255]
    s_add_u32 s74, s61, 95232
    buffer_load_dwordx4 v12, s[40:43], s74 offen offset:3072 lds
    s_add_u32 s60, s60, 128
    s_add_u32 s61, s61, 524288
    s_xor_b32 s62, s62, 0x10000
    s_xor_b32 s63, s63, 0x10000
    ds_read_b128 v[64:67], v18
    ds_read_b64_tr_b16 v[96:97], v20 offset:8192
    ds_read_b64_tr_b16 v[98:99], v20 offset:9216
    ds_read_b64_tr_b16 v[100:101], v21 offset:8192
    ds_read_b64_tr_b16 v[102:103], v21 offset:9216
    ds_read_b128 v[68:71], v18 offset:4096
    ds_read_b128 v[72:75], v18 offset:8192
    ds_read_b128 v[76:79], v18 offset:12288
    s_waitcnt lgkmcnt(15)
    s_waitcnt lgkmcnt(13)
    v_mfma_f32_32x32x16_bf16 v[128:143], v[104:107], v[80:83], v[128:143]
    s_waitcnt lgkmcnt(11)
    v_mfma_f32_32x32x16_bf16 v[144:159], v[108:111], v[80:83], v[144:159]
    s_waitcnt lgkmcnt(10)
    v_mfma_f32_32x32x16_bf16 v[160:175], v[104:107], v[84:87], v[160:175]
    v_mfma_f32_32x32x16_bf16 v[176:191], v[108:111], v[84:87], v[176:191]
    s_waitcnt lgkmcnt(9)
    v_mfma_f32_32x32x16_bf16 v[192:207], v[104:107], v[88:91], v[192:207]
    v_mfma_f32_32x32x16_bf16 v[208:223], v[108:111], v[88:91], v[208:223]
    s_waitcnt lgkmcnt(8)
    v_mfma_f32_32x32x16_bf16 v[224:239], v[104:107], v[92:95], v[224:239]
    v_mfma_f32_32x32x16_bf16 v[240:255], v[108:111], v[92:95], v[240:255]
    ds_read_b128 v[80:83], v19
    ds_read_b64_tr_b16 v[104:105], v20 offset:12288
    ds_read_b64_tr_b16 v[106:107], v20 offset:13312
    ds_read_b64_tr_b16 v[108:109], v21 offset:12288
    ds_read_b64_tr_b16 v[110:111], v21 offset:13312
    ds_read_b128 v[84:87], v19 offset:4096
    ds_read_b128 v[88:91], v19 offset:8192
    ds_read_b128 v[92:95], v19 offset:12288
    s_waitcnt lgkmcnt(15)
    s_waitcnt lgkmcnt(13)
    v_mfma_f32_32x32x16_bf16 v[128:143], v[96:99], v[64:67], v[128:143]
    s_waitcnt lgkmcnt(11)
    v_mfma_f32_32x32x16_bf16 v[144:159], v[100:103], v[64:67], v[144:159]
    s_waitcnt lgkmcnt(10)
    v_mfma_f32_32x32x16_bf16 v[160:175], v[96:99], v[68:71], v[160:175]
    v_mfma_f32_32x32x16_bf16 v[176:191], v[100:103], v[68:71], v[176:191]
    s_waitcnt lgkmcnt(9)
    v_mfma_f32_32x32x16_bf16 v[192:207], v[96:99], v[72:75], v[192:207]
    v_mfma_f32_32x32x16_bf16 v[208:223], v[100:103], v[72:75], v[208:223]
    s_waitcnt lgkmcnt(8)
    v_mfma_f32_32x32x16_bf16 v[224:239], v[96:99], v[76:79], v[224:239]
    v_mfma_f32_32x32x16_bf16 v[240:255], v[100:103], v[76:79], v[240:255]
    s_waitcnt lgkmcnt(0)
    s_waitcnt vmcnt(0)
    s_barrier
    v_xor_b32 v16, 0x10000, v16
    v_xor_b32 v17, 0x10000, v17
    v_xor_b32 v18, 0x10000, v18
    v_xor_b32 v19, 0x10000, v19
    v_xor_b32 v20, 0x10000, v20
    v_xor_b32 v21, 0x10000, v21
    ds_read_b128 v[64:67], v16
    ds_read_b64_tr_b16 v[96:97], v20 offset:0
    ds_read_b64_tr_b16 v[98:99], v20 offset:1024
    ds_read_b64_tr_b16 v[100:101], v21 offset:0
    ds_read_b64_tr_b16 v[102:103], v21 offset:1024
    ds_read_b128 v[68:71], v16 offset:4096
    ds_read_b128 v[72:75], v16 offset:8192
    ds_read_b128 v[76:79], v16 offset:12288
    v_mfma_f32_32x32x16_bf16 v[128:143], v[104:107], v[80:83], v[128:143]
    v_mfma_f32_32x32x16_bf16 v[144:159], v[108:111], v[80:83], v[144:159]
    s_mov_b32 m0, s62
    s_nop 0
    buffer_load_dwordx4 v8, s[32:35], s60 offen offset:0 lds
    v_mfma_f32_32x32x16_bf16 v[160:175], v[104:107], v[84:87], v[160:175]
    v_mfma_f32_32x32x16_bf16 v[176:191], v[108:111], v[84:87], v[176:191]
    buffer_load_dwordx4 v9, s[32:35], s60 offen offset:1024 lds
    v_mfma_f32_32x32x16_bf16 v[192:207], v[104:107], v[88:91], v[192:207]
    v_mfma_f32_32x32x16_bf16 v[208:223], v[108:111], v[88:91], v[208:223]
    buffer_load_dwordx4 v10, s[32:35], s60 offen offset:2048 lds
    v_mfma_f32_32x32x16_bf16 v[224:239], v[104:107], v[92:95], v[224:239]
    v_mfma_f32_32x32x16_bf16 v[240:255], v[108:111], v[92:95], v[240:255]
    buffer_load_dwordx4 v11, s[32:35], s60 offen offset:3072 lds
    ds_read_b128 v[80:83], v17
    ds_read_b64_tr_b16 v[104:105], v20 offset:4096
    ds_read_b64_tr_b16 v[106:107], v20 offset:5120
    ds_read_b64_tr_b16 v[108:109], v21 offset:4096
    ds_read_b64_tr_b16 v[110:111], v21 offset:5120
    ds_read_b128 v[84:87], v17 offset:4096
    ds_read_b128 v[88:91], v17 offset:8192
    ds_read_b128 v[92:95], v17 offset:12288
    s_waitcnt lgkmcnt(15)
    s_waitcnt lgkmcnt(13)
    v_mfma_f32_32x32x16_bf16 v[128:143], v[96:99], v[64:67], v[128:143]
    s_waitcnt lgkmcnt(11)
    v_mfma_f32_32x32x16_bf16 v[144:159], v[100:103], v[64:67], v[144:159]
    s_mov_b32 m0, s63
    s_add_u32 s74, s61, 0
    buffer_load_dwordx4 v12, s[40:43], s74 offen offset:0 lds
    s_waitcnt lgkmcnt(10)
    v_mfma_f32_32x32x16_bf16 v[160:175], v[96:99], v[68:71], v[160:175]
    v_mfma_f32_32x32x16_bf16 v[176:191], v[100:103], v[68:71], v[176:191]
    s_add_u32 s74, s61, 31744
    buffer_load_dwordx4 v12, s[40:43], s74 offen offset:1024 lds
    s_waitcnt lgkmcnt(9)
    v_mfma_f32_32x32x16_bf16 v[192:207], v[96:99], v[72:75], v[192:207]
    v_mfma_f32_32x32x16_bf16 v[208:223], v[100:103], v[72:75], v[208:223]
    s_add_u32 s74, s61, 63488
    buffer_load_dwordx4 v12, s[40:43], s74 offen offset:2048 lds
    s_waitcnt lgkmcnt(8)
    v_mfma_f32_32x32x16_bf16 v[224:239], v[96:99], v[76:79], v[224:239]
    v_mfma_f32_32x32x16_bf16 v[240:255], v[100:103], v[76:79], v[240:255]
    s_add_u32 s74, s61, 95232
    buffer_load_dwordx4 v12, s[40:43], s74 offen offset:3072 lds
    s_add_u32 s60, s60, 128
    s_add_u32 s61, s61, 524288
    s_xor_b32 s62, s62, 0x10000
    s_xor_b32 s63, s63, 0x10000
    ds_read_b128 v[64:67], v18
    ds_read_b64_tr_b16 v[96:97], v20 offset:8192
    ds_read_b64_tr_b16 v[98:99], v20 offset:9216
    ds_read_b64_tr_b16 v[100:101], v21 offset:8192
    ds_read_b64_tr_b16 v[102:103], v21 offset:9216
    ds_read_b128 v[68:71], v18 offset:4096
    ds_read_b128 v[72:75], v18 offset:8192
    ds_read_b128 v[76:79], v18 offset:12288
    s_waitcnt lgkmcnt(15)
    s_waitcnt lgkmcnt(13)
    v_mfma_f32_32x32x16_bf16 v[128:143], v[104:107], v[80:83], v[128:143]
    s_waitcnt lgkmcnt(11)
    v_mfma_f32_32x32x16_bf16 v[144:159], v[108:111], v[80:83], v[144:159]
    s_waitcnt lgkmcnt(10)
    v_mfma_f32_32x32x16_bf16 v[160:175], v[104:107], v[84:87], v[160:175]
    v_mfma_f32_32x32x16_bf16 v[176:191], v[108:111], v[84:87], v[176:191]
    s_waitcnt lgkmcnt(9)
    v_mfma_f32_32x32x16_bf16 v[192:207], v[104:107], v[88:91], v[192:207]
    v_mfma_f32_32x32x16_bf16 v[208:223], v[108:111], v[88:91], v[208:223]
    s_waitcnt lgkmcnt(8)
    v_mfma_f32_32x32x16_bf16 v[224:239], v[104:107], v[92:95], v[224:239]
    v_mfma_f32_32x32x16_bf16 v[240:255], v[108:111], v[92:95], v[240:255]
    ds_read_b128 v[80:83], v19
    ds_read_b64_tr_b16 v[104:105], v20 offset:12288
    ds_read_b64_tr_b16 v[106:107], v20 offset:13312
    ds_read_b64_tr_b16 v[108:109], v21 offset:12288
    ds_read_b64_tr_b16 v[110:111], v21 offset:13312
    ds_read_b128 v[84:87], v19 offset:4096
    ds_read_b128 v[88:91], v19 offset:8192
    ds_read_b128 v[92:95], v19 offset:12288
    s_waitcnt lgkmcnt(15)
    s_waitcnt lgkmcnt(13)
    v_mfma_f32_32x32x16_bf16 v[128:143], v[96:99], v[64:67], v[128:143]
    s_waitcnt lgkmcnt(11)
    v_mfma_f32_32x32x16_bf16 v[144:159], v[100:103], v[64:67], v[144:159]
    s_waitcnt lgkmcnt(10)
    v_mfma_f32_32x32x16_bf16 v[160:175], v[96:99], v[68:71], v[160:175]
    v_mfma_f32_32x32x16_bf16 v[176:191], v[100:103], v[68:71], v[176:191]
    s_waitcnt lgkmcnt(9)
    v_mfma_f32_32x32x16_bf16 v[192:207], v[96:99], v[72:75], v[192:207]
    v_mfma_f32_32x32x16_bf16 v[208:223], v[100:103], v[72:75], v[208:223]
    s_waitcnt lgkmcnt(8)
    v_mfma_f32_32x32x16_bf16 v[224:239], v[96:99], v[76:79], v[224:239]
    v_mfma_f32_32x32x16_bf16 v[240:255], v[100:103], v[76:79], v[240:255]
    s_waitcnt lgkmcnt(0)
    s_waitcnt vmcnt(0)
    s_barrier
    v_xor_b32 v16, 0x10000, v16
    v_xor_b32 v17, 0x10000, v17
    v_xor_b32 v18, 0x10000, v18
    v_xor_b32 v19, 0x10000, v19
    v_xor_b32 v20, 0x10000, v20
    v_xor_b32 v21, 0x10000, v21
    ds_read_b128 v[64:67], v16
    ds_read_b64_tr_b16 v[96:97], v20 offset:0
    ds_read_b64_tr_b16 v[98:99], v20 offset:1024
    ds_read_b64_tr_b16 v[100:101], v21 offset:0
    ds_read_b64_tr_b16 v[102:103], v21 offset:1024
    ds_read_b128 v[68:71], v16 offset:4096
    ds_read_b128 v[72:75], v16 offset:8192
    ds_read_b128 v[76:79], v16 offset:12288
    v_mfma_f32_32x32x16_bf16 v[128:143], v[104:107], v[80:83], v[128:143]
    v_mfma_f32_32x32x16_bf16 v[144:159], v[108:111], v[80:83], v[144:159]
    s_mov_b32 m0, s62
    s_nop 0
    buffer_load_dwordx4 v8, s[32:35], s60 offen offset:0 lds
    v_mfma_f32_32x32x16_bf16 v[160:175], v[104:107], v[84:87], v[160:175]
    v_mfma_f32_32x32x16_bf16 v[176:191], v[108:111], v[84:87], v[176:191]
    buffer_load_dwordx4 v9, s[32:35], s60 offen offset:1024 lds
    v_mfma_f32_32x32x16_bf16 v[192:207], v[104:107], v[88:91], v[192:207]
    v_mfma_f32_32x32x16_bf16 v[208:223], v[108:111], v[88:91], v[208:223]
    buffer_load_dwordx4 v10, s[32:35], s60 offen offset:2048 lds
    v_mfma_f32_32x32x16_bf16 v[224:239], v[104:107], v[92:95], v[224:239]
    v_mfma_f32_32x32x16_bf16 v[240:255], v[108:111], v[92:95], v[240:255]
    buffer_load_dwordx4 v11, s[32:35], s60 offen offset:3072 lds
    ds_read_b128 v[80:83], v17
    ds_read_b64_tr_b16 v[104:105], v20 offset:4096
    ds_read_b64_tr_b16 v[106:107], v20 offset:5120
    ds_read_b64_tr_b16 v[108:109], v21 offset:4096
    ds_read_b64_tr_b16 v[110:111], v21 offset:5120
    ds_read_b128 v[84:87], v17 offset:4096
    ds_read_b128 v[88:91], v17 offset:8192
    ds_read_b128 v[92:95], v17 offset:12288
    s_waitcnt lgkmcnt(15)
    s_waitcnt lgkmcnt(13)
    v_mfma_f32_32x32x16_bf16 v[128:143], v[96:99], v[64:67], v[128:143]
    s_waitcnt lgkmcnt(11)
    v_mfma_f32_32x32x16_bf16 v[144:159], v[100:103], v[64:67], v[144:159]
    s_mov_b32 m0, s63
    s_add_u32 s74, s61, 0
    buffer_load_dwordx4 v12, s[40:43], s74 offen offset:0 lds
    s_waitcnt lgkmcnt(10)
    v_mfma_f32_32x32x16_bf16 v[160:175], v[96:99], v[68:71], v[160:175]
    v_mfma_f32_32x32x16_bf16 v[176:191], v[100:103], v[68:71], v[176:191]
    s_add_u32 s74, s61, 31744
    buffer_load_dwordx4 v12, s[40:43], s74 offen offset:1024 lds
    s_waitcnt lgkmcnt(9)
    v_mfma_f32_32x32x16_bf16 v[192:207], v[96:99], v[72:75], v[192:207]
    v_mfma_f32_32x32x16_bf16 v[208:223], v[100:103], v[72:75], v[208:223]
    s_add_u32 s74, s61, 63488
    buffer_load_dwordx4 v12, s[40:43], s74 offen offset:2048 lds
    s_waitcnt lgkmcnt(8)
    v_mfma_f32_32x32x16_bf16 v[224:239], v[96:99], v[76:79], v[224:239]
    v_mfma_f32_32x32x16_bf16 v[240:255], v[100:103], v[76:79], v[240:255]
    s_add_u32 s74, s61, 95232
    buffer_load_dwordx4 v12, s[40:43], s74 offen offset:3072 lds
    s_add_u32 s60, s60, 128
    s_add_u32 s61, s61, 524288
    s_xor_b32 s62, s62, 0x10000
    s_xor_b32 s63, s63, 0x10000
    ds_read_b128 v[64:67], v18
    ds_read_b64_tr_b16 v[96:97], v20 offset:8192
    ds_read_b64_tr_b16 v[98:99], v20 offset:9216
    ds_read_b64_tr_b16 v[100:101], v21 offset:8192
    ds_read_b64_tr_b16 v[102:103], v21 offset:9216
    ds_read_b128 v[68:71], v18 offset:4096
    ds_read_b128 v[72:75], v18 offset:8192
    ds_read_b128 v[76:79], v18 offset:12288
    s_waitcnt lgkmcnt(15)
    s_waitcnt lgkmcnt(13)
    v_mfma_f32_32x32x16_bf16 v[128:143], v[104:107], v[80:83], v[128:143]
    s_waitcnt lgkmcnt(11)
    v_mfma_f32_32x32x16_bf16 v[144:159], v[108:111], v[80:83], v[144:159]
    s_waitcnt lgkmcnt(10)
    v_mfma_f32_32x32x16_bf16 v[160:175], v[104:107], v[84:87], v[160:175]
    v_mfma_f32_32x32x16_bf16 v[176:191], v[108:111], v[84:87], v[176:191]
    s_waitcnt lgkmcnt(9)
    v_mfma_f32_32x32x16_bf16 v[192:207], v[104:107], v[88:91], v[192:207]
    v_mfma_f32_32x32x16_bf16 v[208:223], v[108:111], v[88:91], v[208:223]
    s_waitcnt lgkmcnt(8)
    v_mfma_f32_32x32x16_bf16 v[224:239], v[104:107], v[92:95], v[224:239]
    v_mfma_f32_32x32x16_bf16 v[240:255], v[108:111], v[92:95], v[240:255]
    ds_read_b128 v[80:83], v19
    ds_read_b64_tr_b16 v[104:105], v20 offset:12288
    ds_read_b64_tr_b16 v[106:107], v20 offset:13312
    ds_read_b64_tr_b16 v[108:109], v21 offset:12288
    ds_read_b64_tr_b16 v[110:111], v21 offset:13312
    ds_read_b128 v[84:87], v19 offset:4096
    ds_read_b128 v[88:91], v19 offset:8192
    ds_read_b128 v[92:95], v19 offset:12288
    s_waitcnt lgkmcnt(15)
    s_waitcnt lgkmcnt(13)
    v_mfma_f32_32x32x16_bf16 v[128:143], v[96:99], v[64:67], v[128:143]
    s_waitcnt lgkmcnt(11)
    v_mfma_f32_32x32x16_bf16 v[144:159], v[100:103], v[64:67], v[144:159]
    s_waitcnt lgkmcnt(10)
    v_mfma_f32_32x32x16_bf16 v[160:175], v[96:99], v[68:71], v[160:175]
    v_mfma_f32_32x32x16_bf16 v[176:191], v[100:103], v[68:71], v[176:191]
    s_waitcnt lgkmcnt(9)
    v_mfma_f32_32x32x16_bf16 v[192:207], v[96:99], v[72:75], v[192:207]
    v_mfma_f32_32x32x16_bf16 v[208:223], v[100:103], v[72:75], v[208:223]
    s_waitcnt lgkmcnt(8)
    v_mfma_f32_32x32x16_bf16 v[224:239], v[96:99], v[76:79], v[224:239]
    v_mfma_f32_32x32x16_bf16 v[240:255], v[100:103], v[76:79], v[240:255]
    s_waitcnt lgkmcnt(0)
    s_waitcnt vmcnt(0)
    s_barrier
    v_xor_b32 v16, 0x10000, v16
    v_xor_b32 v17, 0x10000, v17
    v_xor_b32 v18, 0x10000, v18
    v_xor_b32 v19, 0x10000, v19
    v_xor_b32 v20, 0x10000, v20
    v_xor_b32 v21, 0x10000, v21
    ds_read_b128 v[64:67], v16
    ds_read_b64_tr_b16 v[96:97], v20 offset:0
    ds_read_b64_tr_b16 v[98:99], v20 offset:1024
    ds_read_b64_tr_b16 v[100:101], v21 offset:0
    ds_read_b64_tr_b16 v[102:103], v21 offset:1024
    ds_read_b128 v[68:71], v16 offset:4096
    ds_read_b128 v[72:75], v16 offset:8192
    ds_read_b128 v[76:79], v16 offset:12288
    v_mfma_f32_32x32x16_bf16 v[128:143], v[104:107], v[80:83], v[128:143]
    v_mfma_f32_32x32x16_bf16 v[144:159], v[108:111], v[80:83], v[144:159]
    s_mov_b32 m0, s62
    s_nop 0
    buffer_load_dwordx4 v8, s[32:35], s60 offen offset:0 lds
    v_mfma_f32_32x32x16_bf16 v[160:175], v[104:107], v[84:87], v[160:175]
    v_mfma_f32_32x32x16_bf16 v[176:191], v[108:111], v[84:87], v[176:191]
    buffer_load_dwordx4 v9, s[32:35], s60 offen offset:1024 lds
    v_mfma_f32_32x32x16_bf16 v[192:207], v[104:107], v[88:91], v[192:207]
    v_mfma_f32_32x32x16_bf16 v[208:223], v[108:111], v[88:91], v[208:223]
    buffer_load_dwordx4 v10, s[32:35], s60 offen offset:2048 lds
    v_mfma_f32_32x32x16_bf16 v[224:239], v[104:107], v[92:95], v[224:239]
    v_mfma_f32_32x32x16_bf16 v[240:255], v[108:111], v[92:95], v[240:255]
    buffer_load_dwordx4 v11, s[32:35], s60 offen offset:3072 lds
    ds_read_b128 v[80:83], v17
    ds_read_b64_tr_b16 v[104:105], v20 offset:4096
    ds_read_b64_tr_b16 v[106:107], v20 offset:5120
    ds_read_b64_tr_b16 v[108:109], v21 offset:4096
    ds_read_b64_tr_b16 v[110:111], v21 offset:5120
    ds_read_b128 v[84:87], v17 offset:4096
    ds_read_b128 v[88:91], v17 offset:8192
    ds_read_b128 v[92:95], v17 offset:12288
    s_waitcnt lgkmcnt(15)
    s_waitcnt lgkmcnt(13)
    v_mfma_f32_32x32x16_bf16 v[128:143], v[96:99], v[64:67], v[128:143]
    s_waitcnt lgkmcnt(11)
    v_mfma_f32_32x32x16_bf16 v[144:159], v[100:103], v[64:67], v[144:159]
    s_mov_b32 m0, s63
    s_add_u32 s74, s61, 0
    buffer_load_dwordx4 v12, s[40:43], s74 offen offset:0 lds
    s_waitcnt lgkmcnt(10)
    v_mfma_f32_32x32x16_bf16 v[160:175], v[96:99], v[68:71], v[160:175]
    v_mfma_f32_32x32x16_bf16 v[176:191], v[100:103], v[68:71], v[176:191]
    s_add_u32 s74, s61, 31744
    buffer_load_dwordx4 v12, s[40:43], s74 offen offset:1024 lds
    s_waitcnt lgkmcnt(9)
    v_mfma_f32_32x32x16_bf16 v[192:207], v[96:99], v[72:75], v[192:207]
    v_mfma_f32_32x32x16_bf16 v[208:223], v[100:103], v[72:75], v[208:223]
    s_add_u32 s74, s61, 63488
    buffer_load_dwordx4 v12, s[40:43], s74 offen offset:2048 lds
    s_waitcnt lgkmcnt(8)
    v_mfma_f32_32x32x16_bf16 v[224:239], v[96:99], v[76:79], v[224:239]
    v_mfma_f32_32x32x16_bf16 v[240:255], v[100:103], v[76:79], v[240:255]
    s_add_u32 s74, s61, 95232
    buffer_load_dwordx4 v12, s[40:43], s74 offen offset:3072 lds
    s_add_u32 s60, s60, 128
    s_add_u32 s61, s61, 524288
    s_xor_b32 s62, s62, 0x10000
    s_xor_b32 s63, s63, 0x10000
    ds_read_b128 v[64:67], v18
    ds_read_b64_tr_b16 v[96:97], v20 offset:8192
    ds_read_b64_tr_b16 v[98:99], v20 offset:9216
    ds_read_b64_tr_b16 v[100:101], v21 offset:8192
    ds_read_b64_tr_b16 v[102:103], v21 offset:9216
    ds_read_b128 v[68:71], v18 offset:4096
    ds_read_b128 v[72:75], v18 offset:8192
    ds_read_b128 v[76:79], v18 offset:12288
    s_waitcnt lgkmcnt(15)
    s_waitcnt lgkmcnt(13)
    v_mfma_f32_32x32x16_bf16 v[128:143], v[104:107], v[80:83], v[128:143]
    s_waitcnt lgkmcnt(11)
    v_mfma_f32_32x32x16_bf16 v[144:159], v[108:111], v[80:83], v[144:159]
    s_waitcnt lgkmcnt(10)
    v_mfma_f32_32x32x16_bf16 v[160:175], v[104:107], v[84:87], v[160:175]
    v_mfma_f32_32x32x16_bf16 v[176:191], v[108:111], v[84:87], v[176:191]
    s_waitcnt lgkmcnt(9)
    v_mfma_f32_32x32x16_bf16 v[192:207], v[104:107], v[88:91], v[192:207]
    v_mfma_f32_32x32x16_bf16 v[208:223], v[108:111], v[88:91], v[208:223]
    s_waitcnt lgkmcnt(8)
    v_mfma_f32_32x32x16_bf16 v[224:239], v[104:107], v[92:95], v[224:239]
    v_mfma_f32_32x32x16_bf16 v[240:255], v[108:111], v[92:95], v[240:255]
    ds_read_b128 v[80:83], v19
    ds_read_b64_tr_b16 v[104:105], v20 offset:12288
    ds_read_b64_tr_b16 v[106:107], v20 offset:13312
    ds_read_b64_tr_b16 v[108:109], v21 offset:12288
    ds_read_b64_tr_b16 v[110:111], v21 offset:13312
    ds_read_b128 v[84:87], v19 offset:4096
    ds_read_b128 v[88:91], v19 offset:8192
    ds_read_b128 v[92:95], v19 offset:12288
    s_waitcnt lgkmcnt(15)
    s_waitcnt lgkmcnt(13)
    v_mfma_f32_32x32x16_bf16 v[128:143], v[96:99], v[64:67], v[128:143]
    s_waitcnt lgkmcnt(11)
    v_mfma_f32_32x32x16_bf16 v[144:159], v[100:103], v[64:67], v[144:159]
    s_waitcnt lgkmcnt(10)
    v_mfma_f32_32x32x16_bf16 v[160:175], v[96:99], v[68:71], v[160:175]
    v_mfma_f32_32x32x16_bf16 v[176:191], v[100:103], v[68:71], v[176:191]
    s_waitcnt lgkmcnt(9)
    v_mfma_f32_32x32x16_bf16 v[192:207], v[96:99], v[72:75], v[192:207]
    v_mfma_f32_32x32x16_bf16 v[208:223], v[100:103], v[72:75], v[208:223]
    s_waitcnt lgkmcnt(8)
    v_mfma_f32_32x32x16_bf16 v[224:239], v[96:99], v[76:79], v[224:239]
    v_mfma_f32_32x32x16_bf16 v[240:255], v[100:103], v[76:79], v[240:255]
    s_waitcnt lgkmcnt(0)
    s_waitcnt vmcnt(0)
    s_barrier
    v_xor_b32 v16, 0x10000, v16
    v_xor_b32 v17, 0x10000, v17
    v_xor_b32 v18, 0x10000, v18
    v_xor_b32 v19, 0x10000, v19
    v_xor_b32 v20, 0x10000, v20
    v_xor_b32 v21, 0x10000, v21
    ds_read_b128 v[64:67], v16
    ds_read_b64_tr_b16 v[96:97], v20 offset:0
    ds_read_b64_tr_b16 v[98:99], v20 offset:1024
    ds_read_b64_tr_b16 v[100:101], v21 offset:0
    ds_read_b64_tr_b16 v[102:103], v21 offset:1024
    ds_read_b128 v[68:71], v16 offset:4096
    ds_read_b128 v[72:75], v16 offset:8192
    ds_read_b128 v[76:79], v16 offset:12288
    v_mfma_f32_32x32x16_bf16 v[128:143], v[104:107], v[80:83], v[128:143]
    v_mfma_f32_32x32x16_bf16 v[144:159], v[108:111], v[80:83], v[144:159]
    s_mov_b32 m0, s62
    s_nop 0
    buffer_load_dwordx4 v8, s[32:35], s60 offen offset:0 lds
    v_mfma_f32_32x32x16_bf16 v[160:175], v[104:107], v[84:87], v[160:175]
    v_mfma_f32_32x32x16_bf16 v[176:191], v[108:111], v[84:87], v[176:191]
    buffer_load_dwordx4 v9, s[32:35], s60 offen offset:1024 lds
    v_mfma_f32_32x32x16_bf16 v[192:207], v[104:107], v[88:91], v[192:207]
    v_mfma_f32_32x32x16_bf16 v[208:223], v[108:111], v[88:91], v[208:223]
    buffer_load_dwordx4 v10, s[32:35], s60 offen offset:2048 lds
    v_mfma_f32_32x32x16_bf16 v[224:239], v[104:107], v[92:95], v[224:239]
    v_mfma_f32_32x32x16_bf16 v[240:255], v[108:111], v[92:95], v[240:255]
    buffer_load_dwordx4 v11, s[32:35], s60 offen offset:3072 lds
    ds_read_b128 v[80:83], v17
    ds_read_b64_tr_b16 v[104:105], v20 offset:4096
    ds_read_b64_tr_b16 v[106:107], v20 offset:5120
    ds_read_b64_tr_b16 v[108:109], v21 offset:4096
    ds_read_b64_tr_b16 v[110:111], v21 offset:5120
    ds_read_b128 v[84:87], v17 offset:4096
    ds_read_b128 v[88:91], v17 offset:8192
    ds_read_b128 v[92:95], v17 offset:12288
    s_waitcnt lgkmcnt(15)
    s_waitcnt lgkmcnt(13)
    v_mfma_f32_32x32x16_bf16 v[128:143], v[96:99], v[64:67], v[128:143]
    s_waitcnt lgkmcnt(11)
    v_mfma_f32_32x32x16_bf16 v[144:159], v[100:103], v[64:67], v[144:159]
    s_mov_b32 m0, s63
    s_add_u32 s74, s61, 0
    buffer_load_dwordx4 v12, s[40:43], s74 offen offset:0 lds
    s_waitcnt lgkmcnt(10)
    v_mfma_f32_32x32x16_bf16 v[160:175], v[96:99], v[68:71], v[160:175]
    v_mfma_f32_32x32x16_bf16 v[176:191], v[100:103], v[68:71], v[176:191]
    s_add_u32 s74, s61, 31744
    buffer_load_dwordx4 v12, s[40:43], s74 offen offset:1024 lds
    s_waitcnt lgkmcnt(9)
    v_mfma_f32_32x32x16_bf16 v[192:207], v[96:99], v[72:75], v[192:207]
    v_mfma_f32_32x32x16_bf16 v[208:223], v[100:103], v[72:75], v[208:223]
    s_add_u32 s74, s61, 63488
    buffer_load_dwordx4 v12, s[40:43], s74 offen offset:2048 lds
    s_waitcnt lgkmcnt(8)
    v_mfma_f32_32x32x16_bf16 v[224:239], v[96:99], v[76:79], v[224:239]
    v_mfma_f32_32x32x16_bf16 v[240:255], v[100:103], v[76:79], v[240:255]
    s_add_u32 s74, s61, 95232
    buffer_load_dwordx4 v12, s[40:43], s74 offen offset:3072 lds
    s_add_u32 s60, s60, 128
    s_add_u32 s61, s61, 524288
    s_xor_b32 s62, s62, 0x10000
    s_xor_b32 s63, s63, 0x10000
    ds_read_b128 v[64:67], v18
    ds_read_b64_tr_b16 v[96:97], v20 offset:8192
    ds_read_b64_tr_b16 v[98:99], v20 offset:9216
    ds_read_b64_tr_b16 v[100:101], v21 offset:8192
    ds_read_b64_tr_b16 v[102:103], v21 offset:9216
    ds_read_b128 v[68:71], v18 offset:4096
    ds_read_b128 v[72:75], v18 offset:8192
    ds_read_b128 v[76:79], v18 offset:12288
    s_waitcnt lgkmcnt(15)
    s_waitcnt lgkmcnt(13)
    v_mfma_f32_32x32x16_bf16 v[128:143], v[104:107], v[80:83], v[128:143]
    s_waitcnt lgkmcnt(11)
    v_mfma_f32_32x32x16_bf16 v[144:159], v[108:111], v[80:83], v[144:159]
    s_waitcnt lgkmcnt(10)
    v_mfma_f32_32x32x16_bf16 v[160:175], v[104:107], v[84:87], v[160:175]
    v_mfma_f32_32x32x16_bf16 v[176:191], v[108:111], v[84:87], v[176:191]
    s_waitcnt lgkmcnt(9)
    v_mfma_f32_32x32x16_bf16 v[192:207], v[104:107], v[88:91], v[192:207]
    v_mfma_f32_32x32x16_bf16 v[208:223], v[108:111], v[88:91], v[208:223]
    s_waitcnt lgkmcnt(8)
    v_mfma_f32_32x32x16_bf16 v[224:239], v[104:107], v[92:95], v[224:239]
    v_mfma_f32_32x32x16_bf16 v[240:255], v[108:111], v[92:95], v[240:255]
    ds_read_b128 v[80:83], v19
    ds_read_b64_tr_b16 v[104:105], v20 offset:12288
    ds_read_b64_tr_b16 v[106:107], v20 offset:13312
    ds_read_b64_tr_b16 v[108:109], v21 offset:12288
    ds_read_b64_tr_b16 v[110:111], v21 offset:13312
    ds_read_b128 v[84:87], v19 offset:4096
    ds_read_b128 v[88:91], v19 offset:8192
    ds_read_b128 v[92:95], v19 offset:12288
    s_waitcnt lgkmcnt(15)
    s_waitcnt lgkmcnt(13)
    v_mfma_f32_32x32x16_bf16 v[128:143], v[96:99], v[64:67], v[128:143]
    s_waitcnt lgkmcnt(11)
    v_mfma_f32_32x32x16_bf16 v[144:159], v[100:103], v[64:67], v[144:159]
    s_waitcnt lgkmcnt(10)
    v_mfma_f32_32x32x16_bf16 v[160:175], v[96:99], v[68:71], v[160:175]
    v_mfma_f32_32x32x16_bf16 v[176:191], v[100:103], v[68:71], v[176:191]
    s_waitcnt lgkmcnt(9)
    v_mfma_f32_32x32x16_bf16 v[192:207], v[96:99], v[72:75], v[192:207]
    v_mfma_f32_32x32x16_bf16 v[208:223], v[100:103], v[72:75], v[208:223]
    s_waitcnt lgkmcnt(8)
    v_mfma_f32_32x32x16_bf16 v[224:239], v[96:99], v[76:79], v[224:239]
    v_mfma_f32_32x32x16_bf16 v[240:255], v[100:103], v[76:79], v[240:255]
    s_waitcnt lgkmcnt(0)
    s_waitcnt vmcnt(0)
    s_barrier
    s_mov_b32 s28, s18
    s_mov_b32 s29, s19
    s_mov_b32 s30, 0x400000
    s_mov_b32 s31, 0x00020000
    v_lshrrev_b32 v32, 2, v1
    v_xor_b32 v32, v32, v5
    v_and_b32 v32, 1, v32
    v_lshlrev_b32 v32, 6, v32
    v_lshrrev_b32 v33, 3, v1
    v_lshl_add_u32 v32, v33, 10, v32
    v_and_b32 v33, 3, v1
    v_lshl_add_u32 v32, v33, 4, v32
    v_add_u32 v33, 7168, v32
    s_lshl_b32 s65, s3, 11
    s_add_u32 s65, s65, 49152
    s_mov_b32 m0, s65
    s_lshl_b32 s66, s2, 14
    s_lshl_b32 s65, s3, 7
    s_add_u32 s66, s66, s65
    buffer_load_dwordx4 v32, s[28:31], s66 offen lds
    buffer_load_dwordx4 v33, s[28:31], s66 offen offset:1024 lds
    v_xor_b32 v16, 0x10000, v16
    v_xor_b32 v17, 0x10000, v17
    v_xor_b32 v18, 0x10000, v18
    v_xor_b32 v19, 0x10000, v19
    v_xor_b32 v20, 0x10000, v20
    v_xor_b32 v21, 0x10000, v21
    ds_read_b128 v[64:67], v16
    ds_read_b64_tr_b16 v[96:97], v20 offset:0
    ds_read_b64_tr_b16 v[98:99], v20 offset:1024
    ds_read_b64_tr_b16 v[100:101], v21 offset:0
    ds_read_b64_tr_b16 v[102:103], v21 offset:1024
    ds_read_b128 v[68:71], v16 offset:4096
    ds_read_b128 v[72:75], v16 offset:8192
    ds_read_b128 v[76:79], v16 offset:12288
    v_mfma_f32_32x32x16_bf16 v[128:143], v[104:107], v[80:83], v[128:143]
    v_mfma_f32_32x32x16_bf16 v[144:159], v[108:111], v[80:83], v[144:159]
    s_lshl_b32 s74, s3, 11
    s_add_u32 s74, s74, 0
    s_mov_b32 m0, s74
    s_add_u32 s74, s69, 128
    buffer_load_dwordx4 v8, s[48:51], s74 offen offset:0 lds
    v_mfma_f32_32x32x16_bf16 v[160:175], v[104:107], v[84:87], v[160:175]
    v_mfma_f32_32x32x16_bf16 v[176:191], v[108:111], v[84:87], v[176:191]
    s_add_u32 s74, s69, 128
    buffer_load_dwordx4 v9, s[48:51], s74 offen offset:1024 lds
    v_mfma_f32_32x32x16_bf16 v[192:207], v[104:107], v[88:91], v[192:207]
    v_mfma_f32_32x32x16_bf16 v[208:223], v[108:111], v[88:91], v[208:223]
    s_lshl_b32 s74, s3, 10
    s_add_u32 s74, s74, 16384
    s_mov_b32 m0, s74
    s_add_u32 s74, s70, 128
    buffer_load_dwordx4 v13, s[52:55], s74 offen lds
    v_mfma_f32_32x32x16_bf16 v[224:239], v[104:107], v[92:95], v[224:239]
    v_mfma_f32_32x32x16_bf16 v[240:255], v[108:111], v[92:95], v[240:255]
    s_lshl_b32 s74, s3, 11
    s_add_u32 s74, s74, 24576
    s_mov_b32 m0, s74
    s_add_u32 s74, s69, 256
    buffer_load_dwordx4 v8, s[48:51], s74 offen offset:0 lds
    ds_read_b128 v[80:83], v17
    ds_read_b64_tr_b16 v[104:105], v20 offset:4096
    ds_read_b64_tr_b16 v[106:107], v20 offset:5120
    ds_read_b64_tr_b16 v[108:109], v21 offset:4096
    ds_read_b64_tr_b16 v[110:111], v21 offset:5120
    ds_read_b128 v[84:87], v17 offset:4096
    ds_read_b128 v[88:91], v17 offset:8192
    ds_read_b128 v[92:95], v17 offset:12288
    s_waitcnt lgkmcnt(15)
    s_waitcnt lgkmcnt(13)
    v_mfma_f32_32x32x16_bf16 v[128:143], v[96:99], v[64:67], v[128:143]
    s_waitcnt lgkmcnt(11)
    v_mfma_f32_32x32x16_bf16 v[144:159], v[100:103], v[64:67], v[144:159]
    s_add_u32 s74, s69, 256
    buffer_load_dwordx4 v9, s[48:51], s74 offen offset:1024 lds
    s_waitcnt lgkmcnt(10)
    v_mfma_f32_32x32x16_bf16 v[160:175], v[96:99], v[68:71], v[160:175]
    v_mfma_f32_32x32x16_bf16 v[176:191], v[100:103], v[68:71], v[176:191]
    s_lshl_b32 s74, s3, 10
    s_add_u32 s74, s74, 40960
    s_mov_b32 m0, s74
    s_add_u32 s74, s70, 256
    buffer_load_dwordx4 v13, s[52:55], s74 offen lds
    s_waitcnt lgkmcnt(9)
    v_mfma_f32_32x32x16_bf16 v[192:207], v[96:99], v[72:75], v[192:207]
    v_mfma_f32_32x32x16_bf16 v[208:223], v[100:103], v[72:75], v[208:223]
    s_waitcnt lgkmcnt(8)
    v_mfma_f32_32x32x16_bf16 v[224:239], v[96:99], v[76:79], v[224:239]
    v_mfma_f32_32x32x16_bf16 v[240:255], v[100:103], v[76:79], v[240:255]
    ds_read_b128 v[64:67], v18
    ds_read_b64_tr_b16 v[96:97], v20 offset:8192
    ds_read_b64_tr_b16 v[98:99], v20 offset:9216
    ds_read_b64_tr_b16 v[100:101], v21 offset:8192
    ds_read_b64_tr_b16 v[102:103], v21 offset:9216
    ds_read_b128 v[68:71], v18 offset:4096
    ds_read_b128 v[72:75], v18 offset:8192
    ds_read_b128 v[76:79], v18 offset:12288
    s_waitcnt lgkmcnt(15)
    s_waitcnt lgkmcnt(13)
    v_mfma_f32_32x32x16_bf16 v[128:143], v[104:107], v[80:83], v[128:143]
    s_waitcnt lgkmcnt(11)
    v_mfma_f32_32x32x16_bf16 v[144:159], v[108:111], v[80:83], v[144:159]
    s_waitcnt lgkmcnt(10)
    v_mfma_f32_32x32x16_bf16 v[160:175], v[104:107], v[84:87], v[160:175]
    v_mfma_f32_32x32x16_bf16 v[176:191], v[108:111], v[84:87], v[176:191]
    s_waitcnt lgkmcnt(9)
    v_mfma_f32_32x32x16_bf16 v[192:207], v[104:107], v[88:91], v[192:207]
    v_mfma_f32_32x32x16_bf16 v[208:223], v[108:111], v[88:91], v[208:223]
    s_waitcnt lgkmcnt(8)
    v_mfma_f32_32x32x16_bf16 v[224:239], v[104:107], v[92:95], v[224:239]
    v_mfma_f32_32x32x16_bf16 v[240:255], v[108:111], v[92:95], v[240:255]
    ds_read_b128 v[80:83], v19
    ds_read_b64_tr_b16 v[104:105], v20 offset:12288
    ds_read_b64_tr_b16 v[106:107], v20 offset:13312
    ds_read_b64_tr_b16 v[108:109], v21 offset:12288
    ds_read_b64_tr_b16 v[110:111], v21 offset:13312
    ds_read_b128 v[84:87], v19 offset:4096
    ds_read_b128 v[88:91], v19 offset:8192
    ds_read_b128 v[92:95], v19 offset:12288
    s_waitcnt lgkmcnt(15)
    s_waitcnt lgkmcnt(13)
    v_mfma_f32_32x32x16_bf16 v[128:143], v[96:99], v[64:67], v[128:143]
    s_waitcnt lgkmcnt(11)
    v_mfma_f32_32x32x16_bf16 v[144:159], v[100:103], v[64:67], v[144:159]
    s_waitcnt lgkmcnt(10)
    v_mfma_f32_32x32x16_bf16 v[160:175], v[96:99], v[68:71], v[160:175]
    v_mfma_f32_32x32x16_bf16 v[176:191], v[100:103], v[68:71], v[176:191]
    s_waitcnt lgkmcnt(9)
    v_mfma_f32_32x32x16_bf16 v[192:207], v[96:99], v[72:75], v[192:207]
    v_mfma_f32_32x32x16_bf16 v[208:223], v[100:103], v[72:75], v[208:223]
    s_waitcnt lgkmcnt(8)
    v_mfma_f32_32x32x16_bf16 v[224:239], v[96:99], v[76:79], v[224:239]
    v_mfma_f32_32x32x16_bf16 v[240:255], v[100:103], v[76:79], v[240:255]
    s_waitcnt lgkmcnt(0)
    s_waitcnt vmcnt(0)
    s_barrier
    v_mfma_f32_32x32x16_bf16 v[128:143], v[104:107], v[80:83], v[128:143]
    v_mfma_f32_32x32x16_bf16 v[144:159], v[108:111], v[80:83], v[144:159]
    s_lshl_b32 s74, s3, 11
    s_add_u32 s74, s74, 65536
    s_mov_b32 m0, s74
    s_add_u32 s74, s69, 384
    buffer_load_dwordx4 v8, s[48:51], s74 offen offset:0 lds
    v_mfma_f32_32x32x16_bf16 v[160:175], v[104:107], v[84:87], v[160:175]
    v_mfma_f32_32x32x16_bf16 v[176:191], v[108:111], v[84:87], v[176:191]
    s_add_u32 s74, s69, 384
    buffer_load_dwordx4 v9, s[48:51], s74 offen offset:1024 lds
    v_mfma_f32_32x32x16_bf16 v[192:207], v[104:107], v[88:91], v[192:207]
    v_mfma_f32_32x32x16_bf16 v[208:223], v[108:111], v[88:91], v[208:223]
    s_lshl_b32 s74, s3, 10
    s_add_u32 s74, s74, 81920
    s_mov_b32 m0, s74
    s_add_u32 s74, s70, 384
    buffer_load_dwordx4 v13, s[52:55], s74 offen lds
    v_mfma_f32_32x32x16_bf16 v[224:239], v[104:107], v[92:95], v[224:239]
    v_mfma_f32_32x32x16_bf16 v[240:255], v[108:111], v[92:95], v[240:255]
    s_lshl_b32 s74, s3, 11
    s_add_u32 s74, s74, 90112
    s_mov_b32 m0, s74
    s_add_u32 s74, s69, 512
    buffer_load_dwordx4 v8, s[48:51], s74 offen offset:0 lds
    s_add_u32 s74, s69, 512
    buffer_load_dwordx4 v9, s[48:51], s74 offen offset:1024 lds
    s_lshl_b32 s74, s3, 10
    s_add_u32 s74, s74, 106496
    s_mov_b32 m0, s74
    s_add_u32 s74, s70, 512
    buffer_load_dwordx4 v13, s[52:55], s74 offen lds
    v_add_u32 v6, s6, v24
    v_add_u32 v7, s7, v24
    v_add_u32 v6, 0x20000, v6
    v_add_u32 v7, 0x20000, v7
    ds_read_b128 v[64:67], v6 offset:0
    ds_read_b128 v[68:71], v7 offset:0
    v_add_u32 v6, s6, v25
    v_add_u32 v7, s7, v25
    v_add_u32 v6, 0x20000, v6
    v_add_u32 v7, 0x20000, v7
    ds_read_b128 v[72:75], v6 offset:0
    ds_read_b128 v[76:79], v7 offset:0
    v_add_u32 v6, s6, v26
    v_add_u32 v7, s7, v26
    v_add_u32 v6, 0x20000, v6
    v_add_u32 v7, 0x20000, v7
    ds_read_b128 v[80:83], v6 offset:0
    ds_read_b128 v[84:87], v7 offset:0
    v_add_u32 v6, s6, v27
    v_add_u32 v7, s7, v27
    v_add_u32 v6, 0x20000, v6
    v_add_u32 v7, 0x20000, v7
    ds_read_b128 v[88:91], v6 offset:0
    ds_read_b128 v[92:95], v7 offset:0
    v_add_u32 v6, s6, v24
    v_add_u32 v7, s7, v24
    ds_read_b128 v[32:35], v6 offset:0
    ds_read_b128 v[36:39], v7 offset:0
    v_add_u32 v6, s6, v25
    v_add_u32 v7, s7, v25
    ds_read_b128 v[40:43], v6 offset:0
    ds_read_b128 v[44:47], v7 offset:0
    v_add_u32 v6, s6, v26
    v_add_u32 v7, s7, v26
    ds_read_b128 v[48:51], v6 offset:0
    ds_read_b128 v[52:55], v7 offset:0
    v_add_u32 v6, s6, v27
    v_add_u32 v7, s7, v27
    ds_read_b128 v[56:59], v6 offset:0
    ds_read_b128 v[60:63], v7 offset:0
    s_waitcnt lgkmcnt(14)
    v_mfma_f32_32x32x16_bf16 v[112:127], v[64:67], v[68:71], v[112:127]
    s_waitcnt lgkmcnt(12)
    v_mfma_f32_32x32x16_bf16 v[112:127], v[72:75], v[76:79], v[112:127]
    s_waitcnt lgkmcnt(10)
    v_mfma_f32_32x32x16_bf16 v[112:127], v[80:83], v[84:87], v[112:127]
    s_waitcnt lgkmcnt(8)
    v_mfma_f32_32x32x16_bf16 v[112:127], v[88:91], v[92:95], v[112:127]
    v_add_u32 v6, s6, v24
    v_add_u32 v7, s7, v24
    ds_read_b128 v[64:67], v6 offset:24576
    ds_read_b128 v[68:71], v7 offset:24576
    v_add_u32 v6, s6, v25
    v_add_u32 v7, s7, v25
    ds_read_b128 v[72:75], v6 offset:24576
    ds_read_b128 v[76:79], v7 offset:24576
    v_add_u32 v6, s6, v26
    v_add_u32 v7, s7, v26
    ds_read_b128 v[80:83], v6 offset:24576
    ds_read_b128 v[84:87], v7 offset:24576
    v_add_u32 v6, s6, v27
    v_add_u32 v7, s7, v27
    ds_read_b128 v[88:91], v6 offset:24576
    ds_read_b128 v[92:95], v7 offset:24576
    s_waitcnt lgkmcnt(14)
    v_mfma_f32_32x32x16_bf16 v[112:127], v[32:35], v[36:39], v[112:127]
    s_waitcnt lgkmcnt(12)
    v_mfma_f32_32x32x16_bf16 v[112:127], v[40:43], v[44:47], v[112:127]
    s_waitcnt lgkmcnt(10)
    v_mfma_f32_32x32x16_bf16 v[112:127], v[48:51], v[52:55], v[112:127]
    s_waitcnt lgkmcnt(8)
    v_mfma_f32_32x32x16_bf16 v[112:127], v[56:59], v[60:63], v[112:127]
    s_waitcnt lgkmcnt(6)
    v_mfma_f32_32x32x16_bf16 v[112:127], v[64:67], v[68:71], v[112:127]
    s_waitcnt lgkmcnt(4)
    v_mfma_f32_32x32x16_bf16 v[112:127], v[72:75], v[76:79], v[112:127]
    s_waitcnt lgkmcnt(2)
    v_mfma_f32_32x32x16_bf16 v[112:127], v[80:83], v[84:87], v[112:127]
    s_waitcnt lgkmcnt(0)
    v_mfma_f32_32x32x16_bf16 v[112:127], v[88:91], v[92:95], v[112:127]
    s_waitcnt lgkmcnt(0)
    s_waitcnt vmcnt(0)
    s_barrier
    s_lshl_b32 s74, s3, 11
    s_add_u32 s74, s74, 131072
    s_mov_b32 m0, s74
    s_add_u32 s74, s69, 640
    buffer_load_dwordx4 v8, s[48:51], s74 offen offset:0 lds
    s_add_u32 s74, s69, 640
    buffer_load_dwordx4 v9, s[48:51], s74 offen offset:1024 lds
    s_lshl_b32 s74, s3, 10
    s_add_u32 s74, s74, 147456
    s_mov_b32 m0, s74
    s_add_u32 s74, s70, 640
    buffer_load_dwordx4 v13, s[52:55], s74 offen lds
    s_lshl_b32 s74, s3, 11
    s_add_u32 s74, s74, 0
    s_mov_b32 m0, s74
    s_add_u32 s74, s69, 768
    buffer_load_dwordx4 v8, s[48:51], s74 offen offset:0 lds
    s_add_u32 s74, s69, 768
    buffer_load_dwordx4 v9, s[48:51], s74 offen offset:1024 lds
    s_lshl_b32 s74, s3, 10
    s_add_u32 s74, s74, 16384
    s_mov_b32 m0, s74
    s_add_u32 s74, s70, 768
    buffer_load_dwordx4 v13, s[52:55], s74 offen lds
    s_lshl_b32 s74, s3, 11
    s_add_u32 s74, s74, 24576
    s_mov_b32 m0, s74
    s_add_u32 s74, s69, 896
    buffer_load_dwordx4 v8, s[48:51], s74 offen offset:0 lds
    s_add_u32 s74, s69, 896
    buffer_load_dwordx4 v9, s[48:51], s74 offen offset:1024 lds
    s_lshl_b32 s74, s3, 10
    s_add_u32 s74, s74, 40960
    s_mov_b32 m0, s74
    s_add_u32 s74, s70, 896
    buffer_load_dwordx4 v13, s[52:55], s74 offen lds
    v_lshrrev_b32 v34, 2, v4
    v_lshl_add_u32 v34, v3, 2, v34
    v_lshlrev_b32 v34, 7, v34
    v_and_b32 v35, 1, v5
    v_lshl_add_u32 v34, v35, 5, v34
    v_and_b32 v35, 3, v4
    v_lshl_add_u32 v34, v35, 3, v34
    s_lshl_b32 s65, s3, 11
    s_add_u32 s65, s65, 49152
    v_add_u32 v34, s65, v34
    v_lshrrev_b32 v35, 3, v4
    v_lshl_add_u32 v32, v35, 6, v34
    v_xor_b32 v35, 1, v35
    v_lshl_add_u32 v33, v35, 6, v34
    ds_read_b64_tr_b16 v[40:41], v32 offset:0
    ds_read_b64_tr_b16 v[42:43], v32 offset:1024
    ds_read_b64_tr_b16 v[44:45], v33 offset:0
    ds_read_b64_tr_b16 v[46:47], v33 offset:1024
    s_lshl_b32 s65, s3, 19
    s_lshl_b32 s66, s2, 10
    s_add_u32 s65, s65, s66
    s_add_u32 s65, s65, 0x5000000
    s_add_u32 s66, s65, 0x40000
    s_waitcnt lgkmcnt(0)
    buffer_store_dwordx4 v[40:43], v14, s[56:59], s65 offen sc1
    buffer_store_dwordx4 v[44:47], v14, s[56:59], s66 offen sc1
    s_lshl_b32 s73, s5, 19
    s_and_b32 s65, s3, 1
    s_lshr_b32 s66, s3, 1
    s_and_b32 s66, s66, 1
    s_mov_b32 s64, 0x3e0293ee
    s_lshl_b32 s65, s65, 15
    s_add_u32 s73, s73, s65
    s_lshl_b32 s65, s4, 16
    s_add_u32 s73, s73, s65
    s_lshl_b32 s66, s66, 12
    s_add_u32 s73, s73, s66
    s_add_u32 s73, s73, 0x1000000
    s_add_u32 s65, s73, 0
    v_mul_f32 v128, s64, v128
    v_mul_f32 v129, s64, v129
    v_mul_f32 v130, s64, v130
    v_mul_f32 v131, s64, v131
    v_mul_f32 v132, s64, v132
    v_mul_f32 v133, s64, v133
    v_mul_f32 v134, s64, v134
    v_mul_f32 v135, s64, v135
    v_cvt_pk_bf16_f32 v32, v128, v129
    v_cvt_pk_bf16_f32 v33, v130, v131
    v_cvt_pk_bf16_f32 v34, v132, v133
    v_cvt_pk_bf16_f32 v35, v134, v135
    buffer_store_dwordx4 v[32:35], v14, s[56:59], s65 offen offset:0 sc1
    v_add_u32 v6, s6, v24
    v_add_u32 v7, s7, v24
    v_add_u32 v6, 0x10000, v6
    v_add_u32 v7, 0x10000, v7
    ds_read_b128 v[64:67], v6 offset:0
    ds_read_b128 v[68:71], v7 offset:0
    v_add_u32 v6, s6, v25
    v_add_u32 v7, s7, v25
    v_add_u32 v6, 0x10000, v6
    v_add_u32 v7, 0x10000, v7
    ds_read_b128 v[72:75], v6 offset:0
    ds_read_b128 v[76:79], v7 offset:0
    v_mul_f32 v136, s64, v136
    v_mul_f32 v137, s64, v137
    v_mul_f32 v138, s64, v138
    v_mul_f32 v139, s64, v139
    v_mul_f32 v140, s64, v140
    v_mul_f32 v141, s64, v141
    v_mul_f32 v142, s64, v142
    v_mul_f32 v143, s64, v143
    v_cvt_pk_bf16_f32 v36, v136, v137
    v_cvt_pk_bf16_f32 v37, v138, v139
    v_cvt_pk_bf16_f32 v38, v140, v141
    v_cvt_pk_bf16_f32 v39, v142, v143
    buffer_store_dwordx4 v[36:39], v14, s[56:59], s65 offen offset:1024 sc1
    v_add_u32 v6, s6, v26
    v_add_u32 v7, s7, v26
    v_add_u32 v6, 0x10000, v6
    v_add_u32 v7, 0x10000, v7
    ds_read_b128 v[80:83], v6 offset:0
    ds_read_b128 v[84:87], v7 offset:0
    v_add_u32 v6, s6, v27
    v_add_u32 v7, s7, v27
    v_add_u32 v6, 0x10000, v6
    v_add_u32 v7, 0x10000, v7
    ds_read_b128 v[88:91], v6 offset:0
    ds_read_b128 v[92:95], v7 offset:0
    v_mul_f32 v144, s64, v144
    v_mul_f32 v145, s64, v145
    v_mul_f32 v146, s64, v146
    v_mul_f32 v147, s64, v147
    v_mul_f32 v148, s64, v148
    v_mul_f32 v149, s64, v149
    v_mul_f32 v150, s64, v150
    v_mul_f32 v151, s64, v151
    v_cvt_pk_bf16_f32 v40, v144, v145
    v_cvt_pk_bf16_f32 v41, v146, v147
    v_cvt_pk_bf16_f32 v42, v148, v149
    v_cvt_pk_bf16_f32 v43, v150, v151
    buffer_store_dwordx4 v[40:43], v14, s[56:59], s65 offen offset:2048 sc1
    s_waitcnt lgkmcnt(6)
    v_mfma_f32_32x32x16_bf16 v[112:127], v[64:67], v[68:71], v[112:127]
    s_waitcnt lgkmcnt(4)
    v_mfma_f32_32x32x16_bf16 v[112:127], v[72:75], v[76:79], v[112:127]
    v_mul_f32 v152, s64, v152
    v_mul_f32 v153, s64, v153
    v_mul_f32 v154, s64, v154
    v_mul_f32 v155, s64, v155
    v_mul_f32 v156, s64, v156
    v_mul_f32 v157, s64, v157
    v_mul_f32 v158, s64, v158
    v_mul_f32 v159, s64, v159
    v_cvt_pk_bf16_f32 v44, v152, v153
    v_cvt_pk_bf16_f32 v45, v154, v155
    v_cvt_pk_bf16_f32 v46, v156, v157
    v_cvt_pk_bf16_f32 v47, v158, v159
    buffer_store_dwordx4 v[44:47], v14, s[56:59], s65 offen offset:3072 sc1
    s_waitcnt lgkmcnt(2)
    v_mfma_f32_32x32x16_bf16 v[112:127], v[80:83], v[84:87], v[112:127]
    s_waitcnt lgkmcnt(0)
    v_mfma_f32_32x32x16_bf16 v[112:127], v[88:91], v[92:95], v[112:127]
    s_add_u32 s65, s73, 8192
    v_mul_f32 v160, s64, v160
    v_mul_f32 v161, s64, v161
    v_mul_f32 v162, s64, v162
    v_mul_f32 v163, s64, v163
    v_mul_f32 v164, s64, v164
    v_mul_f32 v165, s64, v165
    v_mul_f32 v166, s64, v166
    v_mul_f32 v167, s64, v167
    v_cvt_pk_bf16_f32 v48, v160, v161
    v_cvt_pk_bf16_f32 v49, v162, v163
    v_cvt_pk_bf16_f32 v50, v164, v165
    v_cvt_pk_bf16_f32 v51, v166, v167
    buffer_store_dwordx4 v[48:51], v14, s[56:59], s65 offen offset:0 sc1
    v_add_u32 v6, s6, v24
    v_add_u32 v7, s7, v24
    v_add_u32 v6, 0x16000, v6
    v_add_u32 v7, 0x16000, v7
    ds_read_b128 v[64:67], v6 offset:0
    ds_read_b128 v[68:71], v7 offset:0
    v_add_u32 v6, s6, v25
    v_add_u32 v7, s7, v25
    v_add_u32 v6, 0x16000, v6
    v_add_u32 v7, 0x16000, v7
    ds_read_b128 v[72:75], v6 offset:0
    ds_read_b128 v[76:79], v7 offset:0
    v_mul_f32 v168, s64, v168
    v_mul_f32 v169, s64, v169
    v_mul_f32 v170, s64, v170
    v_mul_f32 v171, s64, v171
    v_mul_f32 v172, s64, v172
    v_mul_f32 v173, s64, v173
    v_mul_f32 v174, s64, v174
    v_mul_f32 v175, s64, v175
    v_cvt_pk_bf16_f32 v52, v168, v169
    v_cvt_pk_bf16_f32 v53, v170, v171
    v_cvt_pk_bf16_f32 v54, v172, v173
    v_cvt_pk_bf16_f32 v55, v174, v175
    buffer_store_dwordx4 v[52:55], v14, s[56:59], s65 offen offset:1024 sc1
    v_add_u32 v6, s6, v26
    v_add_u32 v7, s7, v26
    v_add_u32 v6, 0x16000, v6
    v_add_u32 v7, 0x16000, v7
    ds_read_b128 v[80:83], v6 offset:0
    ds_read_b128 v[84:87], v7 offset:0
    v_add_u32 v6, s6, v27
    v_add_u32 v7, s7, v27
    v_add_u32 v6, 0x16000, v6
    v_add_u32 v7, 0x16000, v7
    ds_read_b128 v[88:91], v6 offset:0
    ds_read_b128 v[92:95], v7 offset:0
    v_mul_f32 v176, s64, v176
    v_mul_f32 v177, s64, v177
    v_mul_f32 v178, s64, v178
    v_mul_f32 v179, s64, v179
    v_mul_f32 v180, s64, v180
    v_mul_f32 v181, s64, v181
    v_mul_f32 v182, s64, v182
    v_mul_f32 v183, s64, v183
    v_cvt_pk_bf16_f32 v56, v176, v177
    v_cvt_pk_bf16_f32 v57, v178, v179
    v_cvt_pk_bf16_f32 v58, v180, v181
    v_cvt_pk_bf16_f32 v59, v182, v183
    buffer_store_dwordx4 v[56:59], v14, s[56:59], s65 offen offset:2048 sc1
    s_waitcnt lgkmcnt(6)
    v_mfma_f32_32x32x16_bf16 v[112:127], v[64:67], v[68:71], v[112:127]
    s_waitcnt lgkmcnt(4)
    v_mfma_f32_32x32x16_bf16 v[112:127], v[72:75], v[76:79], v[112:127]
    v_mul_f32 v184, s64, v184
    v_mul_f32 v185, s64, v185
    v_mul_f32 v186, s64, v186
    v_mul_f32 v187, s64, v187
    v_mul_f32 v188, s64, v188
    v_mul_f32 v189, s64, v189
    v_mul_f32 v190, s64, v190
    v_mul_f32 v191, s64, v191
    v_cvt_pk_bf16_f32 v60, v184, v185
    v_cvt_pk_bf16_f32 v61, v186, v187
    v_cvt_pk_bf16_f32 v62, v188, v189
    v_cvt_pk_bf16_f32 v63, v190, v191
    buffer_store_dwordx4 v[60:63], v14, s[56:59], s65 offen offset:3072 sc1
    s_waitcnt lgkmcnt(2)
    v_mfma_f32_32x32x16_bf16 v[112:127], v[80:83], v[84:87], v[112:127]
    s_waitcnt lgkmcnt(0)
    v_mfma_f32_32x32x16_bf16 v[112:127], v[88:91], v[92:95], v[112:127]
    s_add_u32 s65, s73, 16384
    v_mul_f32 v192, s64, v192
    v_mul_f32 v193, s64, v193
    v_mul_f32 v194, s64, v194
    v_mul_f32 v195, s64, v195
    v_mul_f32 v196, s64, v196
    v_mul_f32 v197, s64, v197
    v_mul_f32 v198, s64, v198
    v_mul_f32 v199, s64, v199
    v_cvt_pk_bf16_f32 v32, v192, v193
    v_cvt_pk_bf16_f32 v33, v194, v195
    v_cvt_pk_bf16_f32 v34, v196, v197
    v_cvt_pk_bf16_f32 v35, v198, v199
    buffer_store_dwordx4 v[32:35], v14, s[56:59], s65 offen offset:0 sc1
    v_mul_f32 v200, s64, v200
    v_mul_f32 v201, s64, v201
    v_mul_f32 v202, s64, v202
    v_mul_f32 v203, s64, v203
    v_mul_f32 v204, s64, v204
    v_mul_f32 v205, s64, v205
    v_mul_f32 v206, s64, v206
    v_mul_f32 v207, s64, v207
    v_cvt_pk_bf16_f32 v36, v200, v201
    v_cvt_pk_bf16_f32 v37, v202, v203
    v_cvt_pk_bf16_f32 v38, v204, v205
    v_cvt_pk_bf16_f32 v39, v206, v207
    buffer_store_dwordx4 v[36:39], v14, s[56:59], s65 offen offset:1024 sc1
    s_waitcnt lgkmcnt(0)
    s_waitcnt vmcnt(12)
    s_barrier
    v_mul_f32 v208, s64, v208
    v_mul_f32 v209, s64, v209
    v_mul_f32 v210, s64, v210
    v_mul_f32 v211, s64, v211
    v_mul_f32 v212, s64, v212
    v_mul_f32 v213, s64, v213
    v_mul_f32 v214, s64, v214
    v_mul_f32 v215, s64, v215
    v_cvt_pk_bf16_f32 v40, v208, v209
    v_cvt_pk_bf16_f32 v41, v210, v211
    v_cvt_pk_bf16_f32 v42, v212, v213
    v_cvt_pk_bf16_f32 v43, v214, v215
    buffer_store_dwordx4 v[40:43], v14, s[56:59], s65 offen offset:2048 sc1
    v_add_u32 v6, s6, v24
    v_add_u32 v7, s7, v24
    v_add_u32 v6, 0x20000, v6
    v_add_u32 v7, 0x20000, v7
    ds_read_b128 v[64:67], v6 offset:0
    ds_read_b128 v[68:71], v7 offset:0
    v_add_u32 v6, s6, v25
    v_add_u32 v7, s7, v25
    v_add_u32 v6, 0x20000, v6
    v_add_u32 v7, 0x20000, v7
    ds_read_b128 v[72:75], v6 offset:0
    ds_read_b128 v[76:79], v7 offset:0
    v_add_u32 v6, s6, v26
    v_add_u32 v7, s7, v26
    v_add_u32 v6, 0x20000, v6
    v_add_u32 v7, 0x20000, v7
    ds_read_b128 v[80:83], v6 offset:0
    ds_read_b128 v[84:87], v7 offset:0
    v_add_u32 v6, s6, v27
    v_add_u32 v7, s7, v27
    v_add_u32 v6, 0x20000, v6
    v_add_u32 v7, 0x20000, v7
    ds_read_b128 v[88:91], v6 offset:0
    ds_read_b128 v[92:95], v7 offset:0
    v_mul_f32 v216, s64, v216
    v_mul_f32 v217, s64, v217
    v_mul_f32 v218, s64, v218
    v_mul_f32 v219, s64, v219
    v_mul_f32 v220, s64, v220
    v_mul_f32 v221, s64, v221
    v_mul_f32 v222, s64, v222
    v_mul_f32 v223, s64, v223
    v_cvt_pk_bf16_f32 v44, v216, v217
    v_cvt_pk_bf16_f32 v45, v218, v219
    v_cvt_pk_bf16_f32 v46, v220, v221
    v_cvt_pk_bf16_f32 v47, v222, v223
    buffer_store_dwordx4 v[44:47], v14, s[56:59], s65 offen offset:3072 sc1
    s_waitcnt lgkmcnt(6)
    v_mfma_f32_32x32x16_bf16 v[112:127], v[64:67], v[68:71], v[112:127]
    s_waitcnt lgkmcnt(4)
    v_mfma_f32_32x32x16_bf16 v[112:127], v[72:75], v[76:79], v[112:127]
    s_waitcnt lgkmcnt(2)
    v_mfma_f32_32x32x16_bf16 v[112:127], v[80:83], v[84:87], v[112:127]
    s_waitcnt lgkmcnt(0)
    v_mfma_f32_32x32x16_bf16 v[112:127], v[88:91], v[92:95], v[112:127]
    s_add_u32 s65, s73, 24576
    v_mul_f32 v224, s64, v224
    v_mul_f32 v225, s64, v225
    v_mul_f32 v226, s64, v226
    v_mul_f32 v227, s64, v227
    v_mul_f32 v228, s64, v228
    v_mul_f32 v229, s64, v229
    v_mul_f32 v230, s64, v230
    v_mul_f32 v231, s64, v231
    v_cvt_pk_bf16_f32 v48, v224, v225
    v_cvt_pk_bf16_f32 v49, v226, v227
    v_cvt_pk_bf16_f32 v50, v228, v229
    v_cvt_pk_bf16_f32 v51, v230, v231
    buffer_store_dwordx4 v[48:51], v14, s[56:59], s65 offen offset:0 sc1
    v_add_u32 v6, s6, v24
    v_add_u32 v7, s7, v24
    ds_read_b128 v[64:67], v6 offset:0
    ds_read_b128 v[68:71], v7 offset:0
    v_add_u32 v6, s6, v25
    v_add_u32 v7, s7, v25
    ds_read_b128 v[72:75], v6 offset:0
    ds_read_b128 v[76:79], v7 offset:0
    v_add_u32 v6, s6, v26
    v_add_u32 v7, s7, v26
    ds_read_b128 v[80:83], v6 offset:0
    ds_read_b128 v[84:87], v7 offset:0
    v_add_u32 v6, s6, v27
    v_add_u32 v7, s7, v27
    ds_read_b128 v[88:91], v6 offset:0
    ds_read_b128 v[92:95], v7 offset:0
    v_mul_f32 v232, s64, v232
    v_mul_f32 v233, s64, v233
    v_mul_f32 v234, s64, v234
    v_mul_f32 v235, s64, v235
    v_mul_f32 v236, s64, v236
    v_mul_f32 v237, s64, v237
    v_mul_f32 v238, s64, v238
    v_mul_f32 v239, s64, v239
    v_cvt_pk_bf16_f32 v52, v232, v233
    v_cvt_pk_bf16_f32 v53, v234, v235
    v_cvt_pk_bf16_f32 v54, v236, v237
    v_cvt_pk_bf16_f32 v55, v238, v239
    buffer_store_dwordx4 v[52:55], v14, s[56:59], s65 offen offset:1024 sc1
    s_waitcnt lgkmcnt(6)
    v_mfma_f32_32x32x16_bf16 v[112:127], v[64:67], v[68:71], v[112:127]
    s_waitcnt lgkmcnt(4)
    v_mfma_f32_32x32x16_bf16 v[112:127], v[72:75], v[76:79], v[112:127]
    s_waitcnt lgkmcnt(2)
    v_mfma_f32_32x32x16_bf16 v[112:127], v[80:83], v[84:87], v[112:127]
    s_waitcnt lgkmcnt(0)
    v_mfma_f32_32x32x16_bf16 v[112:127], v[88:91], v[92:95], v[112:127]
    v_mul_f32 v240, s64, v240
    v_mul_f32 v241, s64, v241
    v_mul_f32 v242, s64, v242
    v_mul_f32 v243, s64, v243
    v_mul_f32 v244, s64, v244
    v_mul_f32 v245, s64, v245
    v_mul_f32 v246, s64, v246
    v_mul_f32 v247, s64, v247
    v_cvt_pk_bf16_f32 v56, v240, v241
    v_cvt_pk_bf16_f32 v57, v242, v243
    v_cvt_pk_bf16_f32 v58, v244, v245
    v_cvt_pk_bf16_f32 v59, v246, v247
    buffer_store_dwordx4 v[56:59], v14, s[56:59], s65 offen offset:2048 sc1
    v_add_u32 v6, s6, v24
    v_add_u32 v7, s7, v24
    ds_read_b128 v[64:67], v6 offset:24576
    ds_read_b128 v[68:71], v7 offset:24576
    v_add_u32 v6, s6, v25
    v_add_u32 v7, s7, v25
    ds_read_b128 v[72:75], v6 offset:24576
    ds_read_b128 v[76:79], v7 offset:24576
    v_add_u32 v6, s6, v26
    v_add_u32 v7, s7, v26
    ds_read_b128 v[80:83], v6 offset:24576
    ds_read_b128 v[84:87], v7 offset:24576
    v_add_u32 v6, s6, v27
    v_add_u32 v7, s7, v27
    ds_read_b128 v[88:91], v6 offset:24576
    ds_read_b128 v[92:95], v7 offset:24576
    v_mul_f32 v248, s64, v248
    v_mul_f32 v249, s64, v249
    v_mul_f32 v250, s64, v250
    v_mul_f32 v251, s64, v251
    v_mul_f32 v252, s64, v252
    v_mul_f32 v253, s64, v253
    v_mul_f32 v254, s64, v254
    v_mul_f32 v255, s64, v255
    v_cvt_pk_bf16_f32 v60, v248, v249
    v_cvt_pk_bf16_f32 v61, v250, v251
    v_cvt_pk_bf16_f32 v62, v252, v253
    v_cvt_pk_bf16_f32 v63, v254, v255
    buffer_store_dwordx4 v[60:63], v14, s[56:59], s65 offen offset:3072 sc1
    s_waitcnt lgkmcnt(6)
    v_mfma_f32_32x32x16_bf16 v[112:127], v[64:67], v[68:71], v[112:127]
    s_waitcnt lgkmcnt(4)
    v_mfma_f32_32x32x16_bf16 v[112:127], v[72:75], v[76:79], v[112:127]
    s_waitcnt lgkmcnt(2)
    v_mfma_f32_32x32x16_bf16 v[112:127], v[80:83], v[84:87], v[112:127]
    s_waitcnt lgkmcnt(0)
    v_mfma_f32_32x32x16_bf16 v[112:127], v[88:91], v[92:95], v[112:127]
    s_branch L_k1_phase2
L_k1_vtype:
    ds_read_b128 v[64:67], v16
    ds_read_b64_tr_b16 v[96:97], v20 offset:0
    ds_read_b64_tr_b16 v[98:99], v20 offset:1024
    ds_read_b64_tr_b16 v[100:101], v21 offset:0
    ds_read_b64_tr_b16 v[102:103], v21 offset:1024
    ds_read_b128 v[68:71], v16 offset:4096
    ds_read_b128 v[72:75], v16 offset:8192
    ds_read_b128 v[76:79], v16 offset:12288
    ds_read_b128 v[80:83], v17
    ds_read_b64_tr_b16 v[104:105], v20 offset:4096
    ds_read_b64_tr_b16 v[106:107], v20 offset:5120
    ds_read_b64_tr_b16 v[108:109], v21 offset:4096
    ds_read_b64_tr_b16 v[110:111], v21 offset:5120
    ds_read_b128 v[84:87], v17 offset:4096
    ds_read_b128 v[88:91], v17 offset:8192
    ds_read_b128 v[92:95], v17 offset:12288
    s_waitcnt lgkmcnt(15)
    s_waitcnt lgkmcnt(13)
    v_mfma_f32_32x32x16_bf16 v[128:143], v[64:67], v[96:99], v[128:143]
    s_waitcnt lgkmcnt(11)
    v_mfma_f32_32x32x16_bf16 v[144:159], v[64:67], v[100:103], v[144:159]
    s_waitcnt lgkmcnt(10)
    v_mfma_f32_32x32x16_bf16 v[160:175], v[68:71], v[96:99], v[160:175]
    v_mfma_f32_32x32x16_bf16 v[176:191], v[68:71], v[100:103], v[176:191]
    s_waitcnt lgkmcnt(9)
    v_mfma_f32_32x32x16_bf16 v[192:207], v[72:75], v[96:99], v[192:207]
    v_mfma_f32_32x32x16_bf16 v[208:223], v[72:75], v[100:103], v[208:223]
    s_waitcnt lgkmcnt(8)
    v_mfma_f32_32x32x16_bf16 v[224:239], v[76:79], v[96:99], v[224:239]
    v_mfma_f32_32x32x16_bf16 v[240:255], v[76:79], v[100:103], v[240:255]
    ds_read_b128 v[64:67], v18
    ds_read_b64_tr_b16 v[96:97], v20 offset:8192
    ds_read_b64_tr_b16 v[98:99], v20 offset:9216
    ds_read_b64_tr_b16 v[100:101], v21 offset:8192
    ds_read_b64_tr_b16 v[102:103], v21 offset:9216
    ds_read_b128 v[68:71], v18 offset:4096
    ds_read_b128 v[72:75], v18 offset:8192
    ds_read_b128 v[76:79], v18 offset:12288
    s_waitcnt lgkmcnt(15)
    s_waitcnt lgkmcnt(13)
    v_mfma_f32_32x32x16_bf16 v[128:143], v[80:83], v[104:107], v[128:143]
    s_waitcnt lgkmcnt(11)
    v_mfma_f32_32x32x16_bf16 v[144:159], v[80:83], v[108:111], v[144:159]
    s_waitcnt lgkmcnt(10)
    v_mfma_f32_32x32x16_bf16 v[160:175], v[84:87], v[104:107], v[160:175]
    v_mfma_f32_32x32x16_bf16 v[176:191], v[84:87], v[108:111], v[176:191]
    s_waitcnt lgkmcnt(9)
    v_mfma_f32_32x32x16_bf16 v[192:207], v[88:91], v[104:107], v[192:207]
    v_mfma_f32_32x32x16_bf16 v[208:223], v[88:91], v[108:111], v[208:223]
    s_waitcnt lgkmcnt(8)
    v_mfma_f32_32x32x16_bf16 v[224:239], v[92:95], v[104:107], v[224:239]
    v_mfma_f32_32x32x16_bf16 v[240:255], v[92:95], v[108:111], v[240:255]
    ds_read_b128 v[80:83], v19
    ds_read_b64_tr_b16 v[104:105], v20 offset:12288
    ds_read_b64_tr_b16 v[106:107], v20 offset:13312
    ds_read_b64_tr_b16 v[108:109], v21 offset:12288
    ds_read_b64_tr_b16 v[110:111], v21 offset:13312
    ds_read_b128 v[84:87], v19 offset:4096
    ds_read_b128 v[88:91], v19 offset:8192
    ds_read_b128 v[92:95], v19 offset:12288
    s_waitcnt lgkmcnt(15)
    s_waitcnt lgkmcnt(13)
    v_mfma_f32_32x32x16_bf16 v[128:143], v[64:67], v[96:99], v[128:143]
    s_waitcnt lgkmcnt(11)
    v_mfma_f32_32x32x16_bf16 v[144:159], v[64:67], v[100:103], v[144:159]
    s_waitcnt lgkmcnt(10)
    v_mfma_f32_32x32x16_bf16 v[160:175], v[68:71], v[96:99], v[160:175]
    v_mfma_f32_32x32x16_bf16 v[176:191], v[68:71], v[100:103], v[176:191]
    s_waitcnt lgkmcnt(9)
    v_mfma_f32_32x32x16_bf16 v[192:207], v[72:75], v[96:99], v[192:207]
    v_mfma_f32_32x32x16_bf16 v[208:223], v[72:75], v[100:103], v[208:223]
    s_waitcnt lgkmcnt(8)
    v_mfma_f32_32x32x16_bf16 v[224:239], v[76:79], v[96:99], v[224:239]
    v_mfma_f32_32x32x16_bf16 v[240:255], v[76:79], v[100:103], v[240:255]
    s_waitcnt lgkmcnt(0)
    s_waitcnt vmcnt(0)
    s_barrier
    v_xor_b32 v16, 0x10000, v16
    v_xor_b32 v17, 0x10000, v17
    v_xor_b32 v18, 0x10000, v18
    v_xor_b32 v19, 0x10000, v19
    v_xor_b32 v20, 0x10000, v20
    v_xor_b32 v21, 0x10000, v21
    ds_read_b128 v[64:67], v16
    ds_read_b64_tr_b16 v[96:97], v20 offset:0
    ds_read_b64_tr_b16 v[98:99], v20 offset:1024
    ds_read_b64_tr_b16 v[100:101], v21 offset:0
    ds_read_b64_tr_b16 v[102:103], v21 offset:1024
    ds_read_b128 v[68:71], v16 offset:4096
    ds_read_b128 v[72:75], v16 offset:8192
    ds_read_b128 v[76:79], v16 offset:12288
    v_mfma_f32_32x32x16_bf16 v[128:143], v[80:83], v[104:107], v[128:143]
    v_mfma_f32_32x32x16_bf16 v[144:159], v[80:83], v[108:111], v[144:159]
    s_mov_b32 m0, s62
    s_nop 0
    buffer_load_dwordx4 v8, s[32:35], s60 offen offset:0 lds
    v_mfma_f32_32x32x16_bf16 v[160:175], v[84:87], v[104:107], v[160:175]
    v_mfma_f32_32x32x16_bf16 v[176:191], v[84:87], v[108:111], v[176:191]
    buffer_load_dwordx4 v9, s[32:35], s60 offen offset:1024 lds
    v_mfma_f32_32x32x16_bf16 v[192:207], v[88:91], v[104:107], v[192:207]
    v_mfma_f32_32x32x16_bf16 v[208:223], v[88:91], v[108:111], v[208:223]
    buffer_load_dwordx4 v10, s[32:35], s60 offen offset:2048 lds
    v_mfma_f32_32x32x16_bf16 v[224:239], v[92:95], v[104:107], v[224:239]
    v_mfma_f32_32x32x16_bf16 v[240:255], v[92:95], v[108:111], v[240:255]
    buffer_load_dwordx4 v11, s[32:35], s60 offen offset:3072 lds
    ds_read_b128 v[80:83], v17
    ds_read_b64_tr_b16 v[104:105], v20 offset:4096
    ds_read_b64_tr_b16 v[106:107], v20 offset:5120
    ds_read_b64_tr_b16 v[108:109], v21 offset:4096
    ds_read_b64_tr_b16 v[110:111], v21 offset:5120
    ds_read_b128 v[84:87], v17 offset:4096
    ds_read_b128 v[88:91], v17 offset:8192
    ds_read_b128 v[92:95], v17 offset:12288
    s_waitcnt lgkmcnt(15)
    s_waitcnt lgkmcnt(13)
    v_mfma_f32_32x32x16_bf16 v[128:143], v[64:67], v[96:99], v[128:143]
    s_waitcnt lgkmcnt(11)
    v_mfma_f32_32x32x16_bf16 v[144:159], v[64:67], v[100:103], v[144:159]
    s_mov_b32 m0, s63
    s_add_u32 s74, s61, 0
    buffer_load_dwordx4 v12, s[40:43], s74 offen offset:0 lds
    s_waitcnt lgkmcnt(10)
    v_mfma_f32_32x32x16_bf16 v[160:175], v[68:71], v[96:99], v[160:175]
    v_mfma_f32_32x32x16_bf16 v[176:191], v[68:71], v[100:103], v[176:191]
    s_add_u32 s74, s61, 31744
    buffer_load_dwordx4 v12, s[40:43], s74 offen offset:1024 lds
    s_waitcnt lgkmcnt(9)
    v_mfma_f32_32x32x16_bf16 v[192:207], v[72:75], v[96:99], v[192:207]
    v_mfma_f32_32x32x16_bf16 v[208:223], v[72:75], v[100:103], v[208:223]
    s_add_u32 s74, s61, 63488
    buffer_load_dwordx4 v12, s[40:43], s74 offen offset:2048 lds
    s_waitcnt lgkmcnt(8)
    v_mfma_f32_32x32x16_bf16 v[224:239], v[76:79], v[96:99], v[224:239]
    v_mfma_f32_32x32x16_bf16 v[240:255], v[76:79], v[100:103], v[240:255]
    s_add_u32 s74, s61, 95232
    buffer_load_dwordx4 v12, s[40:43], s74 offen offset:3072 lds
    s_add_u32 s60, s60, 128
    s_add_u32 s61, s61, 524288
    s_xor_b32 s62, s62, 0x10000
    s_xor_b32 s63, s63, 0x10000
    ds_read_b128 v[64:67], v18
    ds_read_b64_tr_b16 v[96:97], v20 offset:8192
    ds_read_b64_tr_b16 v[98:99], v20 offset:9216
    ds_read_b64_tr_b16 v[100:101], v21 offset:8192
    ds_read_b64_tr_b16 v[102:103], v21 offset:9216
    ds_read_b128 v[68:71], v18 offset:4096
    ds_read_b128 v[72:75], v18 offset:8192
    ds_read_b128 v[76:79], v18 offset:12288
    s_waitcnt lgkmcnt(15)
    s_waitcnt lgkmcnt(13)
    v_mfma_f32_32x32x16_bf16 v[128:143], v[80:83], v[104:107], v[128:143]
    s_waitcnt lgkmcnt(11)
    v_mfma_f32_32x32x16_bf16 v[144:159], v[80:83], v[108:111], v[144:159]
    s_waitcnt lgkmcnt(10)
    v_mfma_f32_32x32x16_bf16 v[160:175], v[84:87], v[104:107], v[160:175]
    v_mfma_f32_32x32x16_bf16 v[176:191], v[84:87], v[108:111], v[176:191]
    s_waitcnt lgkmcnt(9)
    v_mfma_f32_32x32x16_bf16 v[192:207], v[88:91], v[104:107], v[192:207]
    v_mfma_f32_32x32x16_bf16 v[208:223], v[88:91], v[108:111], v[208:223]
    s_waitcnt lgkmcnt(8)
    v_mfma_f32_32x32x16_bf16 v[224:239], v[92:95], v[104:107], v[224:239]
    v_mfma_f32_32x32x16_bf16 v[240:255], v[92:95], v[108:111], v[240:255]
    ds_read_b128 v[80:83], v19
    ds_read_b64_tr_b16 v[104:105], v20 offset:12288
    ds_read_b64_tr_b16 v[106:107], v20 offset:13312
    ds_read_b64_tr_b16 v[108:109], v21 offset:12288
    ds_read_b64_tr_b16 v[110:111], v21 offset:13312
    ds_read_b128 v[84:87], v19 offset:4096
    ds_read_b128 v[88:91], v19 offset:8192
    ds_read_b128 v[92:95], v19 offset:12288
    s_waitcnt lgkmcnt(15)
    s_waitcnt lgkmcnt(13)
    v_mfma_f32_32x32x16_bf16 v[128:143], v[64:67], v[96:99], v[128:143]
    s_waitcnt lgkmcnt(11)
    v_mfma_f32_32x32x16_bf16 v[144:159], v[64:67], v[100:103], v[144:159]
    s_waitcnt lgkmcnt(10)
    v_mfma_f32_32x32x16_bf16 v[160:175], v[68:71], v[96:99], v[160:175]
    v_mfma_f32_32x32x16_bf16 v[176:191], v[68:71], v[100:103], v[176:191]
    s_waitcnt lgkmcnt(9)
    v_mfma_f32_32x32x16_bf16 v[192:207], v[72:75], v[96:99], v[192:207]
    v_mfma_f32_32x32x16_bf16 v[208:223], v[72:75], v[100:103], v[208:223]
    s_waitcnt lgkmcnt(8)
    v_mfma_f32_32x32x16_bf16 v[224:239], v[76:79], v[96:99], v[224:239]
    v_mfma_f32_32x32x16_bf16 v[240:255], v[76:79], v[100:103], v[240:255]
    s_waitcnt lgkmcnt(0)
    s_waitcnt vmcnt(0)
    s_barrier
    v_xor_b32 v16, 0x10000, v16
    v_xor_b32 v17, 0x10000, v17
    v_xor_b32 v18, 0x10000, v18
    v_xor_b32 v19, 0x10000, v19
    v_xor_b32 v20, 0x10000, v20
    v_xor_b32 v21, 0x10000, v21
    ds_read_b128 v[64:67], v16
    ds_read_b64_tr_b16 v[96:97], v20 offset:0
    ds_read_b64_tr_b16 v[98:99], v20 offset:1024
    ds_read_b64_tr_b16 v[100:101], v21 offset:0
    ds_read_b64_tr_b16 v[102:103], v21 offset:1024
    ds_read_b128 v[68:71], v16 offset:4096
    ds_read_b128 v[72:75], v16 offset:8192
    ds_read_b128 v[76:79], v16 offset:12288
    v_mfma_f32_32x32x16_bf16 v[128:143], v[80:83], v[104:107], v[128:143]
    v_mfma_f32_32x32x16_bf16 v[144:159], v[80:83], v[108:111], v[144:159]
    s_mov_b32 m0, s62
    s_nop 0
    buffer_load_dwordx4 v8, s[32:35], s60 offen offset:0 lds
    v_mfma_f32_32x32x16_bf16 v[160:175], v[84:87], v[104:107], v[160:175]
    v_mfma_f32_32x32x16_bf16 v[176:191], v[84:87], v[108:111], v[176:191]
    buffer_load_dwordx4 v9, s[32:35], s60 offen offset:1024 lds
    v_mfma_f32_32x32x16_bf16 v[192:207], v[88:91], v[104:107], v[192:207]
    v_mfma_f32_32x32x16_bf16 v[208:223], v[88:91], v[108:111], v[208:223]
    buffer_load_dwordx4 v10, s[32:35], s60 offen offset:2048 lds
    v_mfma_f32_32x32x16_bf16 v[224:239], v[92:95], v[104:107], v[224:239]
    v_mfma_f32_32x32x16_bf16 v[240:255], v[92:95], v[108:111], v[240:255]
    buffer_load_dwordx4 v11, s[32:35], s60 offen offset:3072 lds
    ds_read_b128 v[80:83], v17
    ds_read_b64_tr_b16 v[104:105], v20 offset:4096
    ds_read_b64_tr_b16 v[106:107], v20 offset:5120
    ds_read_b64_tr_b16 v[108:109], v21 offset:4096
    ds_read_b64_tr_b16 v[110:111], v21 offset:5120
    ds_read_b128 v[84:87], v17 offset:4096
    ds_read_b128 v[88:91], v17 offset:8192
    ds_read_b128 v[92:95], v17 offset:12288
    s_waitcnt lgkmcnt(15)
    s_waitcnt lgkmcnt(13)
    v_mfma_f32_32x32x16_bf16 v[128:143], v[64:67], v[96:99], v[128:143]
    s_waitcnt lgkmcnt(11)
    v_mfma_f32_32x32x16_bf16 v[144:159], v[64:67], v[100:103], v[144:159]
    s_mov_b32 m0, s63
    s_add_u32 s74, s61, 0
    buffer_load_dwordx4 v12, s[40:43], s74 offen offset:0 lds
    s_waitcnt lgkmcnt(10)
    v_mfma_f32_32x32x16_bf16 v[160:175], v[68:71], v[96:99], v[160:175]
    v_mfma_f32_32x32x16_bf16 v[176:191], v[68:71], v[100:103], v[176:191]
    s_add_u32 s74, s61, 31744
    buffer_load_dwordx4 v12, s[40:43], s74 offen offset:1024 lds
    s_waitcnt lgkmcnt(9)
    v_mfma_f32_32x32x16_bf16 v[192:207], v[72:75], v[96:99], v[192:207]
    v_mfma_f32_32x32x16_bf16 v[208:223], v[72:75], v[100:103], v[208:223]
    s_add_u32 s74, s61, 63488
    buffer_load_dwordx4 v12, s[40:43], s74 offen offset:2048 lds
    s_waitcnt lgkmcnt(8)
    v_mfma_f32_32x32x16_bf16 v[224:239], v[76:79], v[96:99], v[224:239]
    v_mfma_f32_32x32x16_bf16 v[240:255], v[76:79], v[100:103], v[240:255]
    s_add_u32 s74, s61, 95232
    buffer_load_dwordx4 v12, s[40:43], s74 offen offset:3072 lds
    s_add_u32 s60, s60, 128
    s_add_u32 s61, s61, 524288
    s_xor_b32 s62, s62, 0x10000
    s_xor_b32 s63, s63, 0x10000
    ds_read_b128 v[64:67], v18
    ds_read_b64_tr_b16 v[96:97], v20 offset:8192
    ds_read_b64_tr_b16 v[98:99], v20 offset:9216
    ds_read_b64_tr_b16 v[100:101], v21 offset:8192
    ds_read_b64_tr_b16 v[102:103], v21 offset:9216
    ds_read_b128 v[68:71], v18 offset:4096
    ds_read_b128 v[72:75], v18 offset:8192
    ds_read_b128 v[76:79], v18 offset:12288
    s_waitcnt lgkmcnt(15)
    s_waitcnt lgkmcnt(13)
    v_mfma_f32_32x32x16_bf16 v[128:143], v[80:83], v[104:107], v[128:143]
    s_waitcnt lgkmcnt(11)
    v_mfma_f32_32x32x16_bf16 v[144:159], v[80:83], v[108:111], v[144:159]
    s_waitcnt lgkmcnt(10)
    v_mfma_f32_32x32x16_bf16 v[160:175], v[84:87], v[104:107], v[160:175]
    v_mfma_f32_32x32x16_bf16 v[176:191], v[84:87], v[108:111], v[176:191]
    s_waitcnt lgkmcnt(9)
    v_mfma_f32_32x32x16_bf16 v[192:207], v[88:91], v[104:107], v[192:207]
    v_mfma_f32_32x32x16_bf16 v[208:223], v[88:91], v[108:111], v[208:223]
    s_waitcnt lgkmcnt(8)
    v_mfma_f32_32x32x16_bf16 v[224:239], v[92:95], v[104:107], v[224:239]
    v_mfma_f32_32x32x16_bf16 v[240:255], v[92:95], v[108:111], v[240:255]
    ds_read_b128 v[80:83], v19
    ds_read_b64_tr_b16 v[104:105], v20 offset:12288
    ds_read_b64_tr_b16 v[106:107], v20 offset:13312
    ds_read_b64_tr_b16 v[108:109], v21 offset:12288
    ds_read_b64_tr_b16 v[110:111], v21 offset:13312
    ds_read_b128 v[84:87], v19 offset:4096
    ds_read_b128 v[88:91], v19 offset:8192
    ds_read_b128 v[92:95], v19 offset:12288
    s_waitcnt lgkmcnt(15)
    s_waitcnt lgkmcnt(13)
    v_mfma_f32_32x32x16_bf16 v[128:143], v[64:67], v[96:99], v[128:143]
    s_waitcnt lgkmcnt(11)
    v_mfma_f32_32x32x16_bf16 v[144:159], v[64:67], v[100:103], v[144:159]
    s_waitcnt lgkmcnt(10)
    v_mfma_f32_32x32x16_bf16 v[160:175], v[68:71], v[96:99], v[160:175]
    v_mfma_f32_32x32x16_bf16 v[176:191], v[68:71], v[100:103], v[176:191]
    s_waitcnt lgkmcnt(9)
    v_mfma_f32_32x32x16_bf16 v[192:207], v[72:75], v[96:99], v[192:207]
    v_mfma_f32_32x32x16_bf16 v[208:223], v[72:75], v[100:103], v[208:223]
    s_waitcnt lgkmcnt(8)
    v_mfma_f32_32x32x16_bf16 v[224:239], v[76:79], v[96:99], v[224:239]
    v_mfma_f32_32x32x16_bf16 v[240:255], v[76:79], v[100:103], v[240:255]
    s_waitcnt lgkmcnt(0)
    s_waitcnt vmcnt(0)
    s_barrier
    v_xor_b32 v16, 0x10000, v16
    v_xor_b32 v17, 0x10000, v17
    v_xor_b32 v18, 0x10000, v18
    v_xor_b32 v19, 0x10000, v19
    v_xor_b32 v20, 0x10000, v20
    v_xor_b32 v21, 0x10000, v21
    ds_read_b128 v[64:67], v16
    ds_read_b64_tr_b16 v[96:97], v20 offset:0
    ds_read_b64_tr_b16 v[98:99], v20 offset:1024
    ds_read_b64_tr_b16 v[100:101], v21 offset:0
    ds_read_b64_tr_b16 v[102:103], v21 offset:1024
    ds_read_b128 v[68:71], v16 offset:4096
    ds_read_b128 v[72:75], v16 offset:8192
    ds_read_b128 v[76:79], v16 offset:12288
    v_mfma_f32_32x32x16_bf16 v[128:143], v[80:83], v[104:107], v[128:143]
    v_mfma_f32_32x32x16_bf16 v[144:159], v[80:83], v[108:111], v[144:159]
    s_mov_b32 m0, s62
    s_nop 0
    buffer_load_dwordx4 v8, s[32:35], s60 offen offset:0 lds
    v_mfma_f32_32x32x16_bf16 v[160:175], v[84:87], v[104:107], v[160:175]
    v_mfma_f32_32x32x16_bf16 v[176:191], v[84:87], v[108:111], v[176:191]
    buffer_load_dwordx4 v9, s[32:35], s60 offen offset:1024 lds
    v_mfma_f32_32x32x16_bf16 v[192:207], v[88:91], v[104:107], v[192:207]
    v_mfma_f32_32x32x16_bf16 v[208:223], v[88:91], v[108:111], v[208:223]
    buffer_load_dwordx4 v10, s[32:35], s60 offen offset:2048 lds
    v_mfma_f32_32x32x16_bf16 v[224:239], v[92:95], v[104:107], v[224:239]
    v_mfma_f32_32x32x16_bf16 v[240:255], v[92:95], v[108:111], v[240:255]
    buffer_load_dwordx4 v11, s[32:35], s60 offen offset:3072 lds
    ds_read_b128 v[80:83], v17
    ds_read_b64_tr_b16 v[104:105], v20 offset:4096
    ds_read_b64_tr_b16 v[106:107], v20 offset:5120
    ds_read_b64_tr_b16 v[108:109], v21 offset:4096
    ds_read_b64_tr_b16 v[110:111], v21 offset:5120
    ds_read_b128 v[84:87], v17 offset:4096
    ds_read_b128 v[88:91], v17 offset:8192
    ds_read_b128 v[92:95], v17 offset:12288
    s_waitcnt lgkmcnt(15)
    s_waitcnt lgkmcnt(13)
    v_mfma_f32_32x32x16_bf16 v[128:143], v[64:67], v[96:99], v[128:143]
    s_waitcnt lgkmcnt(11)
    v_mfma_f32_32x32x16_bf16 v[144:159], v[64:67], v[100:103], v[144:159]
    s_mov_b32 m0, s63
    s_add_u32 s74, s61, 0
    buffer_load_dwordx4 v12, s[40:43], s74 offen offset:0 lds
    s_waitcnt lgkmcnt(10)
    v_mfma_f32_32x32x16_bf16 v[160:175], v[68:71], v[96:99], v[160:175]
    v_mfma_f32_32x32x16_bf16 v[176:191], v[68:71], v[100:103], v[176:191]
    s_add_u32 s74, s61, 31744
    buffer_load_dwordx4 v12, s[40:43], s74 offen offset:1024 lds
    s_waitcnt lgkmcnt(9)
    v_mfma_f32_32x32x16_bf16 v[192:207], v[72:75], v[96:99], v[192:207]
    v_mfma_f32_32x32x16_bf16 v[208:223], v[72:75], v[100:103], v[208:223]
    s_add_u32 s74, s61, 63488
    buffer_load_dwordx4 v12, s[40:43], s74 offen offset:2048 lds
    s_waitcnt lgkmcnt(8)
    v_mfma_f32_32x32x16_bf16 v[224:239], v[76:79], v[96:99], v[224:239]
    v_mfma_f32_32x32x16_bf16 v[240:255], v[76:79], v[100:103], v[240:255]
    s_add_u32 s74, s61, 95232
    buffer_load_dwordx4 v12, s[40:43], s74 offen offset:3072 lds
    s_add_u32 s60, s60, 128
    s_add_u32 s61, s61, 524288
    s_xor_b32 s62, s62, 0x10000
    s_xor_b32 s63, s63, 0x10000
    ds_read_b128 v[64:67], v18
    ds_read_b64_tr_b16 v[96:97], v20 offset:8192
    ds_read_b64_tr_b16 v[98:99], v20 offset:9216
    ds_read_b64_tr_b16 v[100:101], v21 offset:8192
    ds_read_b64_tr_b16 v[102:103], v21 offset:9216
    ds_read_b128 v[68:71], v18 offset:4096
    ds_read_b128 v[72:75], v18 offset:8192
    ds_read_b128 v[76:79], v18 offset:12288
    s_waitcnt lgkmcnt(15)
    s_waitcnt lgkmcnt(13)
    v_mfma_f32_32x32x16_bf16 v[128:143], v[80:83], v[104:107], v[128:143]
    s_waitcnt lgkmcnt(11)
    v_mfma_f32_32x32x16_bf16 v[144:159], v[80:83], v[108:111], v[144:159]
    s_waitcnt lgkmcnt(10)
    v_mfma_f32_32x32x16_bf16 v[160:175], v[84:87], v[104:107], v[160:175]
    v_mfma_f32_32x32x16_bf16 v[176:191], v[84:87], v[108:111], v[176:191]
    s_waitcnt lgkmcnt(9)
    v_mfma_f32_32x32x16_bf16 v[192:207], v[88:91], v[104:107], v[192:207]
    v_mfma_f32_32x32x16_bf16 v[208:223], v[88:91], v[108:111], v[208:223]
    s_waitcnt lgkmcnt(8)
    v_mfma_f32_32x32x16_bf16 v[224:239], v[92:95], v[104:107], v[224:239]
    v_mfma_f32_32x32x16_bf16 v[240:255], v[92:95], v[108:111], v[240:255]
    ds_read_b128 v[80:83], v19
    ds_read_b64_tr_b16 v[104:105], v20 offset:12288
    ds_read_b64_tr_b16 v[106:107], v20 offset:13312
    ds_read_b64_tr_b16 v[108:109], v21 offset:12288
    ds_read_b64_tr_b16 v[110:111], v21 offset:13312
    ds_read_b128 v[84:87], v19 offset:4096
    ds_read_b128 v[88:91], v19 offset:8192
    ds_read_b128 v[92:95], v19 offset:12288
    s_waitcnt lgkmcnt(15)
    s_waitcnt lgkmcnt(13)
    v_mfma_f32_32x32x16_bf16 v[128:143], v[64:67], v[96:99], v[128:143]
    s_waitcnt lgkmcnt(11)
    v_mfma_f32_32x32x16_bf16 v[144:159], v[64:67], v[100:103], v[144:159]
    s_waitcnt lgkmcnt(10)
    v_mfma_f32_32x32x16_bf16 v[160:175], v[68:71], v[96:99], v[160:175]
    v_mfma_f32_32x32x16_bf16 v[176:191], v[68:71], v[100:103], v[176:191]
    s_waitcnt lgkmcnt(9)
    v_mfma_f32_32x32x16_bf16 v[192:207], v[72:75], v[96:99], v[192:207]
    v_mfma_f32_32x32x16_bf16 v[208:223], v[72:75], v[100:103], v[208:223]
    s_waitcnt lgkmcnt(8)
    v_mfma_f32_32x32x16_bf16 v[224:239], v[76:79], v[96:99], v[224:239]
    v_mfma_f32_32x32x16_bf16 v[240:255], v[76:79], v[100:103], v[240:255]
    s_waitcnt lgkmcnt(0)
    s_waitcnt vmcnt(0)
    s_barrier
    v_xor_b32 v16, 0x10000, v16
    v_xor_b32 v17, 0x10000, v17
    v_xor_b32 v18, 0x10000, v18
    v_xor_b32 v19, 0x10000, v19
    v_xor_b32 v20, 0x10000, v20
    v_xor_b32 v21, 0x10000, v21
    ds_read_b128 v[64:67], v16
    ds_read_b64_tr_b16 v[96:97], v20 offset:0
    ds_read_b64_tr_b16 v[98:99], v20 offset:1024
    ds_read_b64_tr_b16 v[100:101], v21 offset:0
    ds_read_b64_tr_b16 v[102:103], v21 offset:1024
    ds_read_b128 v[68:71], v16 offset:4096
    ds_read_b128 v[72:75], v16 offset:8192
    ds_read_b128 v[76:79], v16 offset:12288
    v_mfma_f32_32x32x16_bf16 v[128:143], v[80:83], v[104:107], v[128:143]
    v_mfma_f32_32x32x16_bf16 v[144:159], v[80:83], v[108:111], v[144:159]
    s_mov_b32 m0, s62
    s_nop 0
    buffer_load_dwordx4 v8, s[32:35], s60 offen offset:0 lds
    v_mfma_f32_32x32x16_bf16 v[160:175], v[84:87], v[104:107], v[160:175]
    v_mfma_f32_32x32x16_bf16 v[176:191], v[84:87], v[108:111], v[176:191]
    buffer_load_dwordx4 v9, s[32:35], s60 offen offset:1024 lds
    v_mfma_f32_32x32x16_bf16 v[192:207], v[88:91], v[104:107], v[192:207]
    v_mfma_f32_32x32x16_bf16 v[208:223], v[88:91], v[108:111], v[208:223]
    buffer_load_dwordx4 v10, s[32:35], s60 offen offset:2048 lds
    v_mfma_f32_32x32x16_bf16 v[224:239], v[92:95], v[104:107], v[224:239]
    v_mfma_f32_32x32x16_bf16 v[240:255], v[92:95], v[108:111], v[240:255]
    buffer_load_dwordx4 v11, s[32:35], s60 offen offset:3072 lds
    ds_read_b128 v[80:83], v17
    ds_read_b64_tr_b16 v[104:105], v20 offset:4096
    ds_read_b64_tr_b16 v[106:107], v20 offset:5120
    ds_read_b64_tr_b16 v[108:109], v21 offset:4096
    ds_read_b64_tr_b16 v[110:111], v21 offset:5120
    ds_read_b128 v[84:87], v17 offset:4096
    ds_read_b128 v[88:91], v17 offset:8192
    ds_read_b128 v[92:95], v17 offset:12288
    s_waitcnt lgkmcnt(15)
    s_waitcnt lgkmcnt(13)
    v_mfma_f32_32x32x16_bf16 v[128:143], v[64:67], v[96:99], v[128:143]
    s_waitcnt lgkmcnt(11)
    v_mfma_f32_32x32x16_bf16 v[144:159], v[64:67], v[100:103], v[144:159]
    s_mov_b32 m0, s63
    s_add_u32 s74, s61, 0
    buffer_load_dwordx4 v12, s[40:43], s74 offen offset:0 lds
    s_waitcnt lgkmcnt(10)
    v_mfma_f32_32x32x16_bf16 v[160:175], v[68:71], v[96:99], v[160:175]
    v_mfma_f32_32x32x16_bf16 v[176:191], v[68:71], v[100:103], v[176:191]
    s_add_u32 s74, s61, 31744
    buffer_load_dwordx4 v12, s[40:43], s74 offen offset:1024 lds
    s_waitcnt lgkmcnt(9)
    v_mfma_f32_32x32x16_bf16 v[192:207], v[72:75], v[96:99], v[192:207]
    v_mfma_f32_32x32x16_bf16 v[208:223], v[72:75], v[100:103], v[208:223]
    s_add_u32 s74, s61, 63488
    buffer_load_dwordx4 v12, s[40:43], s74 offen offset:2048 lds
    s_waitcnt lgkmcnt(8)
    v_mfma_f32_32x32x16_bf16 v[224:239], v[76:79], v[96:99], v[224:239]
    v_mfma_f32_32x32x16_bf16 v[240:255], v[76:79], v[100:103], v[240:255]
    s_add_u32 s74, s61, 95232
    buffer_load_dwordx4 v12, s[40:43], s74 offen offset:3072 lds
    s_add_u32 s60, s60, 128
    s_add_u32 s61, s61, 524288
    s_xor_b32 s62, s62, 0x10000
    s_xor_b32 s63, s63, 0x10000
    ds_read_b128 v[64:67], v18
    ds_read_b64_tr_b16 v[96:97], v20 offset:8192
    ds_read_b64_tr_b16 v[98:99], v20 offset:9216
    ds_read_b64_tr_b16 v[100:101], v21 offset:8192
    ds_read_b64_tr_b16 v[102:103], v21 offset:9216
    ds_read_b128 v[68:71], v18 offset:4096
    ds_read_b128 v[72:75], v18 offset:8192
    ds_read_b128 v[76:79], v18 offset:12288
    s_waitcnt lgkmcnt(15)
    s_waitcnt lgkmcnt(13)
    v_mfma_f32_32x32x16_bf16 v[128:143], v[80:83], v[104:107], v[128:143]
    s_waitcnt lgkmcnt(11)
    v_mfma_f32_32x32x16_bf16 v[144:159], v[80:83], v[108:111], v[144:159]
    s_waitcnt lgkmcnt(10)
    v_mfma_f32_32x32x16_bf16 v[160:175], v[84:87], v[104:107], v[160:175]
    v_mfma_f32_32x32x16_bf16 v[176:191], v[84:87], v[108:111], v[176:191]
    s_waitcnt lgkmcnt(9)
    v_mfma_f32_32x32x16_bf16 v[192:207], v[88:91], v[104:107], v[192:207]
    v_mfma_f32_32x32x16_bf16 v[208:223], v[88:91], v[108:111], v[208:223]
    s_waitcnt lgkmcnt(8)
    v_mfma_f32_32x32x16_bf16 v[224:239], v[92:95], v[104:107], v[224:239]
    v_mfma_f32_32x32x16_bf16 v[240:255], v[92:95], v[108:111], v[240:255]
    ds_read_b128 v[80:83], v19
    ds_read_b64_tr_b16 v[104:105], v20 offset:12288
    ds_read_b64_tr_b16 v[106:107], v20 offset:13312
    ds_read_b64_tr_b16 v[108:109], v21 offset:12288
    ds_read_b64_tr_b16 v[110:111], v21 offset:13312
    ds_read_b128 v[84:87], v19 offset:4096
    ds_read_b128 v[88:91], v19 offset:8192
    ds_read_b128 v[92:95], v19 offset:12288
    s_waitcnt lgkmcnt(15)
    s_waitcnt lgkmcnt(13)
    v_mfma_f32_32x32x16_bf16 v[128:143], v[64:67], v[96:99], v[128:143]
    s_waitcnt lgkmcnt(11)
    v_mfma_f32_32x32x16_bf16 v[144:159], v[64:67], v[100:103], v[144:159]
    s_waitcnt lgkmcnt(10)
    v_mfma_f32_32x32x16_bf16 v[160:175], v[68:71], v[96:99], v[160:175]
    v_mfma_f32_32x32x16_bf16 v[176:191], v[68:71], v[100:103], v[176:191]
    s_waitcnt lgkmcnt(9)
    v_mfma_f32_32x32x16_bf16 v[192:207], v[72:75], v[96:99], v[192:207]
    v_mfma_f32_32x32x16_bf16 v[208:223], v[72:75], v[100:103], v[208:223]
    s_waitcnt lgkmcnt(8)
    v_mfma_f32_32x32x16_bf16 v[224:239], v[76:79], v[96:99], v[224:239]
    v_mfma_f32_32x32x16_bf16 v[240:255], v[76:79], v[100:103], v[240:255]
    s_waitcnt lgkmcnt(0)
    s_waitcnt vmcnt(0)
    s_barrier
    v_xor_b32 v16, 0x10000, v16
    v_xor_b32 v17, 0x10000, v17
    v_xor_b32 v18, 0x10000, v18
    v_xor_b32 v19, 0x10000, v19
    v_xor_b32 v20, 0x10000, v20
    v_xor_b32 v21, 0x10000, v21
    ds_read_b128 v[64:67], v16
    ds_read_b64_tr_b16 v[96:97], v20 offset:0
    ds_read_b64_tr_b16 v[98:99], v20 offset:1024
    ds_read_b64_tr_b16 v[100:101], v21 offset:0
    ds_read_b64_tr_b16 v[102:103], v21 offset:1024
    ds_read_b128 v[68:71], v16 offset:4096
    ds_read_b128 v[72:75], v16 offset:8192
    ds_read_b128 v[76:79], v16 offset:12288
    v_mfma_f32_32x32x16_bf16 v[128:143], v[80:83], v[104:107], v[128:143]
    v_mfma_f32_32x32x16_bf16 v[144:159], v[80:83], v[108:111], v[144:159]
    s_mov_b32 m0, s62
    s_nop 0
    buffer_load_dwordx4 v8, s[32:35], s60 offen offset:0 lds
    v_mfma_f32_32x32x16_bf16 v[160:175], v[84:87], v[104:107], v[160:175]
    v_mfma_f32_32x32x16_bf16 v[176:191], v[84:87], v[108:111], v[176:191]
    buffer_load_dwordx4 v9, s[32:35], s60 offen offset:1024 lds
    v_mfma_f32_32x32x16_bf16 v[192:207], v[88:91], v[104:107], v[192:207]
    v_mfma_f32_32x32x16_bf16 v[208:223], v[88:91], v[108:111], v[208:223]
    buffer_load_dwordx4 v10, s[32:35], s60 offen offset:2048 lds
    v_mfma_f32_32x32x16_bf16 v[224:239], v[92:95], v[104:107], v[224:239]
    v_mfma_f32_32x32x16_bf16 v[240:255], v[92:95], v[108:111], v[240:255]
    buffer_load_dwordx4 v11, s[32:35], s60 offen offset:3072 lds
    ds_read_b128 v[80:83], v17
    ds_read_b64_tr_b16 v[104:105], v20 offset:4096
    ds_read_b64_tr_b16 v[106:107], v20 offset:5120
    ds_read_b64_tr_b16 v[108:109], v21 offset:4096
    ds_read_b64_tr_b16 v[110:111], v21 offset:5120
    ds_read_b128 v[84:87], v17 offset:4096
    ds_read_b128 v[88:91], v17 offset:8192
    ds_read_b128 v[92:95], v17 offset:12288
    s_waitcnt lgkmcnt(15)
    s_waitcnt lgkmcnt(13)
    v_mfma_f32_32x32x16_bf16 v[128:143], v[64:67], v[96:99], v[128:143]
    s_waitcnt lgkmcnt(11)
    v_mfma_f32_32x32x16_bf16 v[144:159], v[64:67], v[100:103], v[144:159]
    s_mov_b32 m0, s63
    s_add_u32 s74, s61, 0
    buffer_load_dwordx4 v12, s[40:43], s74 offen offset:0 lds
    s_waitcnt lgkmcnt(10)
    v_mfma_f32_32x32x16_bf16 v[160:175], v[68:71], v[96:99], v[160:175]
    v_mfma_f32_32x32x16_bf16 v[176:191], v[68:71], v[100:103], v[176:191]
    s_add_u32 s74, s61, 31744
    buffer_load_dwordx4 v12, s[40:43], s74 offen offset:1024 lds
    s_waitcnt lgkmcnt(9)
    v_mfma_f32_32x32x16_bf16 v[192:207], v[72:75], v[96:99], v[192:207]
    v_mfma_f32_32x32x16_bf16 v[208:223], v[72:75], v[100:103], v[208:223]
    s_add_u32 s74, s61, 63488
    buffer_load_dwordx4 v12, s[40:43], s74 offen offset:2048 lds
    s_waitcnt lgkmcnt(8)
    v_mfma_f32_32x32x16_bf16 v[224:239], v[76:79], v[96:99], v[224:239]
    v_mfma_f32_32x32x16_bf16 v[240:255], v[76:79], v[100:103], v[240:255]
    s_add_u32 s74, s61, 95232
    buffer_load_dwordx4 v12, s[40:43], s74 offen offset:3072 lds
    s_add_u32 s60, s60, 128
    s_add_u32 s61, s61, 524288
    s_xor_b32 s62, s62, 0x10000
    s_xor_b32 s63, s63, 0x10000
    ds_read_b128 v[64:67], v18
    ds_read_b64_tr_b16 v[96:97], v20 offset:8192
    ds_read_b64_tr_b16 v[98:99], v20 offset:9216
    ds_read_b64_tr_b16 v[100:101], v21 offset:8192
    ds_read_b64_tr_b16 v[102:103], v21 offset:9216
    ds_read_b128 v[68:71], v18 offset:4096
    ds_read_b128 v[72:75], v18 offset:8192
    ds_read_b128 v[76:79], v18 offset:12288
    s_waitcnt lgkmcnt(15)
    s_waitcnt lgkmcnt(13)
    v_mfma_f32_32x32x16_bf16 v[128:143], v[80:83], v[104:107], v[128:143]
    s_waitcnt lgkmcnt(11)
    v_mfma_f32_32x32x16_bf16 v[144:159], v[80:83], v[108:111], v[144:159]
    s_waitcnt lgkmcnt(10)
    v_mfma_f32_32x32x16_bf16 v[160:175], v[84:87], v[104:107], v[160:175]
    v_mfma_f32_32x32x16_bf16 v[176:191], v[84:87], v[108:111], v[176:191]
    s_waitcnt lgkmcnt(9)
    v_mfma_f32_32x32x16_bf16 v[192:207], v[88:91], v[104:107], v[192:207]
    v_mfma_f32_32x32x16_bf16 v[208:223], v[88:91], v[108:111], v[208:223]
    s_waitcnt lgkmcnt(8)
    v_mfma_f32_32x32x16_bf16 v[224:239], v[92:95], v[104:107], v[224:239]
    v_mfma_f32_32x32x16_bf16 v[240:255], v[92:95], v[108:111], v[240:255]
    ds_read_b128 v[80:83], v19
    ds_read_b64_tr_b16 v[104:105], v20 offset:12288
    ds_read_b64_tr_b16 v[106:107], v20 offset:13312
    ds_read_b64_tr_b16 v[108:109], v21 offset:12288
    ds_read_b64_tr_b16 v[110:111], v21 offset:13312
    ds_read_b128 v[84:87], v19 offset:4096
    ds_read_b128 v[88:91], v19 offset:8192
    ds_read_b128 v[92:95], v19 offset:12288
    s_waitcnt lgkmcnt(15)
    s_waitcnt lgkmcnt(13)
    v_mfma_f32_32x32x16_bf16 v[128:143], v[64:67], v[96:99], v[128:143]
    s_waitcnt lgkmcnt(11)
    v_mfma_f32_32x32x16_bf16 v[144:159], v[64:67], v[100:103], v[144:159]
    s_waitcnt lgkmcnt(10)
    v_mfma_f32_32x32x16_bf16 v[160:175], v[68:71], v[96:99], v[160:175]
    v_mfma_f32_32x32x16_bf16 v[176:191], v[68:71], v[100:103], v[176:191]
    s_waitcnt lgkmcnt(9)
    v_mfma_f32_32x32x16_bf16 v[192:207], v[72:75], v[96:99], v[192:207]
    v_mfma_f32_32x32x16_bf16 v[208:223], v[72:75], v[100:103], v[208:223]
    s_waitcnt lgkmcnt(8)
    v_mfma_f32_32x32x16_bf16 v[224:239], v[76:79], v[96:99], v[224:239]
    v_mfma_f32_32x32x16_bf16 v[240:255], v[76:79], v[100:103], v[240:255]
    s_waitcnt lgkmcnt(0)
    s_waitcnt vmcnt(0)
    s_barrier
    v_xor_b32 v16, 0x10000, v16
    v_xor_b32 v17, 0x10000, v17
    v_xor_b32 v18, 0x10000, v18
    v_xor_b32 v19, 0x10000, v19
    v_xor_b32 v20, 0x10000, v20
    v_xor_b32 v21, 0x10000, v21
    ds_read_b128 v[64:67], v16
    ds_read_b64_tr_b16 v[96:97], v20 offset:0
    ds_read_b64_tr_b16 v[98:99], v20 offset:1024
    ds_read_b64_tr_b16 v[100:101], v21 offset:0
    ds_read_b64_tr_b16 v[102:103], v21 offset:1024
    ds_read_b128 v[68:71], v16 offset:4096
    ds_read_b128 v[72:75], v16 offset:8192
    ds_read_b128 v[76:79], v16 offset:12288
    v_mfma_f32_32x32x16_bf16 v[128:143], v[80:83], v[104:107], v[128:143]
    v_mfma_f32_32x32x16_bf16 v[144:159], v[80:83], v[108:111], v[144:159]
    s_mov_b32 m0, s62
    s_nop 0
    buffer_load_dwordx4 v8, s[32:35], s60 offen offset:0 lds
    v_mfma_f32_32x32x16_bf16 v[160:175], v[84:87], v[104:107], v[160:175]
    v_mfma_f32_32x32x16_bf16 v[176:191], v[84:87], v[108:111], v[176:191]
    buffer_load_dwordx4 v9, s[32:35], s60 offen offset:1024 lds
    v_mfma_f32_32x32x16_bf16 v[192:207], v[88:91], v[104:107], v[192:207]
    v_mfma_f32_32x32x16_bf16 v[208:223], v[88:91], v[108:111], v[208:223]
    buffer_load_dwordx4 v10, s[32:35], s60 offen offset:2048 lds
    v_mfma_f32_32x32x16_bf16 v[224:239], v[92:95], v[104:107], v[224:239]
    v_mfma_f32_32x32x16_bf16 v[240:255], v[92:95], v[108:111], v[240:255]
    buffer_load_dwordx4 v11, s[32:35], s60 offen offset:3072 lds
    ds_read_b128 v[80:83], v17
    ds_read_b64_tr_b16 v[104:105], v20 offset:4096
    ds_read_b64_tr_b16 v[106:107], v20 offset:5120
    ds_read_b64_tr_b16 v[108:109], v21 offset:4096
    ds_read_b64_tr_b16 v[110:111], v21 offset:5120
    ds_read_b128 v[84:87], v17 offset:4096
    ds_read_b128 v[88:91], v17 offset:8192
    ds_read_b128 v[92:95], v17 offset:12288
    s_waitcnt lgkmcnt(15)
    s_waitcnt lgkmcnt(13)
    v_mfma_f32_32x32x16_bf16 v[128:143], v[64:67], v[96:99], v[128:143]
    s_waitcnt lgkmcnt(11)
    v_mfma_f32_32x32x16_bf16 v[144:159], v[64:67], v[100:103], v[144:159]
    s_mov_b32 m0, s63
    s_add_u32 s74, s61, 0
    buffer_load_dwordx4 v12, s[40:43], s74 offen offset:0 lds
    s_waitcnt lgkmcnt(10)
    v_mfma_f32_32x32x16_bf16 v[160:175], v[68:71], v[96:99], v[160:175]
    v_mfma_f32_32x32x16_bf16 v[176:191], v[68:71], v[100:103], v[176:191]
    s_add_u32 s74, s61, 31744
    buffer_load_dwordx4 v12, s[40:43], s74 offen offset:1024 lds
    s_waitcnt lgkmcnt(9)
    v_mfma_f32_32x32x16_bf16 v[192:207], v[72:75], v[96:99], v[192:207]
    v_mfma_f32_32x32x16_bf16 v[208:223], v[72:75], v[100:103], v[208:223]
    s_add_u32 s74, s61, 63488
    buffer_load_dwordx4 v12, s[40:43], s74 offen offset:2048 lds
    s_waitcnt lgkmcnt(8)
    v_mfma_f32_32x32x16_bf16 v[224:239], v[76:79], v[96:99], v[224:239]
    v_mfma_f32_32x32x16_bf16 v[240:255], v[76:79], v[100:103], v[240:255]
    s_add_u32 s74, s61, 95232
    buffer_load_dwordx4 v12, s[40:43], s74 offen offset:3072 lds
    s_add_u32 s60, s60, 128
    s_add_u32 s61, s61, 524288
    s_xor_b32 s62, s62, 0x10000
    s_xor_b32 s63, s63, 0x10000
    ds_read_b128 v[64:67], v18
    ds_read_b64_tr_b16 v[96:97], v20 offset:8192
    ds_read_b64_tr_b16 v[98:99], v20 offset:9216
    ds_read_b64_tr_b16 v[100:101], v21 offset:8192
    ds_read_b64_tr_b16 v[102:103], v21 offset:9216
    ds_read_b128 v[68:71], v18 offset:4096
    ds_read_b128 v[72:75], v18 offset:8192
    ds_read_b128 v[76:79], v18 offset:12288
    s_waitcnt lgkmcnt(15)
    s_waitcnt lgkmcnt(13)
    v_mfma_f32_32x32x16_bf16 v[128:143], v[80:83], v[104:107], v[128:143]
    s_waitcnt lgkmcnt(11)
    v_mfma_f32_32x32x16_bf16 v[144:159], v[80:83], v[108:111], v[144:159]
    s_waitcnt lgkmcnt(10)
    v_mfma_f32_32x32x16_bf16 v[160:175], v[84:87], v[104:107], v[160:175]
    v_mfma_f32_32x32x16_bf16 v[176:191], v[84:87], v[108:111], v[176:191]
    s_waitcnt lgkmcnt(9)
    v_mfma_f32_32x32x16_bf16 v[192:207], v[88:91], v[104:107], v[192:207]
    v_mfma_f32_32x32x16_bf16 v[208:223], v[88:91], v[108:111], v[208:223]
    s_waitcnt lgkmcnt(8)
    v_mfma_f32_32x32x16_bf16 v[224:239], v[92:95], v[104:107], v[224:239]
    v_mfma_f32_32x32x16_bf16 v[240:255], v[92:95], v[108:111], v[240:255]
    ds_read_b128 v[80:83], v19
    ds_read_b64_tr_b16 v[104:105], v20 offset:12288
    ds_read_b64_tr_b16 v[106:107], v20 offset:13312
    ds_read_b64_tr_b16 v[108:109], v21 offset:12288
    ds_read_b64_tr_b16 v[110:111], v21 offset:13312
    ds_read_b128 v[84:87], v19 offset:4096
    ds_read_b128 v[88:91], v19 offset:8192
    ds_read_b128 v[92:95], v19 offset:12288
    s_waitcnt lgkmcnt(15)
    s_waitcnt lgkmcnt(13)
    v_mfma_f32_32x32x16_bf16 v[128:143], v[64:67], v[96:99], v[128:143]
    s_waitcnt lgkmcnt(11)
    v_mfma_f32_32x32x16_bf16 v[144:159], v[64:67], v[100:103], v[144:159]
    s_waitcnt lgkmcnt(10)
    v_mfma_f32_32x32x16_bf16 v[160:175], v[68:71], v[96:99], v[160:175]
    v_mfma_f32_32x32x16_bf16 v[176:191], v[68:71], v[100:103], v[176:191]
    s_waitcnt lgkmcnt(9)
    v_mfma_f32_32x32x16_bf16 v[192:207], v[72:75], v[96:99], v[192:207]
    v_mfma_f32_32x32x16_bf16 v[208:223], v[72:75], v[100:103], v[208:223]
    s_waitcnt lgkmcnt(8)
    v_mfma_f32_32x32x16_bf16 v[224:239], v[76:79], v[96:99], v[224:239]
    v_mfma_f32_32x32x16_bf16 v[240:255], v[76:79], v[100:103], v[240:255]
    s_waitcnt lgkmcnt(0)
    s_waitcnt vmcnt(0)
    s_barrier
    s_mov_b32 s28, s18
    s_mov_b32 s29, s19
    s_mov_b32 s30, 0x400000
    s_mov_b32 s31, 0x00020000
    v_lshrrev_b32 v32, 2, v1
    v_xor_b32 v32, v32, v5
    v_and_b32 v32, 1, v32
    v_lshlrev_b32 v32, 6, v32
    v_lshrrev_b32 v33, 3, v1
    v_lshl_add_u32 v32, v33, 10, v32
    v_and_b32 v33, 3, v1
    v_lshl_add_u32 v32, v33, 4, v32
    v_add_u32 v33, 7168, v32
    s_lshl_b32 s65, s3, 11
    s_add_u32 s65, s65, 49152
    s_mov_b32 m0, s65
    s_lshl_b32 s66, s2, 14
    s_lshl_b32 s65, s3, 7
    s_add_u32 s66, s66, s65
    buffer_load_dwordx4 v32, s[28:31], s66 offen lds
    buffer_load_dwordx4 v33, s[28:31], s66 offen offset:1024 lds
    v_xor_b32 v16, 0x10000, v16
    v_xor_b32 v17, 0x10000, v17
    v_xor_b32 v18, 0x10000, v18
    v_xor_b32 v19, 0x10000, v19
    v_xor_b32 v20, 0x10000, v20
    v_xor_b32 v21, 0x10000, v21
    ds_read_b128 v[64:67], v16
    ds_read_b64_tr_b16 v[96:97], v20 offset:0
    ds_read_b64_tr_b16 v[98:99], v20 offset:1024
    ds_read_b64_tr_b16 v[100:101], v21 offset:0
    ds_read_b64_tr_b16 v[102:103], v21 offset:1024
    ds_read_b128 v[68:71], v16 offset:4096
    ds_read_b128 v[72:75], v16 offset:8192
    ds_read_b128 v[76:79], v16 offset:12288
    v_mfma_f32_32x32x16_bf16 v[128:143], v[80:83], v[104:107], v[128:143]
    v_mfma_f32_32x32x16_bf16 v[144:159], v[80:83], v[108:111], v[144:159]
    s_lshl_b32 s74, s3, 11
    s_add_u32 s74, s74, 0
    s_mov_b32 m0, s74
    s_add_u32 s74, s69, 128
    buffer_load_dwordx4 v8, s[48:51], s74 offen offset:0 lds
    v_mfma_f32_32x32x16_bf16 v[160:175], v[84:87], v[104:107], v[160:175]
    v_mfma_f32_32x32x16_bf16 v[176:191], v[84:87], v[108:111], v[176:191]
    s_add_u32 s74, s69, 128
    buffer_load_dwordx4 v9, s[48:51], s74 offen offset:1024 lds
    v_mfma_f32_32x32x16_bf16 v[192:207], v[88:91], v[104:107], v[192:207]
    v_mfma_f32_32x32x16_bf16 v[208:223], v[88:91], v[108:111], v[208:223]
    s_lshl_b32 s74, s3, 10
    s_add_u32 s74, s74, 16384
    s_mov_b32 m0, s74
    s_add_u32 s74, s70, 128
    buffer_load_dwordx4 v13, s[52:55], s74 offen lds
    v_mfma_f32_32x32x16_bf16 v[224:239], v[92:95], v[104:107], v[224:239]
    v_mfma_f32_32x32x16_bf16 v[240:255], v[92:95], v[108:111], v[240:255]
    s_lshl_b32 s74, s3, 11
    s_add_u32 s74, s74, 24576
    s_mov_b32 m0, s74
    s_add_u32 s74, s69, 256
    buffer_load_dwordx4 v8, s[48:51], s74 offen offset:0 lds
    ds_read_b128 v[80:83], v17
    ds_read_b64_tr_b16 v[104:105], v20 offset:4096
    ds_read_b64_tr_b16 v[106:107], v20 offset:5120
    ds_read_b64_tr_b16 v[108:109], v21 offset:4096
    ds_read_b64_tr_b16 v[110:111], v21 offset:5120
    ds_read_b128 v[84:87], v17 offset:4096
    ds_read_b128 v[88:91], v17 offset:8192
    ds_read_b128 v[92:95], v17 offset:12288
    s_waitcnt lgkmcnt(15)
    s_waitcnt lgkmcnt(13)
    v_mfma_f32_32x32x16_bf16 v[128:143], v[64:67], v[96:99], v[128:143]
    s_waitcnt lgkmcnt(11)
    v_mfma_f32_32x32x16_bf16 v[144:159], v[64:67], v[100:103], v[144:159]
    s_add_u32 s74, s69, 256
    buffer_load_dwordx4 v9, s[48:51], s74 offen offset:1024 lds
    s_waitcnt lgkmcnt(10)
    v_mfma_f32_32x32x16_bf16 v[160:175], v[68:71], v[96:99], v[160:175]
    v_mfma_f32_32x32x16_bf16 v[176:191], v[68:71], v[100:103], v[176:191]
    s_lshl_b32 s74, s3, 10
    s_add_u32 s74, s74, 40960
    s_mov_b32 m0, s74
    s_add_u32 s74, s70, 256
    buffer_load_dwordx4 v13, s[52:55], s74 offen lds
    s_waitcnt lgkmcnt(9)
    v_mfma_f32_32x32x16_bf16 v[192:207], v[72:75], v[96:99], v[192:207]
    v_mfma_f32_32x32x16_bf16 v[208:223], v[72:75], v[100:103], v[208:223]
    s_waitcnt lgkmcnt(8)
    v_mfma_f32_32x32x16_bf16 v[224:239], v[76:79], v[96:99], v[224:239]
    v_mfma_f32_32x32x16_bf16 v[240:255], v[76:79], v[100:103], v[240:255]
    ds_read_b128 v[64:67], v18
    ds_read_b64_tr_b16 v[96:97], v20 offset:8192
    ds_read_b64_tr_b16 v[98:99], v20 offset:9216
    ds_read_b64_tr_b16 v[100:101], v21 offset:8192
    ds_read_b64_tr_b16 v[102:103], v21 offset:9216
    ds_read_b128 v[68:71], v18 offset:4096
    ds_read_b128 v[72:75], v18 offset:8192
    ds_read_b128 v[76:79], v18 offset:12288
    s_waitcnt lgkmcnt(15)
    s_waitcnt lgkmcnt(13)
    v_mfma_f32_32x32x16_bf16 v[128:143], v[80:83], v[104:107], v[128:143]
    s_waitcnt lgkmcnt(11)
    v_mfma_f32_32x32x16_bf16 v[144:159], v[80:83], v[108:111], v[144:159]
    s_waitcnt lgkmcnt(10)
    v_mfma_f32_32x32x16_bf16 v[160:175], v[84:87], v[104:107], v[160:175]
    v_mfma_f32_32x32x16_bf16 v[176:191], v[84:87], v[108:111], v[176:191]
    s_waitcnt lgkmcnt(9)
    v_mfma_f32_32x32x16_bf16 v[192:207], v[88:91], v[104:107], v[192:207]
    v_mfma_f32_32x32x16_bf16 v[208:223], v[88:91], v[108:111], v[208:223]
    s_waitcnt lgkmcnt(8)
    v_mfma_f32_32x32x16_bf16 v[224:239], v[92:95], v[104:107], v[224:239]
    v_mfma_f32_32x32x16_bf16 v[240:255], v[92:95], v[108:111], v[240:255]
    ds_read_b128 v[80:83], v19
    ds_read_b64_tr_b16 v[104:105], v20 offset:12288
    ds_read_b64_tr_b16 v[106:107], v20 offset:13312
    ds_read_b64_tr_b16 v[108:109], v21 offset:12288
    ds_read_b64_tr_b16 v[110:111], v21 offset:13312
    ds_read_b128 v[84:87], v19 offset:4096
    ds_read_b128 v[88:91], v19 offset:8192
    ds_read_b128 v[92:95], v19 offset:12288
    s_waitcnt lgkmcnt(15)
    s_waitcnt lgkmcnt(13)
    v_mfma_f32_32x32x16_bf16 v[128:143], v[64:67], v[96:99], v[128:143]
    s_waitcnt lgkmcnt(11)
    v_mfma_f32_32x32x16_bf16 v[144:159], v[64:67], v[100:103], v[144:159]
    s_waitcnt lgkmcnt(10)
    v_mfma_f32_32x32x16_bf16 v[160:175], v[68:71], v[96:99], v[160:175]
    v_mfma_f32_32x32x16_bf16 v[176:191], v[68:71], v[100:103], v[176:191]
    s_waitcnt lgkmcnt(9)
    v_mfma_f32_32x32x16_bf16 v[192:207], v[72:75], v[96:99], v[192:207]
    v_mfma_f32_32x32x16_bf16 v[208:223], v[72:75], v[100:103], v[208:223]
    s_waitcnt lgkmcnt(8)
    v_mfma_f32_32x32x16_bf16 v[224:239], v[76:79], v[96:99], v[224:239]
    v_mfma_f32_32x32x16_bf16 v[240:255], v[76:79], v[100:103], v[240:255]
    s_waitcnt lgkmcnt(0)
    s_waitcnt vmcnt(0)
    s_barrier
    v_mfma_f32_32x32x16_bf16 v[128:143], v[80:83], v[104:107], v[128:143]
    v_mfma_f32_32x32x16_bf16 v[144:159], v[80:83], v[108:111], v[144:159]
    s_lshl_b32 s74, s3, 11
    s_add_u32 s74, s74, 65536
    s_mov_b32 m0, s74
    s_add_u32 s74, s69, 384
    buffer_load_dwordx4 v8, s[48:51], s74 offen offset:0 lds
    v_mfma_f32_32x32x16_bf16 v[160:175], v[84:87], v[104:107], v[160:175]
    v_mfma_f32_32x32x16_bf16 v[176:191], v[84:87], v[108:111], v[176:191]
    s_add_u32 s74, s69, 384
    buffer_load_dwordx4 v9, s[48:51], s74 offen offset:1024 lds
    v_mfma_f32_32x32x16_bf16 v[192:207], v[88:91], v[104:107], v[192:207]
    v_mfma_f32_32x32x16_bf16 v[208:223], v[88:91], v[108:111], v[208:223]
    s_lshl_b32 s74, s3, 10
    s_add_u32 s74, s74, 81920
    s_mov_b32 m0, s74
    s_add_u32 s74, s70, 384
    buffer_load_dwordx4 v13, s[52:55], s74 offen lds
    v_mfma_f32_32x32x16_bf16 v[224:239], v[92:95], v[104:107], v[224:239]
    v_mfma_f32_32x32x16_bf16 v[240:255], v[92:95], v[108:111], v[240:255]
    s_lshl_b32 s74, s3, 11
    s_add_u32 s74, s74, 90112
    s_mov_b32 m0, s74
    s_add_u32 s74, s69, 512
    buffer_load_dwordx4 v8, s[48:51], s74 offen offset:0 lds
    s_add_u32 s74, s69, 512
    buffer_load_dwordx4 v9, s[48:51], s74 offen offset:1024 lds
    s_lshl_b32 s74, s3, 10
    s_add_u32 s74, s74, 106496
    s_mov_b32 m0, s74
    s_add_u32 s74, s70, 512
    buffer_load_dwordx4 v13, s[52:55], s74 offen lds
    v_add_u32 v6, s6, v24
    v_add_u32 v7, s7, v24
    v_add_u32 v6, 0x20000, v6
    v_add_u32 v7, 0x20000, v7
    ds_read_b128 v[64:67], v6 offset:0
    ds_read_b128 v[68:71], v7 offset:0
    v_add_u32 v6, s6, v25
    v_add_u32 v7, s7, v25
    v_add_u32 v6, 0x20000, v6
    v_add_u32 v7, 0x20000, v7
    ds_read_b128 v[72:75], v6 offset:0
    ds_read_b128 v[76:79], v7 offset:0
    v_add_u32 v6, s6, v26
    v_add_u32 v7, s7, v26
    v_add_u32 v6, 0x20000, v6
    v_add_u32 v7, 0x20000, v7
    ds_read_b128 v[80:83], v6 offset:0
    ds_read_b128 v[84:87], v7 offset:0
    v_add_u32 v6, s6, v27
    v_add_u32 v7, s7, v27
    v_add_u32 v6, 0x20000, v6
    v_add_u32 v7, 0x20000, v7
    ds_read_b128 v[88:91], v6 offset:0
    ds_read_b128 v[92:95], v7 offset:0
    v_add_u32 v6, s6, v24
    v_add_u32 v7, s7, v24
    ds_read_b128 v[32:35], v6 offset:0
    ds_read_b128 v[36:39], v7 offset:0
    v_add_u32 v6, s6, v25
    v_add_u32 v7, s7, v25
    ds_read_b128 v[40:43], v6 offset:0
    ds_read_b128 v[44:47], v7 offset:0
    v_add_u32 v6, s6, v26
    v_add_u32 v7, s7, v26
    ds_read_b128 v[48:51], v6 offset:0
    ds_read_b128 v[52:55], v7 offset:0
    v_add_u32 v6, s6, v27
    v_add_u32 v7, s7, v27
    ds_read_b128 v[56:59], v6 offset:0
    ds_read_b128 v[60:63], v7 offset:0
    s_waitcnt lgkmcnt(14)
    v_mfma_f32_32x32x16_bf16 v[112:127], v[64:67], v[68:71], v[112:127]
    s_waitcnt lgkmcnt(12)
    v_mfma_f32_32x32x16_bf16 v[112:127], v[72:75], v[76:79], v[112:127]
    s_waitcnt lgkmcnt(10)
    v_mfma_f32_32x32x16_bf16 v[112:127], v[80:83], v[84:87], v[112:127]
    s_waitcnt lgkmcnt(8)
    v_mfma_f32_32x32x16_bf16 v[112:127], v[88:91], v[92:95], v[112:127]
    v_add_u32 v6, s6, v24
    v_add_u32 v7, s7, v24
    ds_read_b128 v[64:67], v6 offset:24576
    ds_read_b128 v[68:71], v7 offset:24576
    v_add_u32 v6, s6, v25
    v_add_u32 v7, s7, v25
    ds_read_b128 v[72:75], v6 offset:24576
    ds_read_b128 v[76:79], v7 offset:24576
    v_add_u32 v6, s6, v26
    v_add_u32 v7, s7, v26
    ds_read_b128 v[80:83], v6 offset:24576
    ds_read_b128 v[84:87], v7 offset:24576
    v_add_u32 v6, s6, v27
    v_add_u32 v7, s7, v27
    ds_read_b128 v[88:91], v6 offset:24576
    ds_read_b128 v[92:95], v7 offset:24576
    s_waitcnt lgkmcnt(14)
    v_mfma_f32_32x32x16_bf16 v[112:127], v[32:35], v[36:39], v[112:127]
    s_waitcnt lgkmcnt(12)
    v_mfma_f32_32x32x16_bf16 v[112:127], v[40:43], v[44:47], v[112:127]
    s_waitcnt lgkmcnt(10)
    v_mfma_f32_32x32x16_bf16 v[112:127], v[48:51], v[52:55], v[112:127]
    s_waitcnt lgkmcnt(8)
    v_mfma_f32_32x32x16_bf16 v[112:127], v[56:59], v[60:63], v[112:127]
    s_waitcnt lgkmcnt(6)
    v_mfma_f32_32x32x16_bf16 v[112:127], v[64:67], v[68:71], v[112:127]
    s_waitcnt lgkmcnt(4)
    v_mfma_f32_32x32x16_bf16 v[112:127], v[72:75], v[76:79], v[112:127]
    s_waitcnt lgkmcnt(2)
    v_mfma_f32_32x32x16_bf16 v[112:127], v[80:83], v[84:87], v[112:127]
    s_waitcnt lgkmcnt(0)
    v_mfma_f32_32x32x16_bf16 v[112:127], v[88:91], v[92:95], v[112:127]
    s_waitcnt lgkmcnt(0)
    s_waitcnt vmcnt(0)
    s_barrier
    s_lshl_b32 s74, s3, 11
    s_add_u32 s74, s74, 131072
    s_mov_b32 m0, s74
    s_add_u32 s74, s69, 640
    buffer_load_dwordx4 v8, s[48:51], s74 offen offset:0 lds
    s_add_u32 s74, s69, 640
    buffer_load_dwordx4 v9, s[48:51], s74 offen offset:1024 lds
    s_lshl_b32 s74, s3, 10
    s_add_u32 s74, s74, 147456
    s_mov_b32 m0, s74
    s_add_u32 s74, s70, 640
    buffer_load_dwordx4 v13, s[52:55], s74 offen lds
    s_lshl_b32 s74, s3, 11
    s_add_u32 s74, s74, 0
    s_mov_b32 m0, s74
    s_add_u32 s74, s69, 768
    buffer_load_dwordx4 v8, s[48:51], s74 offen offset:0 lds
    s_add_u32 s74, s69, 768
    buffer_load_dwordx4 v9, s[48:51], s74 offen offset:1024 lds
    s_lshl_b32 s74, s3, 10
    s_add_u32 s74, s74, 16384
    s_mov_b32 m0, s74
    s_add_u32 s74, s70, 768
    buffer_load_dwordx4 v13, s[52:55], s74 offen lds
    s_lshl_b32 s74, s3, 11
    s_add_u32 s74, s74, 24576
    s_mov_b32 m0, s74
    s_add_u32 s74, s69, 896
    buffer_load_dwordx4 v8, s[48:51], s74 offen offset:0 lds
    s_add_u32 s74, s69, 896
    buffer_load_dwordx4 v9, s[48:51], s74 offen offset:1024 lds
    s_lshl_b32 s74, s3, 10
    s_add_u32 s74, s74, 40960
    s_mov_b32 m0, s74
    s_add_u32 s74, s70, 896
    buffer_load_dwordx4 v13, s[52:55], s74 offen lds
    v_lshrrev_b32 v34, 2, v4
    v_lshl_add_u32 v34, v3, 2, v34
    v_lshlrev_b32 v34, 7, v34
    v_and_b32 v35, 1, v5
    v_lshl_add_u32 v34, v35, 5, v34
    v_and_b32 v35, 3, v4
    v_lshl_add_u32 v34, v35, 3, v34
    s_lshl_b32 s65, s3, 11
    s_add_u32 s65, s65, 49152
    v_add_u32 v34, s65, v34
    v_lshrrev_b32 v35, 3, v4
    v_lshl_add_u32 v32, v35, 6, v34
    v_xor_b32 v35, 1, v35
    v_lshl_add_u32 v33, v35, 6, v34
    ds_read_b64_tr_b16 v[40:41], v32 offset:0
    ds_read_b64_tr_b16 v[42:43], v32 offset:1024
    ds_read_b64_tr_b16 v[44:45], v33 offset:0
    ds_read_b64_tr_b16 v[46:47], v33 offset:1024
    s_lshl_b32 s65, s3, 19
    s_lshl_b32 s66, s2, 10
    s_add_u32 s65, s65, s66
    s_add_u32 s65, s65, 0x5000000
    s_add_u32 s66, s65, 0x40000
    s_waitcnt lgkmcnt(0)
    buffer_store_dwordx4 v[40:43], v14, s[56:59], s65 offen sc1
    buffer_store_dwordx4 v[44:47], v14, s[56:59], s66 offen sc1
    s_lshl_b32 s73, s5, 19
    s_and_b32 s65, s3, 1
    s_lshr_b32 s66, s3, 1
    s_and_b32 s66, s66, 1
    s_lshl_b32 s65, s65, 15
    s_add_u32 s73, s73, s65
    s_lshl_b32 s65, s4, 16
    s_add_u32 s73, s73, s65
    s_lshl_b32 s66, s66, 13
    s_add_u32 s73, s73, s66
    s_add_u32 s73, s73, 0x2000000
    s_add_u32 s65, s73, 0
    v_cvt_pk_bf16_f32 v32, v128, v129
    v_cvt_pk_bf16_f32 v33, v130, v131
    v_cvt_pk_bf16_f32 v34, v132, v133
    v_cvt_pk_bf16_f32 v35, v134, v135
    buffer_store_dwordx4 v[32:35], v14, s[56:59], s65 offen offset:0 sc1
    v_add_u32 v6, s6, v24
    v_add_u32 v7, s7, v24
    v_add_u32 v6, 0x10000, v6
    v_add_u32 v7, 0x10000, v7
    ds_read_b128 v[64:67], v6 offset:0
    ds_read_b128 v[68:71], v7 offset:0
    v_add_u32 v6, s6, v25
    v_add_u32 v7, s7, v25
    v_add_u32 v6, 0x10000, v6
    v_add_u32 v7, 0x10000, v7
    ds_read_b128 v[72:75], v6 offset:0
    ds_read_b128 v[76:79], v7 offset:0
    v_cvt_pk_bf16_f32 v36, v136, v137
    v_cvt_pk_bf16_f32 v37, v138, v139
    v_cvt_pk_bf16_f32 v38, v140, v141
    v_cvt_pk_bf16_f32 v39, v142, v143
    buffer_store_dwordx4 v[36:39], v14, s[56:59], s65 offen offset:1024 sc1
    v_add_u32 v6, s6, v26
    v_add_u32 v7, s7, v26
    v_add_u32 v6, 0x10000, v6
    v_add_u32 v7, 0x10000, v7
    ds_read_b128 v[80:83], v6 offset:0
    ds_read_b128 v[84:87], v7 offset:0
    v_add_u32 v6, s6, v27
    v_add_u32 v7, s7, v27
    v_add_u32 v6, 0x10000, v6
    v_add_u32 v7, 0x10000, v7
    ds_read_b128 v[88:91], v6 offset:0
    ds_read_b128 v[92:95], v7 offset:0
    s_add_u32 s65, s73, 4096
    v_cvt_pk_bf16_f32 v40, v144, v145
    v_cvt_pk_bf16_f32 v41, v146, v147
    v_cvt_pk_bf16_f32 v42, v148, v149
    v_cvt_pk_bf16_f32 v43, v150, v151
    buffer_store_dwordx4 v[40:43], v14, s[56:59], s65 offen offset:0 sc1
    s_waitcnt lgkmcnt(6)
    v_mfma_f32_32x32x16_bf16 v[112:127], v[64:67], v[68:71], v[112:127]
    s_waitcnt lgkmcnt(4)
    v_mfma_f32_32x32x16_bf16 v[112:127], v[72:75], v[76:79], v[112:127]
    v_cvt_pk_bf16_f32 v44, v152, v153
    v_cvt_pk_bf16_f32 v45, v154, v155
    v_cvt_pk_bf16_f32 v46, v156, v157
    v_cvt_pk_bf16_f32 v47, v158, v159
    buffer_store_dwordx4 v[44:47], v14, s[56:59], s65 offen offset:1024 sc1
    s_waitcnt lgkmcnt(2)
    v_mfma_f32_32x32x16_bf16 v[112:127], v[80:83], v[84:87], v[112:127]
    s_waitcnt lgkmcnt(0)
    v_mfma_f32_32x32x16_bf16 v[112:127], v[88:91], v[92:95], v[112:127]
    s_add_u32 s65, s73, 0
    v_cvt_pk_bf16_f32 v48, v160, v161
    v_cvt_pk_bf16_f32 v49, v162, v163
    v_cvt_pk_bf16_f32 v50, v164, v165
    v_cvt_pk_bf16_f32 v51, v166, v167
    buffer_store_dwordx4 v[48:51], v14, s[56:59], s65 offen offset:2048 sc1
    v_add_u32 v6, s6, v24
    v_add_u32 v7, s7, v24
    v_add_u32 v6, 0x16000, v6
    v_add_u32 v7, 0x16000, v7
    ds_read_b128 v[64:67], v6 offset:0
    ds_read_b128 v[68:71], v7 offset:0
    v_add_u32 v6, s6, v25
    v_add_u32 v7, s7, v25
    v_add_u32 v6, 0x16000, v6
    v_add_u32 v7, 0x16000, v7
    ds_read_b128 v[72:75], v6 offset:0
    ds_read_b128 v[76:79], v7 offset:0
    v_cvt_pk_bf16_f32 v52, v168, v169
    v_cvt_pk_bf16_f32 v53, v170, v171
    v_cvt_pk_bf16_f32 v54, v172, v173
    v_cvt_pk_bf16_f32 v55, v174, v175
    buffer_store_dwordx4 v[52:55], v14, s[56:59], s65 offen offset:3072 sc1
    v_add_u32 v6, s6, v26
    v_add_u32 v7, s7, v26
    v_add_u32 v6, 0x16000, v6
    v_add_u32 v7, 0x16000, v7
    ds_read_b128 v[80:83], v6 offset:0
    ds_read_b128 v[84:87], v7 offset:0
    v_add_u32 v6, s6, v27
    v_add_u32 v7, s7, v27
    v_add_u32 v6, 0x16000, v6
    v_add_u32 v7, 0x16000, v7
    ds_read_b128 v[88:91], v6 offset:0
    ds_read_b128 v[92:95], v7 offset:0
    s_add_u32 s65, s73, 4096
    v_cvt_pk_bf16_f32 v56, v176, v177
    v_cvt_pk_bf16_f32 v57, v178, v179
    v_cvt_pk_bf16_f32 v58, v180, v181
    v_cvt_pk_bf16_f32 v59, v182, v183
    buffer_store_dwordx4 v[56:59], v14, s[56:59], s65 offen offset:2048 sc1
    s_waitcnt lgkmcnt(6)
    v_mfma_f32_32x32x16_bf16 v[112:127], v[64:67], v[68:71], v[112:127]
    s_waitcnt lgkmcnt(4)
    v_mfma_f32_32x32x16_bf16 v[112:127], v[72:75], v[76:79], v[112:127]
    v_cvt_pk_bf16_f32 v60, v184, v185
    v_cvt_pk_bf16_f32 v61, v186, v187
    v_cvt_pk_bf16_f32 v62, v188, v189
    v_cvt_pk_bf16_f32 v63, v190, v191
    buffer_store_dwordx4 v[60:63], v14, s[56:59], s65 offen offset:3072 sc1
    s_waitcnt lgkmcnt(2)
    v_mfma_f32_32x32x16_bf16 v[112:127], v[80:83], v[84:87], v[112:127]
    s_waitcnt lgkmcnt(0)
    v_mfma_f32_32x32x16_bf16 v[112:127], v[88:91], v[92:95], v[112:127]
    s_add_u32 s65, s73, 16384
    v_cvt_pk_bf16_f32 v32, v192, v193
    v_cvt_pk_bf16_f32 v33, v194, v195
    v_cvt_pk_bf16_f32 v34, v196, v197
    v_cvt_pk_bf16_f32 v35, v198, v199
    buffer_store_dwordx4 v[32:35], v14, s[56:59], s65 offen offset:0 sc1
    v_cvt_pk_bf16_f32 v36, v200, v201
    v_cvt_pk_bf16_f32 v37, v202, v203
    v_cvt_pk_bf16_f32 v38, v204, v205
    v_cvt_pk_bf16_f32 v39, v206, v207
    buffer_store_dwordx4 v[36:39], v14, s[56:59], s65 offen offset:1024 sc1
    s_waitcnt lgkmcnt(0)
    s_waitcnt vmcnt(12)
    s_barrier
    s_add_u32 s65, s73, 20480
    v_cvt_pk_bf16_f32 v40, v208, v209
    v_cvt_pk_bf16_f32 v41, v210, v211
    v_cvt_pk_bf16_f32 v42, v212, v213
    v_cvt_pk_bf16_f32 v43, v214, v215
    buffer_store_dwordx4 v[40:43], v14, s[56:59], s65 offen offset:0 sc1
    v_add_u32 v6, s6, v24
    v_add_u32 v7, s7, v24
    v_add_u32 v6, 0x20000, v6
    v_add_u32 v7, 0x20000, v7
    ds_read_b128 v[64:67], v6 offset:0
    ds_read_b128 v[68:71], v7 offset:0
    v_add_u32 v6, s6, v25
    v_add_u32 v7, s7, v25
    v_add_u32 v6, 0x20000, v6
    v_add_u32 v7, 0x20000, v7
    ds_read_b128 v[72:75], v6 offset:0
    ds_read_b128 v[76:79], v7 offset:0
    v_add_u32 v6, s6, v26
    v_add_u32 v7, s7, v26
    v_add_u32 v6, 0x20000, v6
    v_add_u32 v7, 0x20000, v7
    ds_read_b128 v[80:83], v6 offset:0
    ds_read_b128 v[84:87], v7 offset:0
    v_add_u32 v6, s6, v27
    v_add_u32 v7, s7, v27
    v_add_u32 v6, 0x20000, v6
    v_add_u32 v7, 0x20000, v7
    ds_read_b128 v[88:91], v6 offset:0
    ds_read_b128 v[92:95], v7 offset:0
    v_cvt_pk_bf16_f32 v44, v216, v217
    v_cvt_pk_bf16_f32 v45, v218, v219
    v_cvt_pk_bf16_f32 v46, v220, v221
    v_cvt_pk_bf16_f32 v47, v222, v223
    buffer_store_dwordx4 v[44:47], v14, s[56:59], s65 offen offset:1024 sc1
    s_waitcnt lgkmcnt(6)
    v_mfma_f32_32x32x16_bf16 v[112:127], v[64:67], v[68:71], v[112:127]
    s_waitcnt lgkmcnt(4)
    v_mfma_f32_32x32x16_bf16 v[112:127], v[72:75], v[76:79], v[112:127]
    s_waitcnt lgkmcnt(2)
    v_mfma_f32_32x32x16_bf16 v[112:127], v[80:83], v[84:87], v[112:127]
    s_waitcnt lgkmcnt(0)
    v_mfma_f32_32x32x16_bf16 v[112:127], v[88:91], v[92:95], v[112:127]
    s_add_u32 s65, s73, 16384
    v_cvt_pk_bf16_f32 v48, v224, v225
    v_cvt_pk_bf16_f32 v49, v226, v227
    v_cvt_pk_bf16_f32 v50, v228, v229
    v_cvt_pk_bf16_f32 v51, v230, v231
    buffer_store_dwordx4 v[48:51], v14, s[56:59], s65 offen offset:2048 sc1
    v_add_u32 v6, s6, v24
    v_add_u32 v7, s7, v24
    ds_read_b128 v[64:67], v6 offset:0
    ds_read_b128 v[68:71], v7 offset:0
    v_add_u32 v6, s6, v25
    v_add_u32 v7, s7, v25
    ds_read_b128 v[72:75], v6 offset:0
    ds_read_b128 v[76:79], v7 offset:0
    v_add_u32 v6, s6, v26
    v_add_u32 v7, s7, v26
    ds_read_b128 v[80:83], v6 offset:0
    ds_read_b128 v[84:87], v7 offset:0
    v_add_u32 v6, s6, v27
    v_add_u32 v7, s7, v27
    ds_read_b128 v[88:91], v6 offset:0
    ds_read_b128 v[92:95], v7 offset:0
    v_cvt_pk_bf16_f32 v52, v232, v233
    v_cvt_pk_bf16_f32 v53, v234, v235
    v_cvt_pk_bf16_f32 v54, v236, v237
    v_cvt_pk_bf16_f32 v55, v238, v239
    buffer_store_dwordx4 v[52:55], v14, s[56:59], s65 offen offset:3072 sc1
    s_waitcnt lgkmcnt(6)
    v_mfma_f32_32x32x16_bf16 v[112:127], v[64:67], v[68:71], v[112:127]
    s_waitcnt lgkmcnt(4)
    v_mfma_f32_32x32x16_bf16 v[112:127], v[72:75], v[76:79], v[112:127]
    s_waitcnt lgkmcnt(2)
    v_mfma_f32_32x32x16_bf16 v[112:127], v[80:83], v[84:87], v[112:127]
    s_waitcnt lgkmcnt(0)
    v_mfma_f32_32x32x16_bf16 v[112:127], v[88:91], v[92:95], v[112:127]
    s_add_u32 s65, s73, 20480
    v_cvt_pk_bf16_f32 v56, v240, v241
    v_cvt_pk_bf16_f32 v57, v242, v243
    v_cvt_pk_bf16_f32 v58, v244, v245
    v_cvt_pk_bf16_f32 v59, v246, v247
    buffer_store_dwordx4 v[56:59], v14, s[56:59], s65 offen offset:2048 sc1
    v_add_u32 v6, s6, v24
    v_add_u32 v7, s7, v24
    ds_read_b128 v[64:67], v6 offset:24576
    ds_read_b128 v[68:71], v7 offset:24576
    v_add_u32 v6, s6, v25
    v_add_u32 v7, s7, v25
    ds_read_b128 v[72:75], v6 offset:24576
    ds_read_b128 v[76:79], v7 offset:24576
    v_add_u32 v6, s6, v26
    v_add_u32 v7, s7, v26
    ds_read_b128 v[80:83], v6 offset:24576
    ds_read_b128 v[84:87], v7 offset:24576
    v_add_u32 v6, s6, v27
    v_add_u32 v7, s7, v27
    ds_read_b128 v[88:91], v6 offset:24576
    ds_read_b128 v[92:95], v7 offset:24576
    v_cvt_pk_bf16_f32 v60, v248, v249
    v_cvt_pk_bf16_f32 v61, v250, v251
    v_cvt_pk_bf16_f32 v62, v252, v253
    v_cvt_pk_bf16_f32 v63, v254, v255
    buffer_store_dwordx4 v[60:63], v14, s[56:59], s65 offen offset:3072 sc1
    s_waitcnt lgkmcnt(6)
    v_mfma_f32_32x32x16_bf16 v[112:127], v[64:67], v[68:71], v[112:127]
    s_waitcnt lgkmcnt(4)
    v_mfma_f32_32x32x16_bf16 v[112:127], v[72:75], v[76:79], v[112:127]
    s_waitcnt lgkmcnt(2)
    v_mfma_f32_32x32x16_bf16 v[112:127], v[80:83], v[84:87], v[112:127]
    s_waitcnt lgkmcnt(0)
    v_mfma_f32_32x32x16_bf16 v[112:127], v[88:91], v[92:95], v[112:127]
    s_branch L_k1_phase2
L_k1_phase2:
    s_nop 15
    s_and_b32 s65, s72, 1
    s_lshl_b32 s73, s65, 22
    s_lshr_b32 s65, s72, 1
    s_lshl_b32 s65, s65, 19
    s_add_u32 s73, s73, s65
    s_lshr_b32 s65, s3, 2
    s_lshl_b32 s65, s65, 18
    s_add_u32 s73, s73, s65
    s_lshl_b32 s65, s71, 9
    s_add_u32 s73, s73, s65
    s_and_b32 s65, s3, 3
    s_lshl_b32 s65, s65, 7
    s_add_u32 s73, s73, s65
    s_add_u32 s73, s73, 0x4000000
    buffer_store_dwordx4 v[112:115], v15, s[56:59], s73 offen offset:0
    buffer_store_dwordx4 v[116:119], v15, s[56:59], s73 offen offset:32
    buffer_store_dwordx4 v[120:123], v15, s[56:59], s73 offen offset:64
    buffer_store_dwordx4 v[124:127], v15, s[56:59], s73 offen offset:96
L_k1_end:
    s_endpgm
.globl attn_kernel
.p2align 8
.type attn_kernel,@function
attn_kernel:
    s_cmp_ge_u32 s2, 256
    s_cbranch_scc1 L_k2_end
    s_load_dwordx2 s[28:29], s[0:1], 136
    s_load_dwordx4 s[8:11], s[0:1], 56
    s_load_dwordx2 s[12:13], s[0:1], 104
    s_load_dwordx2 s[14:15], s[0:1], 0
    s_load_dwordx2 s[16:17], s[0:1], 16
    v_and_b32 v1, 63, v0
    v_lshrrev_b32 v2, 6, v0
    s_nop 0
    v_readfirstlane_b32 s3, v2
    v_and_b32 v2, 31, v1
    v_lshrrev_b32 v3, 5, v1
    v_lshlrev_b32 v4, 4, v1
    v_lshlrev_b32 v14, 2, v3
    v_sub_u32 v12, v2, v14
    v_mov_b32 v10, 0xff800000
    s_and_b32 s4, s3, 3
    s_lshr_b32 s7, s3, 2
    s_and_b32 s45, s2, 7
    s_lshl_b32 s45, s45, 2
    s_lshr_b32 s46, s2, 3
    s_and_b32 s46, s46, 3
    s_add_u32 s5, s45, s46
    s_lshr_b32 s6, s2, 5
    s_mov_b32 s42, 0x5f800000
    v_and_b32 v13, 15, v1
    v_bfe_u32 v14, v1, 4, 1
    v_cmp_eq_u32 vcc, v13, v14
    v_mov_b32 v15, 0x3f803f80
    s_lshl_b32 s45, s7, 16
    s_lshl_b32 s46, s4, 12
    v_cndmask_b32 v240, 0, v15, vcc
    v_cndmask_b32 v241, 0, v15, vcc
    v_cndmask_b32 v242, 0, v15, vcc
    v_cndmask_b32 v243, 0, v15, vcc
    v_add_u32 v6, s46, v4
    s_add_u32 s40, s45, s46
    s_lshl_b32 s47, s7, 15
    s_add_u32 s40, s40, s47
    s_add_u32 s41, s40, 16384
    s_lshl_b32 s45, s5, 19
    s_add_u32 s36, s45, 0x1000000
    s_add_u32 s37, s45, 0x2000000
    s_lshl_b32 s45, s6, 1
    s_sub_u32 s47, 15, s45
    s_cmp_eq_u32 s7, 0
    s_cselect_b32 s38, 17, 0
    s_cselect_b32 s39, s47, 17
    s_mov_b32 s48, 0x18000
    v_add_u32 v5, s48, v4
    s_waitcnt lgkmcnt(0)
    s_mov_b32 s32, s28
    s_mov_b32 s33, s29
    s_mov_b32 s34, 0x10000000
    s_mov_b32 s35, 0x00020000
    s_mov_b32 s20, s14
    s_mov_b32 s21, s15
    s_mov_b32 s22, 0x200000
    s_mov_b32 s23, 0x00020000
    s_mov_b32 s24, s16
    s_mov_b32 s25, s17
    s_mov_b32 s26, 0x400000
    s_mov_b32 s27, 0x00020000
    s_lshl_b32 s45, s2, 2
    s_load_dword s60, s[8:9], s45
    s_load_dword s61, s[10:11], s45
    s_load_dword s62, s[12:13], s45
    v_lshlrev_b32 v13, 4, v0
    s_lshl_b32 s45, s2, 14
    s_add_u32 s45, s45, 0x4000000
    s_add_u32 s46, s45, 0
    buffer_load_dwordx4 v[152:155], v13, s[32:35], s46 offen
    s_add_u32 s46, s45, 4194304
    buffer_load_dwordx4 v[156:159], v13, s[32:35], s46 offen
    s_add_u32 s46, s45, 8192
    buffer_load_dwordx4 v[244:247], v13, s[32:35], s46 offen
    s_add_u32 s46, s45, 4202496
    buffer_load_dwordx4 v[248:251], v13, s[32:35], s46 offen
    v_lshrrev_b32 v15, 4, v1
    v_lshrrev_b32 v13, 3, v1
    v_lshlrev_b32 v13, 10, v13
    v_and_b32 v14, 7, v1
    v_xor_b32 v14, v14, v15
    v_lshl_add_u32 v224, v14, 4, v13
    v_xor_b32 v14, 4, v14
    v_lshl_add_u32 v225, v14, 4, v13
    v_add_u32 v226, 14336, v224
    v_add_u32 v227, 21504, v225
    v_add_u32 v225, 7168, v225
    v_lshrrev_b32 v13, 2, v1
    v_and_b32 v13, 3, v13
    v_xor_b32 v13, v13, v15
    v_lshlrev_b32 v13, 6, v13
    v_lshl_add_u32 v13, v15, 13, v13
    v_and_b32 v14, 3, v1
    v_lshl_add_u32 v228, v14, 4, v13
    s_sub_u32 s45, 15, s6
    s_cmp_eq_u32 s7, 0
    s_cselect_b32 s45, s6, s45
    s_lshl_b32 s45, s45, 2
    s_add_u32 s45, s45, s4
    s_lshl_b32 s18, s45, 15
    s_lshl_b32 s45, s3, 16
    s_lshl_b32 s46, s5, 8
    s_add_u32 s19, s45, s46
    s_lshl_b32 s63, s3, 12
    s_add_u32 s63, s63, 0
    s_mov_b32 m0, s63
    s_add_u32 s63, s18, 0
    buffer_load_dwordx4 v224, s[20:23], s63 offen offset:0 lds
    s_add_u32 s63, s18, 0
    buffer_load_dwordx4 v225, s[20:23], s63 offen offset:1024 lds
    s_add_u32 s63, s18, 0
    buffer_load_dwordx4 v226, s[20:23], s63 offen offset:2048 lds
    s_add_u32 s63, s18, 0
    buffer_load_dwordx4 v227, s[20:23], s63 offen offset:3072 lds
    s_lshl_b32 s63, s3, 11
    s_add_u32 s63, s63, 32768
    s_mov_b32 m0, s63
    s_add_u32 s63, s19, 0
    buffer_load_dwordx4 v228, s[24:27], s63 offen offset:0 lds
    s_add_u32 s63, s19, 31744
    buffer_load_dwordx4 v228, s[24:27], s63 offen offset:1024 lds
    v_lshrrev_b32 v13, 1, v2
    v_and_b32 v13, 7, v13
    s_lshl_b32 s45, s3, 12
    v_add_u32 v14, 0, v3
    v_xor_b32 v14, v14, v13
    v_lshlrev_b32 v14, 4, v14
    v_lshl_add_u32 v14, v2, 7, v14
    v_add_u32 v229, s45, v14
    v_add_u32 v14, 2, v3
    v_xor_b32 v14, v14, v13
    v_lshlrev_b32 v14, 4, v14
    v_lshl_add_u32 v14, v2, 7, v14
    v_add_u32 v230, s45, v14
    v_add_u32 v14, 4, v3
    v_xor_b32 v14, v14, v13
    v_lshlrev_b32 v14, 4, v14
    v_lshl_add_u32 v14, v2, 7, v14
    v_add_u32 v231, s45, v14
    v_add_u32 v14, 6, v3
    v_xor_b32 v14, v14, v13
    v_lshlrev_b32 v14, 4, v14
    v_lshl_add_u32 v14, v2, 7, v14
    v_add_u32 v232, s45, v14
    v_and_b32 v13, 15, v1
    v_lshrrev_b32 v14, 2, v13
    v_lshl_add_u32 v8, v3, 3, v14
    v_lshlrev_b32 v8, 8, v8
    v_and_b32 v9, 1, v15
    v_lshl_add_u32 v8, v9, 5, v8
    v_and_b32 v9, 3, v13
    v_lshl_add_u32 v8, v9, 3, v8
    v_add_u32 v8, 0x8000, v8
    v_xor_b32 v9, 0, v14
    v_lshl_add_u32 v233, v9, 6, v8
    v_xor_b32 v9, 1, v14
    v_lshl_add_u32 v234, v9, 6, v8
    v_xor_b32 v9, 2, v14
    v_lshl_add_u32 v235, v9, 6, v8
    v_xor_b32 v9, 3, v14
    v_lshl_add_u32 v236, v9, 6, v8
    s_waitcnt lgkmcnt(0)
    s_lshl_b32 s64, s60, 16
    s_and_b32 s65, s60, 0xffff0000
    s_lshl_b32 s66, s61, 16
    s_and_b32 s67, s61, 0xffff0000
    s_lshl_b32 s68, s62, 16
    s_and_b32 s69, s62, 0xffff0000
    s_mov_b32 s70, 0x3fb8aa3b
    s_mov_b32 s71, 0x3e22f983
    v_cvt_f32_u32 v15, v1
    v_mul_f32 v15, 4.0, v15
    v_mov_b32 v16, s64
    v_mov_b32 v17, s66
    v_mov_b32 v21, s68
    v_mul_f32 v21, s70, v21
    v_exp_f32 v21, v21
    s_nop 0
    v_cvt_pk_bf16_f32 v21, v21, v21
    v_lshlrev_b32 v18, 16, v21
    v_mul_f32 v19, v18, v16
    v_mul_f32 v20, v18, v17
    v_mul_f32 v19, s70, v19
    v_mul_f32 v20, s71, v20
    v_exp_f32 v21, v19
    v_fract_f32 v22, v20
    v_cos_f32 v25, v22
    v_sin_f32 v26, v22
    s_nop 0
    v_mul_f32 v25, v25, v21
    v_mul_f32 v26, v26, v21
    v_mul_f32 v55, v15, v19
    v_mul_f32 v56, v15, v20
    v_exp_f32 v21, v55
    v_fract_f32 v22, v56
    v_cos_f32 v45, v22
    v_sin_f32 v46, v22
    s_nop 0
    v_mul_f32 v45, v45, v21
    v_mul_f32 v46, v46, v21
    v_add_f32 v55, -1.0, v25
    v_mul_f32 v21, v16, v16
    v_fma_f32 v21, v17, v17, v21
    v_rcp_f32 v21, v21
    v_mul_f32 v23, v55, v16
    v_fma_f32 v23, v26, v17, v23
    v_mul_f32 v24, v26, v16
    v_fma_f32 v24, -v55, v17, v24
    v_mul_f32 v23, v23, v21
    v_mul_f32 v24, v24, v21
    v_mul_f32 v21, v26, v26
    v_fma_f32 v27, v25, v25, -v21
    v_mul_f32 v21, v26, v25
    v_fma_f32 v28, v25, v26, v21
    v_mul_f32 v21, v28, v26
    v_fma_f32 v29, v27, v25, -v21
    v_mul_f32 v21, v28, v25
    v_fma_f32 v30, v27, v26, v21
    v_mul_f32 v21, v28, v28
    v_fma_f32 v31, v27, v27, -v21
    v_mul_f32 v21, v28, v27
    v_fma_f32 v32, v27, v28, v21
    v_mul_f32 v21, v32, v32
    v_fma_f32 v33, v31, v31, -v21
    v_mul_f32 v21, v32, v31
    v_fma_f32 v34, v31, v32, v21
    v_mul_f32 v21, v34, v34
    v_fma_f32 v35, v33, v33, -v21
    v_mul_f32 v21, v34, v33
    v_fma_f32 v36, v33, v34, v21
    v_mul_f32 v21, v36, v36
    v_fma_f32 v37, v35, v35, -v21
    v_mul_f32 v21, v36, v35
    v_fma_f32 v38, v35, v36, v21
    v_mul_f32 v21, v38, v38
    v_fma_f32 v39, v37, v37, -v21
    v_mul_f32 v21, v38, v37
    v_fma_f32 v40, v37, v38, v21
    v_mul_f32 v21, v40, v40
    v_fma_f32 v41, v39, v39, -v21
    v_mul_f32 v21, v40, v39
    v_fma_f32 v42, v39, v40, v21
    v_mul_f32 v21, v42, v42
    v_fma_f32 v43, v41, v41, -v21
    v_mul_f32 v21, v42, v41
    v_fma_f32 v44, v41, v42, v21
    v_mov_b32 v64, s65
    v_mov_b32 v65, s67
    v_mov_b32 v69, s69
    v_mul_f32 v69, s70, v69
    v_exp_f32 v69, v69
    s_nop 0
    v_cvt_pk_bf16_f32 v69, v69, v69
    v_lshlrev_b32 v66, 16, v69
    v_mul_f32 v67, v66, v64
    v_mul_f32 v68, v66, v65
    v_mul_f32 v67, s70, v67
    v_mul_f32 v68, s71, v68
    v_exp_f32 v69, v67
    v_fract_f32 v70, v68
    v_cos_f32 v73, v70
    s_lshl_b32 s63, s3, 12
    s_add_u32 s63, s63, 49152
    s_mov_b32 m0, s63
    s_add_u32 s63, s18, 128
    buffer_load_dwordx4 v224, s[20:23], s63 offen offset:0 lds
    s_add_u32 s63, s18, 128
    buffer_load_dwordx4 v225, s[20:23], s63 offen offset:1024 lds
    s_add_u32 s63, s18, 128
    buffer_load_dwordx4 v226, s[20:23], s63 offen offset:2048 lds
    s_add_u32 s63, s18, 128
    buffer_load_dwordx4 v227, s[20:23], s63 offen offset:3072 lds
    s_lshl_b32 s63, s3, 11
    s_add_u32 s63, s63, 81920
    s_mov_b32 m0, s63
    s_add_u32 s63, s19, 524288
    buffer_load_dwordx4 v228, s[24:27], s63 offen offset:0 lds
    s_add_u32 s63, s19, 556032
    buffer_load_dwordx4 v228, s[24:27], s63 offen offset:1024 lds
    v_sin_f32 v74, v70
    s_nop 0
    v_mul_f32 v73, v73, v69
    v_mul_f32 v74, v74, v69
    v_mul_f32 v103, v15, v67
    v_mul_f32 v104, v15, v68
    v_exp_f32 v69, v103
    v_fract_f32 v70, v104
    v_cos_f32 v93, v70
    v_sin_f32 v94, v70
    s_nop 0
    v_mul_f32 v93, v93, v69
    v_mul_f32 v94, v94, v69
    v_add_f32 v103, -1.0, v73
    v_mul_f32 v69, v64, v64
    v_fma_f32 v69, v65, v65, v69
    v_rcp_f32 v69, v69
    v_mul_f32 v71, v103, v64
    v_fma_f32 v71, v74, v65, v71
    v_mul_f32 v72, v74, v64
    v_fma_f32 v72, -v103, v65, v72
    v_mul_f32 v71, v71, v69
    v_mul_f32 v72, v72, v69
    v_mul_f32 v69, v74, v74
    v_fma_f32 v75, v73, v73, -v69
    v_mul_f32 v69, v74, v73
    v_fma_f32 v76, v73, v74, v69
    v_mul_f32 v69, v76, v74
    v_fma_f32 v77, v75, v73, -v69
    v_mul_f32 v69, v76, v73
    v_fma_f32 v78, v75, v74, v69
    v_mul_f32 v69, v76, v76
    v_fma_f32 v79, v75, v75, -v69
    v_mul_f32 v69, v76, v75
    v_fma_f32 v80, v75, v76, v69
    v_mul_f32 v69, v80, v80
    v_fma_f32 v81, v79, v79, -v69
    v_mul_f32 v69, v80, v79
    v_fma_f32 v82, v79, v80, v69
    v_mul_f32 v69, v82, v82
    v_fma_f32 v83, v81, v81, -v69
    v_mul_f32 v69, v82, v81
    v_fma_f32 v84, v81, v82, v69
    v_mul_f32 v69, v84, v84
    v_fma_f32 v85, v83, v83, -v69
    v_mul_f32 v69, v84, v83
    v_fma_f32 v86, v83, v84, v69
    v_mul_f32 v69, v86, v86
    v_fma_f32 v87, v85, v85, -v69
    v_mul_f32 v69, v86, v85
    v_fma_f32 v88, v85, v86, v69
    v_mul_f32 v69, v88, v88
    v_fma_f32 v89, v87, v87, -v69
    v_mul_f32 v69, v88, v87
    v_fma_f32 v90, v87, v88, v69
    v_mul_f32 v69, v90, v90
    v_fma_f32 v91, v89, v89, -v69
    v_mul_f32 v69, v90, v89
    v_fma_f32 v92, v89, v90, v69
    s_waitcnt vmcnt(6)
    s_waitcnt lgkmcnt(0)
    s_barrier
    ds_read_b128 v[112:115], v229
    ds_read_b64_tr_b16 v[116:117], v233 offset:0
    ds_read_b64_tr_b16 v[118:119], v233 offset:1024
    ds_read_b64_tr_b16 v[120:121], v234 offset:0
    ds_read_b64_tr_b16 v[122:123], v234 offset:1024
    ds_read_b64_tr_b16 v[124:125], v235 offset:0
    ds_read_b64_tr_b16 v[126:127], v235 offset:1024
    ds_read_b64_tr_b16 v[128:129], v236 offset:0
    ds_read_b64_tr_b16 v[130:131], v236 offset:1024
    ds_read_b128 v[132:135], v230
    ds_read_b64_tr_b16 v[136:137], v233 offset:4096
    ds_read_b64_tr_b16 v[138:139], v233 offset:5120
    ds_read_b64_tr_b16 v[140:141], v234 offset:4096
    ds_read_b64_tr_b16 v[142:143], v234 offset:5120
    ds_read_b64_tr_b16 v[144:145], v235 offset:4096
    ds_read_b64_tr_b16 v[146:147], v235 offset:5120
    ds_read_b64_tr_b16 v[148:149], v236 offset:4096
    ds_read_b64_tr_b16 v[150:151], v236 offset:5120
    s_waitcnt lgkmcnt(15)
    v_mfma_f32_32x32x16_bf16 v[160:175], v[116:119], v[112:115], 0
    s_lshl_b32 s63, s3, 12
    s_add_u32 s63, s63, 98304
    s_mov_b32 m0, s63
    s_add_u32 s63, s18, 256
    buffer_load_dwordx4 v224, s[20:23], s63 offen offset:0 lds
    v_mul_f32 v21, v24, v156
    v_fma_f32 v47, v23, v152, -v21
    v_mul_f32 v21, v24, v152
    s_waitcnt lgkmcnt(13)
    v_mfma_f32_32x32x16_bf16 v[176:191], v[120:123], v[112:115], 0
    s_add_u32 s63, s18, 256
    buffer_load_dwordx4 v225, s[20:23], s63 offen offset:1024 lds
    v_fma_f32 v48, v23, v156, v21
    v_mul_f32 v21, v24, v157
    v_fma_f32 v49, v23, v153, -v21
    v_mul_f32 v21, v24, v153
    s_waitcnt lgkmcnt(11)
    v_mfma_f32_32x32x16_bf16 v[192:207], v[124:127], v[112:115], 0
    s_add_u32 s63, s18, 256
    buffer_load_dwordx4 v226, s[20:23], s63 offen offset:2048 lds
    v_fma_f32 v50, v23, v157, v21
    v_fma_f32 v49, v25, v47, v49
    v_fma_f32 v49, -v26, v48, v49
    v_fma_f32 v50, v25, v48, v50
    s_waitcnt lgkmcnt(9)
    v_mfma_f32_32x32x16_bf16 v[208:223], v[128:131], v[112:115], 0
    s_add_u32 s63, s18, 256
    buffer_load_dwordx4 v227, s[20:23], s63 offen offset:3072 lds
    v_fma_f32 v50, v26, v47, v50
    v_mul_f32 v21, v24, v158
    v_fma_f32 v51, v23, v154, -v21
    v_mul_f32 v21, v24, v154
    ds_read_b128 v[112:115], v231
    ds_read_b64_tr_b16 v[116:117], v233 offset:8192
    ds_read_b64_tr_b16 v[118:119], v233 offset:9216
    ds_read_b64_tr_b16 v[120:121], v234 offset:8192
    ds_read_b64_tr_b16 v[122:123], v234 offset:9216
    ds_read_b64_tr_b16 v[124:125], v235 offset:8192
    ds_read_b64_tr_b16 v[126:127], v235 offset:9216
    ds_read_b64_tr_b16 v[128:129], v236 offset:8192
    ds_read_b64_tr_b16 v[130:131], v236 offset:9216
    s_waitcnt lgkmcnt(15)
    v_mfma_f32_32x32x16_bf16 v[160:175], v[136:139], v[132:135], v[160:175]
    s_lshl_b32 s63, s3, 11
    s_add_u32 s63, s63, 131072
    s_mov_b32 m0, s63
    s_add_u32 s63, s19, 1048576
    buffer_load_dwordx4 v228, s[24:27], s63 offen offset:0 lds
    v_fma_f32 v52, v23, v158, v21
    v_fma_f32 v51, v25, v49, v51
    v_fma_f32 v51, -v26, v50, v51
    v_fma_f32 v52, v25, v50, v52
    s_waitcnt lgkmcnt(13)
    v_mfma_f32_32x32x16_bf16 v[176:191], v[140:143], v[132:135], v[176:191]
    s_add_u32 s63, s19, 1080320
    buffer_load_dwordx4 v228, s[24:27], s63 offen offset:1024 lds
    v_fma_f32 v52, v26, v49, v52
    v_mul_f32 v21, v24, v159
    v_fma_f32 v53, v23, v155, -v21
    v_mul_f32 v21, v24, v155
    s_waitcnt lgkmcnt(11)
    v_mfma_f32_32x32x16_bf16 v[192:207], v[144:147], v[132:135], v[192:207]
    v_fma_f32 v54, v23, v159, v21
    v_fma_f32 v53, v25, v51, v53
    v_fma_f32 v53, -v26, v52, v53
    v_fma_f32 v54, v25, v52, v54
    s_waitcnt lgkmcnt(9)
    v_mfma_f32_32x32x16_bf16 v[208:223], v[148:151], v[132:135], v[208:223]
    v_fma_f32 v54, v26, v51, v54
    v_mov_b32 v55, v53
    v_mov_b32 v56, v54
    v_mul_f32 v69, v72, v248
    ds_read_b128 v[132:135], v232
    ds_read_b64_tr_b16 v[136:137], v233 offset:12288
    ds_read_b64_tr_b16 v[138:139], v233 offset:13312
    ds_read_b64_tr_b16 v[140:141], v234 offset:12288
    ds_read_b64_tr_b16 v[142:143], v234 offset:13312
    ds_read_b64_tr_b16 v[144:145], v235 offset:12288
    ds_read_b64_tr_b16 v[146:147], v235 offset:13312
    ds_read_b64_tr_b16 v[148:149], v236 offset:12288
    ds_read_b64_tr_b16 v[150:151], v236 offset:13312
    s_waitcnt lgkmcnt(15)
    v_mfma_f32_32x32x16_bf16 v[160:175], v[116:119], v[112:115], v[160:175]
    v_fma_f32 v95, v71, v244, -v69
    v_mul_f32 v69, v72, v244
    v_fma_f32 v96, v71, v248, v69
    v_mul_f32 v69, v72, v249
    s_waitcnt lgkmcnt(13)
    v_mfma_f32_32x32x16_bf16 v[176:191], v[120:123], v[112:115], v[176:191]
    v_fma_f32 v97, v71, v245, -v69
    v_mul_f32 v69, v72, v245
    v_fma_f32 v98, v71, v249, v69
    v_fma_f32 v97, v73, v95, v97
    s_waitcnt lgkmcnt(11)
    v_mfma_f32_32x32x16_bf16 v[192:207], v[124:127], v[112:115], v[192:207]
    v_fma_f32 v97, -v74, v96, v97
    v_fma_f32 v98, v73, v96, v98
    v_fma_f32 v98, v74, v95, v98
    v_mul_f32 v69, v72, v250
    s_waitcnt lgkmcnt(9)
    v_mfma_f32_32x32x16_bf16 v[208:223], v[128:131], v[112:115], v[208:223]
    v_fma_f32 v99, v71, v246, -v69
    v_mul_f32 v69, v72, v246
    v_fma_f32 v100, v71, v250, v69
    v_fma_f32 v99, v73, v97, v99
    s_waitcnt lgkmcnt(0)
    s_waitcnt vmcnt(6)
    s_barrier
    v_add_u32 v229, 0xc000, v229
    v_add_u32 v230, 0xc000, v230
    v_add_u32 v231, 0xc000, v231
    v_add_u32 v232, 0xc000, v232
    v_add_u32 v233, 0xc000, v233
    v_add_u32 v234, 0xc000, v234
    v_add_u32 v235, 0xc000, v235
    v_add_u32 v236, 0xc000, v236
    ds_read_b128 v[112:115], v229
    ds_read_b64_tr_b16 v[116:117], v233 offset:0
    ds_read_b64_tr_b16 v[118:119], v233 offset:1024
    ds_read_b64_tr_b16 v[120:121], v234 offset:0
    ds_read_b64_tr_b16 v[122:123], v234 offset:1024
    ds_read_b64_tr_b16 v[124:125], v235 offset:0
    ds_read_b64_tr_b16 v[126:127], v235 offset:1024
    ds_read_b64_tr_b16 v[128:129], v236 offset:0
    ds_read_b64_tr_b16 v[130:131], v236 offset:1024
    v_mfma_f32_32x32x16_bf16 v[160:175], v[136:139], v[132:135], v[160:175]
    s_lshl_b32 s63, s3, 12
    s_add_u32 s63, s63, 0
    s_mov_b32 m0, s63
    s_add_u32 s63, s18, 384
    buffer_load_dwordx4 v224, s[20:23], s63 offen offset:0 lds
    v_fma_f32 v99, -v74, v98, v99
    v_fma_f32 v100, v73, v98, v100
    v_fma_f32 v100, v74, v97, v100
    v_mul_f32 v69, v72, v251
    v_mfma_f32_32x32x16_bf16 v[176:191], v[140:143], v[132:135], v[176:191]
    s_add_u32 s63, s18, 384
    buffer_load_dwordx4 v225, s[20:23], s63 offen offset:1024 lds
    v_fma_f32 v101, v71, v247, -v69
    v_mul_f32 v69, v72, v247
    v_fma_f32 v102, v71, v251, v69
    v_fma_f32 v101, v73, v99, v101
    v_mfma_f32_32x32x16_bf16 v[192:207], v[144:147], v[132:135], v[192:207]
    s_add_u32 s63, s18, 384
    buffer_load_dwordx4 v226, s[20:23], s63 offen offset:2048 lds
    v_fma_f32 v101, -v74, v100, v101
    v_fma_f32 v102, v73, v100, v102
    v_fma_f32 v102, v74, v99, v102
    v_mov_b32 v103, v101
    v_mfma_f32_32x32x16_bf16 v[208:223], v[148:151], v[132:135], v[208:223]
    s_add_u32 s63, s18, 384
    buffer_load_dwordx4 v227, s[20:23], s63 offen offset:3072 lds
    v_mov_b32 v104, v102
    v_subrev_u32 v14, 1, v1
    v_and_b32 v14, 63, v14
    v_lshlrev_b32 v14, 2, v14
    ds_read_b128 v[132:135], v230
    ds_read_b64_tr_b16 v[136:137], v233 offset:4096
    ds_read_b64_tr_b16 v[138:139], v233 offset:5120
    ds_read_b64_tr_b16 v[140:141], v234 offset:4096
    ds_read_b64_tr_b16 v[142:143], v234 offset:5120
    ds_read_b64_tr_b16 v[144:145], v235 offset:4096
    ds_read_b64_tr_b16 v[146:147], v235 offset:5120
    ds_read_b64_tr_b16 v[148:149], v236 offset:4096
    ds_read_b64_tr_b16 v[150:151], v236 offset:5120
    s_waitcnt lgkmcnt(15)
    v_mfma_f32_32x32x16_bf16 v[160:175], v[116:119], v[112:115], v[160:175]
    s_lshl_b32 s63, s3, 11
    s_add_u32 s63, s63, 32768
    s_mov_b32 m0, s63
    s_add_u32 s63, s19, 1572864
    buffer_load_dwordx4 v228, s[24:27], s63 offen offset:0 lds
    ds_bpermute_b32 v57, v14, v55
    ds_bpermute_b32 v58, v14, v56
    ds_bpermute_b32 v105, v14, v103
    ds_bpermute_b32 v106, v14, v104
    s_waitcnt lgkmcnt(15)
    v_mfma_f32_32x32x16_bf16 v[176:191], v[120:123], v[112:115], v[176:191]
    s_add_u32 s63, s19, 1604608
    buffer_load_dwordx4 v228, s[24:27], s63 offen offset:1024 lds
    v_cmp_le_u32 vcc, 1, v1
    s_nop 1
    s_waitcnt lgkmcnt(0)
    v_cndmask_b32 v57, 0, v57, vcc
    v_mfma_f32_32x32x16_bf16 v[192:207], v[124:127], v[112:115], v[192:207]
    v_cndmask_b32 v58, 0, v58, vcc
    v_cndmask_b32 v105, 0, v105, vcc
    v_cndmask_b32 v106, 0, v106, vcc
    v_fma_f32 v55, v31, v57, v55
    v_mfma_f32_32x32x16_bf16 v[208:223], v[128:131], v[112:115], v[208:223]
    v_fma_f32 v55, -v32, v58, v55
    v_fma_f32 v56, v31, v58, v56
    v_fma_f32 v56, v32, v57, v56
    v_fma_f32 v103, v79, v105, v103
    ds_read_b128 v[112:115], v231
    ds_read_b64_tr_b16 v[116:117], v233 offset:8192
    ds_read_b64_tr_b16 v[118:119], v233 offset:9216
    ds_read_b64_tr_b16 v[120:121], v234 offset:8192
    ds_read_b64_tr_b16 v[122:123], v234 offset:9216
    ds_read_b64_tr_b16 v[124:125], v235 offset:8192
    ds_read_b64_tr_b16 v[126:127], v235 offset:9216
    ds_read_b64_tr_b16 v[128:129], v236 offset:8192
    ds_read_b64_tr_b16 v[130:131], v236 offset:9216
    v_mfma_f32_32x32x16_bf16 v[160:175], v[136:139], v[132:135], v[160:175]
    v_fma_f32 v103, -v80, v106, v103
    v_fma_f32 v104, v79, v106, v104
    v_fma_f32 v104, v80, v105, v104
    v_subrev_u32 v14, 2, v1
    v_mfma_f32_32x32x16_bf16 v[176:191], v[140:143], v[132:135], v[176:191]
    v_and_b32 v14, 63, v14
    v_lshlrev_b32 v14, 2, v14
    ds_bpermute_b32 v57, v14, v55
    ds_bpermute_b32 v58, v14, v56
    v_mfma_f32_32x32x16_bf16 v[192:207], v[144:147], v[132:135], v[192:207]
    ds_bpermute_b32 v105, v14, v103
    ds_bpermute_b32 v106, v14, v104
    v_cmp_le_u32 vcc, 2, v1
    s_nop 1
    v_mfma_f32_32x32x16_bf16 v[208:223], v[148:151], v[132:135], v[208:223]
    s_waitcnt lgkmcnt(0)
    v_cndmask_b32 v57, 0, v57, vcc
    v_cndmask_b32 v58, 0, v58, vcc
    v_cndmask_b32 v105, 0, v105, vcc
    ds_read_b128 v[132:135], v232
    ds_read_b64_tr_b16 v[136:137], v233 offset:12288
    ds_read_b64_tr_b16 v[138:139], v233 offset:13312
    ds_read_b64_tr_b16 v[140:141], v234 offset:12288
    ds_read_b64_tr_b16 v[142:143], v234 offset:13312
    ds_read_b64_tr_b16 v[144:145], v235 offset:12288
    ds_read_b64_tr_b16 v[146:147], v235 offset:13312
    ds_read_b64_tr_b16 v[148:149], v236 offset:12288
    ds_read_b64_tr_b16 v[150:151], v236 offset:13312
    v_mfma_f32_32x32x16_bf16 v[160:175], v[116:119], v[112:115], v[160:175]
    v_cndmask_b32 v106, 0, v106, vcc
    v_fma_f32 v55, v33, v57, v55
    v_fma_f32 v55, -v34, v58, v55
    v_fma_f32 v56, v33, v58, v56
    v_mfma_f32_32x32x16_bf16 v[176:191], v[120:123], v[112:115], v[176:191]
    v_fma_f32 v56, v34, v57, v56
    v_fma_f32 v103, v81, v105, v103
    v_fma_f32 v103, -v82, v106, v103
    v_fma_f32 v104, v81, v106, v104
    v_mfma_f32_32x32x16_bf16 v[192:207], v[124:127], v[112:115], v[192:207]
    v_fma_f32 v104, v82, v105, v104
    v_subrev_u32 v14, 4, v1
    v_and_b32 v14, 63, v14
    v_lshlrev_b32 v14, 2, v14
    v_mfma_f32_32x32x16_bf16 v[208:223], v[128:131], v[112:115], v[208:223]
    ds_bpermute_b32 v57, v14, v55
    ds_bpermute_b32 v58, v14, v56
    ds_bpermute_b32 v105, v14, v103
    ds_bpermute_b32 v106, v14, v104
    s_waitcnt lgkmcnt(0)
    s_waitcnt vmcnt(6)
    s_barrier
    v_add_u32 v229, 0xc000, v229
    v_add_u32 v230, 0xc000, v230
    v_add_u32 v231, 0xc000, v231
    v_add_u32 v232, 0xc000, v232
    v_add_u32 v233, 0xc000, v233
    v_add_u32 v234, 0xc000, v234
    v_add_u32 v235, 0xc000, v235
    v_add_u32 v236, 0xc000, v236
    ds_read_b128 v[112:115], v229
    ds_read_b64_tr_b16 v[116:117], v233 offset:0
    ds_read_b64_tr_b16 v[118:119], v233 offset:1024
    ds_read_b64_tr_b16 v[120:121], v234 offset:0
    ds_read_b64_tr_b16 v[122:123], v234 offset:1024
    ds_read_b64_tr_b16 v[124:125], v235 offset:0
    ds_read_b64_tr_b16 v[126:127], v235 offset:1024
    ds_read_b64_tr_b16 v[128:129], v236 offset:0
    ds_read_b64_tr_b16 v[130:131], v236 offset:1024
    v_mfma_f32_32x32x16_bf16 v[160:175], v[136:139], v[132:135], v[160:175]
    s_lshl_b32 s63, s3, 12
    s_add_u32 s63, s63, 49152
    s_mov_b32 m0, s63
    s_add_u32 s63, s18, 512
    buffer_load_dwordx4 v224, s[20:23], s63 offen offset:0 lds
    v_cmp_le_u32 vcc, 4, v1
    s_nop 1
    v_cndmask_b32 v57, 0, v57, vcc
    v_mfma_f32_32x32x16_bf16 v[176:191], v[140:143], v[132:135], v[176:191]
    s_add_u32 s63, s18, 512
    buffer_load_dwordx4 v225, s[20:23], s63 offen offset:1024 lds
    v_cndmask_b32 v58, 0, v58, vcc
    v_cndmask_b32 v105, 0, v105, vcc
    v_cndmask_b32 v106, 0, v106, vcc
    v_fma_f32 v55, v35, v57, v55
    v_mfma_f32_32x32x16_bf16 v[192:207], v[144:147], v[132:135], v[192:207]
    s_add_u32 s63, s18, 512
    buffer_load_dwordx4 v226, s[20:23], s63 offen offset:2048 lds
    v_fma_f32 v55, -v36, v58, v55
    v_fma_f32 v56, v35, v58, v56
    v_fma_f32 v56, v36, v57, v56
    v_fma_f32 v103, v83, v105, v103
    v_mfma_f32_32x32x16_bf16 v[208:223], v[148:151], v[132:135], v[208:223]
    s_add_u32 s63, s18, 512
    buffer_load_dwordx4 v227, s[20:23], s63 offen offset:3072 lds
    v_fma_f32 v103, -v84, v106, v103
    v_fma_f32 v104, v83, v106, v104
    v_fma_f32 v104, v84, v105, v104
    v_subrev_u32 v14, 8, v1
    ds_read_b128 v[132:135], v230
    ds_read_b64_tr_b16 v[136:137], v233 offset:4096
    ds_read_b64_tr_b16 v[138:139], v233 offset:5120
    ds_read_b64_tr_b16 v[140:141], v234 offset:4096
    ds_read_b64_tr_b16 v[142:143], v234 offset:5120
    ds_read_b64_tr_b16 v[144:145], v235 offset:4096
    ds_read_b64_tr_b16 v[146:147], v235 offset:5120
    ds_read_b64_tr_b16 v[148:149], v236 offset:4096
    ds_read_b64_tr_b16 v[150:151], v236 offset:5120
    s_waitcnt lgkmcnt(15)
    v_mfma_f32_32x32x16_bf16 v[160:175], v[116:119], v[112:115], v[160:175]
    s_lshl_b32 s63, s3, 11
    s_add_u32 s63, s63, 81920
    s_mov_b32 m0, s63
    s_add_u32 s63, s19, 2097152
    buffer_load_dwordx4 v228, s[24:27], s63 offen offset:0 lds
    v_and_b32 v14, 63, v14
    v_lshlrev_b32 v14, 2, v14
    ds_bpermute_b32 v57, v14, v55
    ds_bpermute_b32 v58, v14, v56
    s_waitcnt lgkmcnt(15)
    v_mfma_f32_32x32x16_bf16 v[176:191], v[120:123], v[112:115], v[176:191]
    s_add_u32 s63, s19, 2128896
    buffer_load_dwordx4 v228, s[24:27], s63 offen offset:1024 lds
    ds_bpermute_b32 v105, v14, v103
    ds_bpermute_b32 v106, v14, v104
    v_cmp_le_u32 vcc, 8, v1
    s_nop 1
    s_waitcnt lgkmcnt(15)
    v_mfma_f32_32x32x16_bf16 v[192:207], v[124:127], v[112:115], v[192:207]
    s_waitcnt lgkmcnt(0)
    v_cndmask_b32 v57, 0, v57, vcc
    v_cndmask_b32 v58, 0, v58, vcc
    v_cndmask_b32 v105, 0, v105, vcc
    v_mfma_f32_32x32x16_bf16 v[208:223], v[128:131], v[112:115], v[208:223]
    v_cndmask_b32 v106, 0, v106, vcc
    v_fma_f32 v55, v37, v57, v55
    v_fma_f32 v55, -v38, v58, v55
    v_fma_f32 v56, v37, v58, v56
    ds_read_b128 v[112:115], v231
    ds_read_b64_tr_b16 v[116:117], v233 offset:8192
    ds_read_b64_tr_b16 v[118:119], v233 offset:9216
    ds_read_b64_tr_b16 v[120:121], v234 offset:8192
    ds_read_b64_tr_b16 v[122:123], v234 offset:9216
    ds_read_b64_tr_b16 v[124:125], v235 offset:8192
    ds_read_b64_tr_b16 v[126:127], v235 offset:9216
    ds_read_b64_tr_b16 v[128:129], v236 offset:8192
    ds_read_b64_tr_b16 v[130:131], v236 offset:9216
    v_mfma_f32_32x32x16_bf16 v[160:175], v[136:139], v[132:135], v[160:175]
    v_fma_f32 v56, v38, v57, v56
    v_fma_f32 v103, v85, v105, v103
    v_fma_f32 v103, -v86, v106, v103
    v_fma_f32 v104, v85, v106, v104
    v_mfma_f32_32x32x16_bf16 v[176:191], v[140:143], v[132:135], v[176:191]
    v_fma_f32 v104, v86, v105, v104
    v_subrev_u32 v14, 16, v1
    v_and_b32 v14, 63, v14
    v_lshlrev_b32 v14, 2, v14
    v_mfma_f32_32x32x16_bf16 v[192:207], v[144:147], v[132:135], v[192:207]
    ds_bpermute_b32 v57, v14, v55
    ds_bpermute_b32 v58, v14, v56
    ds_bpermute_b32 v105, v14, v103
    ds_bpermute_b32 v106, v14, v104
    v_mfma_f32_32x32x16_bf16 v[208:223], v[148:151], v[132:135], v[208:223]
    v_cmp_le_u32 vcc, 16, v1
    s_nop 1
    s_waitcnt lgkmcnt(0)
    v_cndmask_b32 v57, 0, v57, vcc
    ds_read_b128 v[132:135], v232
    ds_read_b64_tr_b16 v[136:137], v233 offset:12288
    ds_read_b64_tr_b16 v[138:139], v233 offset:13312
    ds_read_b64_tr_b16 v[140:141], v234 offset:12288
    ds_read_b64_tr_b16 v[142:143], v234 offset:13312
    ds_read_b64_tr_b16 v[144:145], v235 offset:12288
    ds_read_b64_tr_b16 v[146:147], v235 offset:13312
    ds_read_b64_tr_b16 v[148:149], v236 offset:12288
    ds_read_b64_tr_b16 v[150:151], v236 offset:13312
    v_mfma_f32_32x32x16_bf16 v[160:175], v[116:119], v[112:115], v[160:175]
    v_cndmask_b32 v58, 0, v58, vcc
    v_cndmask_b32 v105, 0, v105, vcc
    v_cndmask_b32 v106, 0, v106, vcc
    v_mfma_f32_32x32x16_bf16 v[176:191], v[120:123], v[112:115], v[176:191]
    v_fma_f32 v55, v39, v57, v55
    v_fma_f32 v55, -v40, v58, v55
    v_fma_f32 v56, v39, v58, v56
    v_mfma_f32_32x32x16_bf16 v[192:207], v[124:127], v[112:115], v[192:207]
    v_fma_f32 v56, v40, v57, v56
    v_fma_f32 v103, v87, v105, v103
    v_fma_f32 v103, -v88, v106, v103
    v_mfma_f32_32x32x16_bf16 v[208:223], v[128:131], v[112:115], v[208:223]
    v_fma_f32 v104, v87, v106, v104
    v_fma_f32 v104, v88, v105, v104
    v_subrev_u32 v14, 32, v1
    s_waitcnt lgkmcnt(0)
    s_waitcnt vmcnt(6)
    s_barrier
    v_subrev_u32 v229, 0x18000, v229
    v_subrev_u32 v230, 0x18000, v230
    v_subrev_u32 v231, 0x18000, v231
    v_subrev_u32 v232, 0x18000, v232
    v_subrev_u32 v233, 0x18000, v233
    v_subrev_u32 v234, 0x18000, v234
    v_subrev_u32 v235, 0x18000, v235
    v_subrev_u32 v236, 0x18000, v236
    ds_read_b128 v[112:115], v229
    ds_read_b64_tr_b16 v[116:117], v233 offset:0
    ds_read_b64_tr_b16 v[118:119], v233 offset:1024
    ds_read_b64_tr_b16 v[120:121], v234 offset:0
    ds_read_b64_tr_b16 v[122:123], v234 offset:1024
    ds_read_b64_tr_b16 v[124:125], v235 offset:0
    ds_read_b64_tr_b16 v[126:127], v235 offset:1024
    ds_read_b64_tr_b16 v[128:129], v236 offset:0
    ds_read_b64_tr_b16 v[130:131], v236 offset:1024
    v_mfma_f32_32x32x16_bf16 v[160:175], v[136:139], v[132:135], v[160:175]
    s_lshl_b32 s63, s3, 12
    s_add_u32 s63, s63, 98304
    s_mov_b32 m0, s63
    s_add_u32 s63, s18, 640
    buffer_load_dwordx4 v224, s[20:23], s63 offen offset:0 lds
    v_and_b32 v14, 63, v14
    v_lshlrev_b32 v14, 2, v14
    ds_bpermute_b32 v57, v14, v55
    v_mfma_f32_32x32x16_bf16 v[176:191], v[140:143], v[132:135], v[176:191]
    s_add_u32 s63, s18, 640
    buffer_load_dwordx4 v225, s[20:23], s63 offen offset:1024 lds
    ds_bpermute_b32 v58, v14, v56
    ds_bpermute_b32 v105, v14, v103
    ds_bpermute_b32 v106, v14, v104
    v_mfma_f32_32x32x16_bf16 v[192:207], v[144:147], v[132:135], v[192:207]
    s_add_u32 s63, s18, 640
    buffer_load_dwordx4 v226, s[20:23], s63 offen offset:2048 lds
    v_cmp_le_u32 vcc, 32, v1
    s_nop 1
    s_waitcnt lgkmcnt(0)
    v_mfma_f32_32x32x16_bf16 v[208:223], v[148:151], v[132:135], v[208:223]
    s_add_u32 s63, s18, 640
    buffer_load_dwordx4 v227, s[20:23], s63 offen offset:3072 lds
    v_cndmask_b32 v57, 0, v57, vcc
    v_cndmask_b32 v58, 0, v58, vcc
    v_cndmask_b32 v105, 0, v105, vcc
    ds_read_b128 v[132:135], v230
    ds_read_b64_tr_b16 v[136:137], v233 offset:4096
    ds_read_b64_tr_b16 v[138:139], v233 offset:5120
    ds_read_b64_tr_b16 v[140:141], v234 offset:4096
    ds_read_b64_tr_b16 v[142:143], v234 offset:5120
    ds_read_b64_tr_b16 v[144:145], v235 offset:4096
    ds_read_b64_tr_b16 v[146:147], v235 offset:5120
    ds_read_b64_tr_b16 v[148:149], v236 offset:4096
    ds_read_b64_tr_b16 v[150:151], v236 offset:5120
    v_mfma_f32_32x32x16_bf16 v[160:175], v[116:119], v[112:115], v[160:175]
    s_lshl_b32 s63, s3, 11
    s_add_u32 s63, s63, 131072
    s_mov_b32 m0, s63
    s_add_u32 s63, s19, 2621440
    buffer_load_dwordx4 v228, s[24:27], s63 offen offset:0 lds
    v_cndmask_b32 v106, 0, v106, vcc
    v_fma_f32 v55, v41, v57, v55
    v_fma_f32 v55, -v42, v58, v55
    v_mfma_f32_32x32x16_bf16 v[176:191], v[120:123], v[112:115], v[176:191]
    s_add_u32 s63, s19, 2653184
    buffer_load_dwordx4 v228, s[24:27], s63 offen offset:1024 lds
    v_fma_f32 v56, v41, v58, v56
    v_fma_f32 v56, v42, v57, v56
    v_fma_f32 v103, v89, v105, v103
    v_mfma_f32_32x32x16_bf16 v[192:207], v[124:127], v[112:115], v[192:207]
    v_fma_f32 v103, -v90, v106, v103
    v_fma_f32 v104, v89, v106, v104
    v_fma_f32 v104, v90, v105, v104
    v_mfma_f32_32x32x16_bf16 v[208:223], v[128:131], v[112:115], v[208:223]
    v_subrev_u32 v14, 1, v1
    v_and_b32 v14, 63, v14
    v_lshlrev_b32 v14, 2, v14
    ds_read_b128 v[112:115], v231
    ds_read_b64_tr_b16 v[116:117], v233 offset:8192
    ds_read_b64_tr_b16 v[118:119], v233 offset:9216
    ds_read_b64_tr_b16 v[120:121], v234 offset:8192
    ds_read_b64_tr_b16 v[122:123], v234 offset:9216
    ds_read_b64_tr_b16 v[124:125], v235 offset:8192
    ds_read_b64_tr_b16 v[126:127], v235 offset:9216
    ds_read_b64_tr_b16 v[128:129], v236 offset:8192
    ds_read_b64_tr_b16 v[130:131], v236 offset:9216
    s_waitcnt lgkmcnt(15)
    v_mfma_f32_32x32x16_bf16 v[160:175], v[136:139], v[132:135], v[160:175]
    ds_bpermute_b32 v59, v14, v55
    ds_bpermute_b32 v60, v14, v56
    ds_bpermute_b32 v107, v14, v103
    s_waitcnt lgkmcnt(15)
    v_mfma_f32_32x32x16_bf16 v[176:191], v[140:143], v[132:135], v[176:191]
    ds_bpermute_b32 v108, v14, v104
    v_cmp_le_u32 vcc, 1, v1
    s_nop 1
    s_waitcnt lgkmcnt(15)
    v_mfma_f32_32x32x16_bf16 v[192:207], v[144:147], v[132:135], v[192:207]
    s_waitcnt lgkmcnt(0)
    v_cndmask_b32 v59, 0, v59, vcc
    v_cndmask_b32 v60, 0, v60, vcc
    v_mfma_f32_32x32x16_bf16 v[208:223], v[148:151], v[132:135], v[208:223]
    v_cndmask_b32 v107, 0, v107, vcc
    v_cndmask_b32 v108, 0, v108, vcc
    s_nop 1
    ds_read_b128 v[132:135], v232
    ds_read_b64_tr_b16 v[136:137], v233 offset:12288
    ds_read_b64_tr_b16 v[138:139], v233 offset:13312
    ds_read_b64_tr_b16 v[140:141], v234 offset:12288
    ds_read_b64_tr_b16 v[142:143], v234 offset:13312
    ds_read_b64_tr_b16 v[144:145], v235 offset:12288
    ds_read_b64_tr_b16 v[146:147], v235 offset:13312
    ds_read_b64_tr_b16 v[148:149], v236 offset:12288
    ds_read_b64_tr_b16 v[150:151], v236 offset:13312
    v_mfma_f32_32x32x16_bf16 v[160:175], v[116:119], v[112:115], v[160:175]
    v_readlane_b32 s72, v55, 63
    v_readlane_b32 s73, v56, 63
    v_readlane_b32 s74, v103, 63
    v_mfma_f32_32x32x16_bf16 v[176:191], v[120:123], v[112:115], v[176:191]
    v_readlane_b32 s75, v104, 63
    s_lshl_b32 s76, s3, 11
    s_add_u32 s76, s76, 147456
    v_mfma_f32_32x32x16_bf16 v[192:207], v[124:127], v[112:115], v[192:207]
    v_mov_b32 v14, s76
    v_mov_b32 v152, s72
    v_mov_b32 v153, s73
    v_mfma_f32_32x32x16_bf16 v[208:223], v[128:131], v[112:115], v[208:223]
    v_mov_b32 v154, s74
    v_mov_b32 v155, s75
    ds_write_b128 v14, v[152:155]
    s_waitcnt lgkmcnt(0)
    s_waitcnt vmcnt(6)
    s_barrier
    v_add_u32 v229, 0xc000, v229
    v_add_u32 v230, 0xc000, v230
    v_add_u32 v231, 0xc000, v231
    v_add_u32 v232, 0xc000, v232
    v_add_u32 v233, 0xc000, v233
    v_add_u32 v234, 0xc000, v234
    v_add_u32 v235, 0xc000, v235
    v_add_u32 v236, 0xc000, v236
    ds_read_b128 v[112:115], v229
    ds_read_b64_tr_b16 v[116:117], v233 offset:0
    ds_read_b64_tr_b16 v[118:119], v233 offset:1024
    ds_read_b64_tr_b16 v[120:121], v234 offset:0
    ds_read_b64_tr_b16 v[122:123], v234 offset:1024
    ds_read_b64_tr_b16 v[124:125], v235 offset:0
    ds_read_b64_tr_b16 v[126:127], v235 offset:1024
    ds_read_b64_tr_b16 v[128:129], v236 offset:0
    ds_read_b64_tr_b16 v[130:131], v236 offset:1024
    v_mfma_f32_32x32x16_bf16 v[160:175], v[136:139], v[132:135], v[160:175]
    s_lshl_b32 s63, s3, 12
    s_add_u32 s63, s63, 0
    s_mov_b32 m0, s63
    s_add_u32 s63, s18, 768
    buffer_load_dwordx4 v224, s[20:23], s63 offen offset:0 lds
    v_mov_b32 v14, 0x24000
    ds_read_b128 v[152:155], v14 offset:0
    ds_read_b128 v[156:159], v14 offset:2048
    ds_read_b128 v[244:247], v14 offset:4096
    ds_read_b128 v[248:251], v14 offset:6144
    ds_read_b128 v[16:19], v14 offset:8192
    v_mfma_f32_32x32x16_bf16 v[176:191], v[140:143], v[132:135], v[176:191]
    s_add_u32 s63, s18, 768
    buffer_load_dwordx4 v225, s[20:23], s63 offen offset:1024 lds
    ds_read_b128 v[20:23], v14 offset:10240
    ds_read_b128 v[64:67], v14 offset:12288
    v_mov_b32 v61, 0
    v_mov_b32 v62, 0
    v_mov_b32 v109, 0
    v_mov_b32 v110, 0
    v_mfma_f32_32x32x16_bf16 v[192:207], v[144:147], v[132:135], v[192:207]
    s_add_u32 s63, s18, 768
    buffer_load_dwordx4 v226, s[20:23], s63 offen offset:2048 lds
    s_cmp_gt_u32 s3, 0
    s_cselect_b64 s[78:79], -1, 0
    s_waitcnt lgkmcnt(6)
    v_mov_b32 v57, v152
    v_mov_b32 v58, v153
    v_fma_f32 v57, v61, v43, v57
    v_fma_f32 v57, -v62, v44, v57
    v_mfma_f32_32x32x16_bf16 v[208:223], v[148:151], v[132:135], v[208:223]
    s_add_u32 s63, s18, 768
    buffer_load_dwordx4 v227, s[20:23], s63 offen offset:3072 lds
    v_fma_f32 v58, v61, v44, v58
    v_fma_f32 v58, v62, v43, v58
    v_cndmask_b32 v61, v61, v57, s[78:79]
    v_cndmask_b32 v62, v62, v58, s[78:79]
    v_mov_b32 v105, v154
    v_mov_b32 v106, v155
    ds_read_b128 v[132:135], v230
    ds_read_b64_tr_b16 v[136:137], v233 offset:4096
    ds_read_b64_tr_b16 v[138:139], v233 offset:5120
    ds_read_b64_tr_b16 v[140:141], v234 offset:4096
    ds_read_b64_tr_b16 v[142:143], v234 offset:5120
    ds_read_b64_tr_b16 v[144:145], v235 offset:4096
    ds_read_b64_tr_b16 v[146:147], v235 offset:5120
    ds_read_b64_tr_b16 v[148:149], v236 offset:4096
    ds_read_b64_tr_b16 v[150:151], v236 offset:5120
    v_mfma_f32_32x32x16_bf16 v[160:175], v[116:119], v[112:115], v[160:175]
    s_lshl_b32 s63, s3, 11
    s_add_u32 s63, s63, 32768
    s_mov_b32 m0, s63
    s_add_u32 s63, s19, 3145728
    buffer_load_dwordx4 v228, s[24:27], s63 offen offset:0 lds
    v_fma_f32 v105, v109, v91, v105
    v_fma_f32 v105, -v110, v92, v105
    v_fma_f32 v106, v109, v92, v106
    v_fma_f32 v106, v110, v91, v106
    v_cndmask_b32 v109, v109, v105, s[78:79]
    v_cndmask_b32 v110, v110, v106, s[78:79]
    v_mfma_f32_32x32x16_bf16 v[176:191], v[120:123], v[112:115], v[176:191]
    s_add_u32 s63, s19, 3177472
    buffer_load_dwordx4 v228, s[24:27], s63 offen offset:1024 lds
    s_cmp_gt_u32 s3, 1
    s_cselect_b64 s[78:79], -1, 0
    s_waitcnt lgkmcnt(14)
    v_mov_b32 v57, v156
    v_mov_b32 v58, v157
    v_fma_f32 v57, v61, v43, v57
    v_fma_f32 v57, -v62, v44, v57
    v_mfma_f32_32x32x16_bf16 v[192:207], v[124:127], v[112:115], v[192:207]
    v_fma_f32 v58, v61, v44, v58
    v_fma_f32 v58, v62, v43, v58
    v_cndmask_b32 v61, v61, v57, s[78:79]
    v_cndmask_b32 v62, v62, v58, s[78:79]
    v_mov_b32 v105, v158
    v_mov_b32 v106, v159
    v_mfma_f32_32x32x16_bf16 v[208:223], v[128:131], v[112:115], v[208:223]
    v_fma_f32 v105, v109, v91, v105
    v_fma_f32 v105, -v110, v92, v105
    v_fma_f32 v106, v109, v92, v106
    v_fma_f32 v106, v110, v91, v106
    v_cndmask_b32 v109, v109, v105, s[78:79]
    v_cndmask_b32 v110, v110, v106, s[78:79]
    ds_read_b128 v[112:115], v231
    ds_read_b64_tr_b16 v[116:117], v233 offset:8192
    ds_read_b64_tr_b16 v[118:119], v233 offset:9216
    ds_read_b64_tr_b16 v[120:121], v234 offset:8192
    ds_read_b64_tr_b16 v[122:123], v234 offset:9216
    ds_read_b64_tr_b16 v[124:125], v235 offset:8192
    ds_read_b64_tr_b16 v[126:127], v235 offset:9216
    ds_read_b64_tr_b16 v[128:129], v236 offset:8192
    ds_read_b64_tr_b16 v[130:131], v236 offset:9216
    s_waitcnt lgkmcnt(15)
    v_mfma_f32_32x32x16_bf16 v[160:175], v[136:139], v[132:135], v[160:175]
    s_cmp_gt_u32 s3, 2
    s_cselect_b64 s[78:79], -1, 0
    v_mov_b32 v57, v244
    v_mov_b32 v58, v245
    v_fma_f32 v57, v61, v43, v57
    v_fma_f32 v57, -v62, v44, v57
    s_waitcnt lgkmcnt(13)
    v_mfma_f32_32x32x16_bf16 v[176:191], v[140:143], v[132:135], v[176:191]
    v_fma_f32 v58, v61, v44, v58
    v_fma_f32 v58, v62, v43, v58
    v_cndmask_b32 v61, v61, v57, s[78:79]
    v_cndmask_b32 v62, v62, v58, s[78:79]
    v_mov_b32 v105, v246
    v_mov_b32 v106, v247
    s_waitcnt lgkmcnt(11)
    v_mfma_f32_32x32x16_bf16 v[192:207], v[144:147], v[132:135], v[192:207]
    v_fma_f32 v105, v109, v91, v105
    v_fma_f32 v105, -v110, v92, v105
    v_fma_f32 v106, v109, v92, v106
    v_fma_f32 v106, v110, v91, v106
    v_cndmask_b32 v109, v109, v105, s[78:79]
    v_cndmask_b32 v110, v110, v106, s[78:79]
    s_waitcnt lgkmcnt(9)
    v_mfma_f32_32x32x16_bf16 v[208:223], v[148:151], v[132:135], v[208:223]
    s_cmp_gt_u32 s3, 3
    s_cselect_b64 s[78:79], -1, 0
    v_mov_b32 v57, v248
    v_mov_b32 v58, v249
    v_fma_f32 v57, v61, v43, v57
    v_fma_f32 v57, -v62, v44, v57
    ds_read_b128 v[132:135], v232
    ds_read_b64_tr_b16 v[136:137], v233 offset:12288
    ds_read_b64_tr_b16 v[138:139], v233 offset:13312
    ds_read_b64_tr_b16 v[140:141], v234 offset:12288
    ds_read_b64_tr_b16 v[142:143], v234 offset:13312
    ds_read_b64_tr_b16 v[144:145], v235 offset:12288
    ds_read_b64_tr_b16 v[146:147], v235 offset:13312
    ds_read_b64_tr_b16 v[148:149], v236 offset:12288
    ds_read_b64_tr_b16 v[150:151], v236 offset:13312
    s_waitcnt lgkmcnt(15)
    v_mfma_f32_32x32x16_bf16 v[160:175], v[116:119], v[112:115], v[160:175]
    v_fma_f32 v58, v61, v44, v58
    v_fma_f32 v58, v62, v43, v58
    v_cndmask_b32 v61, v61, v57, s[78:79]
    v_cndmask_b32 v62, v62, v58, s[78:79]
    v_mov_b32 v105, v250
    v_mov_b32 v106, v251
    s_waitcnt lgkmcnt(13)
    v_mfma_f32_32x32x16_bf16 v[176:191], v[120:123], v[112:115], v[176:191]
    v_fma_f32 v105, v109, v91, v105
    v_fma_f32 v105, -v110, v92, v105
    v_fma_f32 v106, v109, v92, v106
    v_fma_f32 v106, v110, v91, v106
    v_cndmask_b32 v109, v109, v105, s[78:79]
    v_cndmask_b32 v110, v110, v106, s[78:79]
    s_waitcnt lgkmcnt(11)
    v_mfma_f32_32x32x16_bf16 v[192:207], v[124:127], v[112:115], v[192:207]
    s_cmp_gt_u32 s3, 4
    s_cselect_b64 s[78:79], -1, 0
    v_mov_b32 v57, v16
    v_mov_b32 v58, v17
    v_fma_f32 v57, v61, v43, v57
    v_fma_f32 v57, -v62, v44, v57
    s_waitcnt lgkmcnt(9)
    v_mfma_f32_32x32x16_bf16 v[208:223], v[128:131], v[112:115], v[208:223]
    v_fma_f32 v58, v61, v44, v58
    v_fma_f32 v58, v62, v43, v58
    v_cndmask_b32 v61, v61, v57, s[78:79]
    v_cndmask_b32 v62, v62, v58, s[78:79]
    v_mov_b32 v105, v18
    v_mov_b32 v106, v19
    s_waitcnt lgkmcnt(0)
    s_waitcnt vmcnt(6)
    s_barrier
    v_add_u32 v229, 0xc000, v229
    v_add_u32 v230, 0xc000, v230
    v_add_u32 v231, 0xc000, v231
    v_add_u32 v232, 0xc000, v232
    v_add_u32 v233, 0xc000, v233
    v_add_u32 v234, 0xc000, v234
    v_add_u32 v235, 0xc000, v235
    v_add_u32 v236, 0xc000, v236
    ds_read_b128 v[112:115], v229
    ds_read_b64_tr_b16 v[116:117], v233 offset:0
    ds_read_b64_tr_b16 v[118:119], v233 offset:1024
    ds_read_b64_tr_b16 v[120:121], v234 offset:0
    ds_read_b64_tr_b16 v[122:123], v234 offset:1024
    ds_read_b64_tr_b16 v[124:125], v235 offset:0
    ds_read_b64_tr_b16 v[126:127], v235 offset:1024
    ds_read_b64_tr_b16 v[128:129], v236 offset:0
    ds_read_b64_tr_b16 v[130:131], v236 offset:1024
    v_mfma_f32_32x32x16_bf16 v[160:175], v[136:139], v[132:135], v[160:175]
    s_lshl_b32 s63, s3, 12
    s_add_u32 s63, s63, 49152
    s_mov_b32 m0, s63
    s_add_u32 s63, s18, 896
    buffer_load_dwordx4 v224, s[20:23], s63 offen offset:0 lds
    v_fma_f32 v105, v109, v91, v105
    v_fma_f32 v105, -v110, v92, v105
    v_fma_f32 v106, v109, v92, v106
    v_fma_f32 v106, v110, v91, v106
    v_cndmask_b32 v109, v109, v105, s[78:79]
    v_cndmask_b32 v110, v110, v106, s[78:79]
    v_mfma_f32_32x32x16_bf16 v[176:191], v[140:143], v[132:135], v[176:191]
    s_add_u32 s63, s18, 896
    buffer_load_dwordx4 v225, s[20:23], s63 offen offset:1024 lds
    s_cmp_gt_u32 s3, 5
    s_cselect_b64 s[78:79], -1, 0
    v_mov_b32 v57, v20
    v_mov_b32 v58, v21
    v_fma_f32 v57, v61, v43, v57
    v_fma_f32 v57, -v62, v44, v57
    v_mfma_f32_32x32x16_bf16 v[192:207], v[144:147], v[132:135], v[192:207]
    s_add_u32 s63, s18, 896
    buffer_load_dwordx4 v226, s[20:23], s63 offen offset:2048 lds
    v_fma_f32 v58, v61, v44, v58
    v_fma_f32 v58, v62, v43, v58
    v_cndmask_b32 v61, v61, v57, s[78:79]
    v_cndmask_b32 v62, v62, v58, s[78:79]
    v_mov_b32 v105, v22
    v_mov_b32 v106, v23
    v_mfma_f32_32x32x16_bf16 v[208:223], v[148:151], v[132:135], v[208:223]
    s_add_u32 s63, s18, 896
    buffer_load_dwordx4 v227, s[20:23], s63 offen offset:3072 lds
    v_fma_f32 v105, v109, v91, v105
    v_fma_f32 v105, -v110, v92, v105
    v_fma_f32 v106, v109, v92, v106
    v_fma_f32 v106, v110, v91, v106
    v_cndmask_b32 v109, v109, v105, s[78:79]
    v_cndmask_b32 v110, v110, v106, s[78:79]
    ds_read_b128 v[132:135], v230
    ds_read_b64_tr_b16 v[136:137], v233 offset:4096
    ds_read_b64_tr_b16 v[138:139], v233 offset:5120
    ds_read_b64_tr_b16 v[140:141], v234 offset:4096
    ds_read_b64_tr_b16 v[142:143], v234 offset:5120
    ds_read_b64_tr_b16 v[144:145], v235 offset:4096
    ds_read_b64_tr_b16 v[146:147], v235 offset:5120
    ds_read_b64_tr_b16 v[148:149], v236 offset:4096
    ds_read_b64_tr_b16 v[150:151], v236 offset:5120
    s_waitcnt lgkmcnt(15)
    v_mfma_f32_32x32x16_bf16 v[160:175], v[116:119], v[112:115], v[160:175]
    s_lshl_b32 s63, s3, 11
    s_add_u32 s63, s63, 81920
    s_mov_b32 m0, s63
    s_add_u32 s63, s19, 3670016
    buffer_load_dwordx4 v228, s[24:27], s63 offen offset:0 lds
    s_cmp_gt_u32 s3, 6
    s_cselect_b64 s[78:79], -1, 0
    v_mov_b32 v57, v64
    v_mov_b32 v58, v65
    v_fma_f32 v57, v61, v43, v57
    v_fma_f32 v57, -v62, v44, v57
    s_waitcnt lgkmcnt(13)
    v_mfma_f32_32x32x16_bf16 v[176:191], v[120:123], v[112:115], v[176:191]
    s_add_u32 s63, s19, 3701760
    buffer_load_dwordx4 v228, s[24:27], s63 offen offset:1024 lds
    v_fma_f32 v58, v61, v44, v58
    v_fma_f32 v58, v62, v43, v58
    v_cndmask_b32 v61, v61, v57, s[78:79]
    v_cndmask_b32 v62, v62, v58, s[78:79]
    v_mov_b32 v105, v66
    v_mov_b32 v106, v67
    s_waitcnt lgkmcnt(11)
    v_mfma_f32_32x32x16_bf16 v[192:207], v[124:127], v[112:115], v[192:207]
    v_fma_f32 v105, v109, v91, v105
    v_fma_f32 v105, -v110, v92, v105
    v_fma_f32 v106, v109, v92, v106
    v_fma_f32 v106, v110, v91, v106
    v_cndmask_b32 v109, v109, v105, s[78:79]
    v_cndmask_b32 v110, v110, v106, s[78:79]
    s_waitcnt lgkmcnt(9)
    v_mfma_f32_32x32x16_bf16 v[208:223], v[128:131], v[112:115], v[208:223]
    v_fma_f32 v59, v45, v61, v59
    v_fma_f32 v59, -v46, v62, v59
    v_fma_f32 v60, v45, v62, v60
    v_fma_f32 v60, v46, v61, v60
    v_fma_f32 v47, v25, v59, v47
    v_fma_f32 v47, -v26, v60, v47
    ds_read_b128 v[112:115], v231
    ds_read_b64_tr_b16 v[116:117], v233 offset:8192
    ds_read_b64_tr_b16 v[118:119], v233 offset:9216
    ds_read_b64_tr_b16 v[120:121], v234 offset:8192
    ds_read_b64_tr_b16 v[122:123], v234 offset:9216
    ds_read_b64_tr_b16 v[124:125], v235 offset:8192
    ds_read_b64_tr_b16 v[126:127], v235 offset:9216
    ds_read_b64_tr_b16 v[128:129], v236 offset:8192
    ds_read_b64_tr_b16 v[130:131], v236 offset:9216
    s_waitcnt lgkmcnt(15)
    v_mfma_f32_32x32x16_bf16 v[160:175], v[136:139], v[132:135], v[160:175]
    v_fma_f32 v48, v25, v60, v48
    v_fma_f32 v48, v26, v59, v48
    v_fma_f32 v49, v27, v59, v49
    v_fma_f32 v49, -v28, v60, v49
    v_fma_f32 v50, v27, v60, v50
    v_fma_f32 v50, v28, v59, v50
    s_waitcnt lgkmcnt(13)
    v_mfma_f32_32x32x16_bf16 v[176:191], v[140:143], v[132:135], v[176:191]
    v_fma_f32 v51, v29, v59, v51
    v_fma_f32 v51, -v30, v60, v51
    v_fma_f32 v52, v29, v60, v52
    v_fma_f32 v52, v30, v59, v52
    v_fma_f32 v53, v31, v59, v53
    v_fma_f32 v53, -v32, v60, v53
    s_waitcnt lgkmcnt(11)
    v_mfma_f32_32x32x16_bf16 v[192:207], v[144:147], v[132:135], v[192:207]
    v_fma_f32 v54, v31, v60, v54
    v_fma_f32 v54, v32, v59, v54
    v_fma_f32 v107, v93, v109, v107
    v_fma_f32 v107, -v94, v110, v107
    v_fma_f32 v108, v93, v110, v108
    s_waitcnt lgkmcnt(9)
    v_mfma_f32_32x32x16_bf16 v[208:223], v[148:151], v[132:135], v[208:223]
    v_fma_f32 v108, v94, v109, v108
    v_fma_f32 v95, v73, v107, v95
    v_fma_f32 v95, -v74, v108, v95
    v_fma_f32 v96, v73, v108, v96
    v_fma_f32 v96, v74, v107, v96
    ds_read_b128 v[132:135], v232
    ds_read_b64_tr_b16 v[136:137], v233 offset:12288
    ds_read_b64_tr_b16 v[138:139], v233 offset:13312
    ds_read_b64_tr_b16 v[140:141], v234 offset:12288
    ds_read_b64_tr_b16 v[142:143], v234 offset:13312
    ds_read_b64_tr_b16 v[144:145], v235 offset:12288
    ds_read_b64_tr_b16 v[146:147], v235 offset:13312
    ds_read_b64_tr_b16 v[148:149], v236 offset:12288
    ds_read_b64_tr_b16 v[150:151], v236 offset:13312
    s_waitcnt lgkmcnt(15)
    v_mfma_f32_32x32x16_bf16 v[160:175], v[116:119], v[112:115], v[160:175]
    v_fma_f32 v97, v75, v107, v97
    v_fma_f32 v97, -v76, v108, v97
    v_fma_f32 v98, v75, v108, v98
    v_fma_f32 v98, v76, v107, v98
    v_fma_f32 v99, v77, v107, v99
    s_waitcnt lgkmcnt(13)
    v_mfma_f32_32x32x16_bf16 v[176:191], v[120:123], v[112:115], v[176:191]
    v_fma_f32 v99, -v78, v108, v99
    v_fma_f32 v100, v77, v108, v100
    v_fma_f32 v100, v78, v107, v100
    v_fma_f32 v101, v79, v107, v101
    v_fma_f32 v101, -v80, v108, v101
    s_waitcnt lgkmcnt(11)
    v_mfma_f32_32x32x16_bf16 v[192:207], v[124:127], v[112:115], v[192:207]
    v_fma_f32 v102, v79, v108, v102
    v_fma_f32 v102, v80, v107, v102
    v_cvt_pk_bf16_f32 v244, v47, v95
    v_cvt_pk_bf16_f32 v245, -v48, -v96
    v_cvt_pk_bf16_f32 v246, v49, v97
    s_waitcnt lgkmcnt(9)
    v_mfma_f32_32x32x16_bf16 v[208:223], v[128:131], v[112:115], v[208:223]
    v_cvt_pk_bf16_f32 v247, -v50, -v98
    v_cvt_pk_bf16_f32 v248, v51, v99
    v_cvt_pk_bf16_f32 v249, -v52, -v100
    v_cvt_pk_bf16_f32 v250, v53, v101
    v_cvt_pk_bf16_f32 v251, -v54, -v102
    s_waitcnt lgkmcnt(0)
    s_waitcnt vmcnt(6)
    s_barrier
    s_cmp_eq_u32 s7, 0
    s_cbranch_scc1 L_k2_nt0
    s_cmp_eq_u32 s39, 0
    s_cbranch_scc1 L_k2_nodma_1
    s_lshl_b32 s45, s38, 14
    s_add_u32 s46, s45, s36
    s_mov_b32 m0, s40
    s_add_u32 s45, s45, s37
    buffer_load_dwordx4 v6, s[32:35], s46 offen offset:0 lds
    buffer_load_dwordx4 v6, s[32:35], s46 offen offset:1024 lds
    buffer_load_dwordx4 v6, s[32:35], s46 offen offset:2048 lds
    buffer_load_dwordx4 v6, s[32:35], s46 offen offset:3072 lds
    s_mov_b32 m0, s41
    s_sub_u32 s39, s39, 1
    buffer_load_dwordx4 v6, s[32:35], s45 offen offset:0 lds
    buffer_load_dwordx4 v6, s[32:35], s45 offen offset:1024 lds
    buffer_load_dwordx4 v6, s[32:35], s45 offen offset:2048 lds
    buffer_load_dwordx4 v6, s[32:35], s45 offen offset:3072 lds
    s_add_u32 s38, s38, 1
L_k2_nodma_1:
    s_xor_b32 s40, s40, 0x8000
    s_xor_b32 s41, s41, 0x8000
L_k2_nt0:
    v_subrev_u32 v229, 0x18000, v229
    v_subrev_u32 v230, 0x18000, v230
    v_subrev_u32 v231, 0x18000, v231
    v_subrev_u32 v232, 0x18000, v232
    v_subrev_u32 v233, 0x18000, v233
    v_subrev_u32 v234, 0x18000, v234
    v_subrev_u32 v235, 0x18000, v235
    v_subrev_u32 v236, 0x18000, v236
    ds_read_b128 v[112:115], v229
    ds_read_b64_tr_b16 v[116:117], v233 offset:0
    ds_read_b64_tr_b16 v[118:119], v233 offset:1024
    ds_read_b64_tr_b16 v[120:121], v234 offset:0
    ds_read_b64_tr_b16 v[122:123], v234 offset:1024
    ds_read_b64_tr_b16 v[124:125], v235 offset:0
    ds_read_b64_tr_b16 v[126:127], v235 offset:1024
    ds_read_b64_tr_b16 v[128:129], v236 offset:0
    ds_read_b64_tr_b16 v[130:131], v236 offset:1024
    v_mfma_f32_32x32x16_bf16 v[160:175], v[136:139], v[132:135], v[160:175]
    s_lshl_b32 s76, s3, 11
    s_add_u32 s76, s76, 147456
    v_mfma_f32_32x32x16_bf16 v[176:191], v[140:143], v[132:135], v[176:191]
    v_lshlrev_b32 v14, 5, v1
    v_add_u32 v14, s76, v14
    v_mfma_f32_32x32x16_bf16 v[192:207], v[144:147], v[132:135], v[192:207]
    ds_write_b128 v14, v[244:247]
    ds_write_b128 v14, v[248:251] offset:16
    v_mfma_f32_32x32x16_bf16 v[208:223], v[148:151], v[132:135], v[208:223]
    v_lshlrev_b32 v15, 3, v1
    ds_read_b128 v[132:135], v230
    ds_read_b64_tr_b16 v[136:137], v233 offset:4096
    ds_read_b64_tr_b16 v[138:139], v233 offset:5120
    ds_read_b64_tr_b16 v[140:141], v234 offset:4096
    ds_read_b64_tr_b16 v[142:143], v234 offset:5120
    ds_read_b64_tr_b16 v[144:145], v235 offset:4096
    ds_read_b64_tr_b16 v[146:147], v235 offset:5120
    ds_read_b64_tr_b16 v[148:149], v236 offset:4096
    ds_read_b64_tr_b16 v[150:151], v236 offset:5120
    s_waitcnt lgkmcnt(15)
    v_mfma_f32_32x32x16_bf16 v[160:175], v[116:119], v[112:115], v[160:175]
    v_add_u32 v15, s76, v15
    v_mfma_f32_32x32x16_bf16 v[176:191], v[120:123], v[112:115], v[176:191]
    s_waitcnt lgkmcnt(9)
    v_mfma_f32_32x32x16_bf16 v[192:207], v[124:127], v[112:115], v[192:207]
    ds_read_b64 v[152:153], v15 offset:0
    v_mfma_f32_32x32x16_bf16 v[208:223], v[128:131], v[112:115], v[208:223]
    ds_read_b64 v[154:155], v15 offset:512
    ds_read_b128 v[112:115], v231
    ds_read_b64_tr_b16 v[116:117], v233 offset:8192
    ds_read_b64_tr_b16 v[118:119], v233 offset:9216
    ds_read_b64_tr_b16 v[120:121], v234 offset:8192
    ds_read_b64_tr_b16 v[122:123], v234 offset:9216
    ds_read_b64_tr_b16 v[124:125], v235 offset:8192
    ds_read_b64_tr_b16 v[126:127], v235 offset:9216
    ds_read_b64_tr_b16 v[128:129], v236 offset:8192
    ds_read_b64_tr_b16 v[130:131], v236 offset:9216
    s_waitcnt lgkmcnt(15)
    v_mfma_f32_32x32x16_bf16 v[160:175], v[136:139], v[132:135], v[160:175]
    ds_read_b64 v[156:157], v15 offset:1024
    v_mfma_f32_32x32x16_bf16 v[176:191], v[140:143], v[132:135], v[176:191]
    ds_read_b64 v[158:159], v15 offset:1536
    s_waitcnt lgkmcnt(15)
    v_mfma_f32_32x32x16_bf16 v[192:207], v[144:147], v[132:135], v[192:207]
    v_lshlrev_b32 v14, 16, v3
    s_waitcnt lgkmcnt(13)
    v_mfma_f32_32x32x16_bf16 v[208:223], v[148:151], v[132:135], v[208:223]
    v_lshl_add_u32 v14, v2, 4, v14
    ds_read_b128 v[132:135], v232
    ds_read_b64_tr_b16 v[136:137], v233 offset:12288
    ds_read_b64_tr_b16 v[138:139], v233 offset:13312
    ds_read_b64_tr_b16 v[140:141], v234 offset:12288
    ds_read_b64_tr_b16 v[142:143], v234 offset:13312
    ds_read_b64_tr_b16 v[144:145], v235 offset:12288
    ds_read_b64_tr_b16 v[146:147], v235 offset:13312
    ds_read_b64_tr_b16 v[148:149], v236 offset:12288
    ds_read_b64_tr_b16 v[150:151], v236 offset:13312
    s_waitcnt lgkmcnt(15)
    v_mfma_f32_32x32x16_bf16 v[160:175], v[116:119], v[112:115], v[160:175]
    s_lshr_b32 s76, s2, 2
    v_mfma_f32_32x32x16_bf16 v[176:191], v[120:123], v[112:115], v[176:191]
    s_lshl_b32 s76, s76, 10
    s_waitcnt lgkmcnt(13)
    v_mfma_f32_32x32x16_bf16 v[192:207], v[124:127], v[112:115], v[192:207]
    s_lshr_b32 s77, s2, 1
    s_waitcnt lgkmcnt(11)
    v_mfma_f32_32x32x16_bf16 v[208:223], v[128:131], v[112:115], v[208:223]
    s_and_b32 s77, s77, 1
    s_waitcnt lgkmcnt(0)
    s_waitcnt vmcnt(0)
    s_barrier
    s_cmp_eq_u32 s7, 0
    s_cbranch_scc0 L_k2_nt17
    s_cmp_eq_u32 s39, 0
    s_cbranch_scc1 L_k2_nodma_2
    s_lshl_b32 s45, s38, 14
    s_add_u32 s46, s45, s36
    s_mov_b32 m0, s40
    s_add_u32 s45, s45, s37
    buffer_load_dwordx4 v6, s[32:35], s46 offen offset:0 lds
    buffer_load_dwordx4 v6, s[32:35], s46 offen offset:1024 lds
    buffer_load_dwordx4 v6, s[32:35], s46 offen offset:2048 lds
    buffer_load_dwordx4 v6, s[32:35], s46 offen offset:3072 lds
    s_mov_b32 m0, s41
    s_sub_u32 s39, s39, 1
    buffer_load_dwordx4 v6, s[32:35], s45 offen offset:0 lds
    buffer_load_dwordx4 v6, s[32:35], s45 offen offset:1024 lds
    buffer_load_dwordx4 v6, s[32:35], s45 offen offset:2048 lds
    buffer_load_dwordx4 v6, s[32:35], s45 offen offset:3072 lds
    s_add_u32 s38, s38, 1
L_k2_nodma_2:
    s_xor_b32 s40, s40, 0x8000
    s_xor_b32 s41, s41, 0x8000
L_k2_nt17:
    v_add_u32 v229, 0xc000, v229
    v_add_u32 v230, 0xc000, v230
    v_add_u32 v231, 0xc000, v231
    v_add_u32 v232, 0xc000, v232
    v_add_u32 v233, 0xc000, v233
    v_add_u32 v234, 0xc000, v234
    v_add_u32 v235, 0xc000, v235
    v_add_u32 v236, 0xc000, v236
    ds_read_b128 v[112:115], v229
    ds_read_b64_tr_b16 v[116:117], v233 offset:0
    ds_read_b64_tr_b16 v[118:119], v233 offset:1024
    ds_read_b64_tr_b16 v[120:121], v234 offset:0
    ds_read_b64_tr_b16 v[122:123], v234 offset:1024
    ds_read_b64_tr_b16 v[124:125], v235 offset:0
    ds_read_b64_tr_b16 v[126:127], v235 offset:1024
    ds_read_b64_tr_b16 v[128:129], v236 offset:0
    ds_read_b64_tr_b16 v[130:131], v236 offset:1024
    v_mfma_f32_32x32x16_bf16 v[160:175], v[136:139], v[132:135], v[160:175]
    s_lshl_b32 s77, s77, 9
    v_mfma_f32_32x32x16_bf16 v[176:191], v[140:143], v[132:135], v[176:191]
    s_add_u32 s76, s76, s77
    v_mfma_f32_32x32x16_bf16 v[192:207], v[144:147], v[132:135], v[192:207]
    s_and_b32 s77, s2, 1
    v_mfma_f32_32x32x16_bf16 v[208:223], v[148:151], v[132:135], v[208:223]
    s_lshl_b32 s77, s77, 3
    ds_read_b128 v[132:135], v230
    ds_read_b64_tr_b16 v[136:137], v233 offset:4096
    ds_read_b64_tr_b16 v[138:139], v233 offset:5120
    ds_read_b64_tr_b16 v[140:141], v234 offset:4096
    ds_read_b64_tr_b16 v[142:143], v234 offset:5120
    ds_read_b64_tr_b16 v[144:145], v235 offset:4096
    ds_read_b64_tr_b16 v[146:147], v235 offset:5120
    ds_read_b64_tr_b16 v[148:149], v236 offset:4096
    ds_read_b64_tr_b16 v[150:151], v236 offset:5120
    s_waitcnt lgkmcnt(15)
    v_mfma_f32_32x32x16_bf16 v[160:175], v[116:119], v[112:115], v[160:175]
    s_add_u32 s76, s76, s77
    s_waitcnt lgkmcnt(13)
    v_mfma_f32_32x32x16_bf16 v[176:191], v[120:123], v[112:115], v[176:191]
    s_lshl_b32 s77, s3, 19
    s_waitcnt lgkmcnt(11)
    v_mfma_f32_32x32x16_bf16 v[192:207], v[124:127], v[112:115], v[192:207]
    s_add_u32 s76, s76, s77
    s_waitcnt lgkmcnt(9)
    v_mfma_f32_32x32x16_bf16 v[208:223], v[128:131], v[112:115], v[208:223]
    s_add_u32 s76, s76, 0x4800000
    ds_read_b128 v[112:115], v231
    ds_read_b64_tr_b16 v[116:117], v233 offset:8192
    ds_read_b64_tr_b16 v[118:119], v233 offset:9216
    ds_read_b64_tr_b16 v[120:121], v234 offset:8192
    ds_read_b64_tr_b16 v[122:123], v234 offset:9216
    ds_read_b64_tr_b16 v[124:125], v235 offset:8192
    ds_read_b64_tr_b16 v[126:127], v235 offset:9216
    ds_read_b64_tr_b16 v[128:129], v236 offset:8192
    ds_read_b64_tr_b16 v[130:131], v236 offset:9216
    s_waitcnt lgkmcnt(15)
    v_mfma_f32_32x32x16_bf16 v[160:175], v[136:139], v[132:135], v[160:175]
    s_add_u32 s77, s76, 0
    s_waitcnt lgkmcnt(13)
    v_mfma_f32_32x32x16_bf16 v[176:191], v[140:143], v[132:135], v[176:191]
    s_waitcnt lgkmcnt(11)
    v_mfma_f32_32x32x16_bf16 v[192:207], v[144:147], v[132:135], v[192:207]
    buffer_store_dwordx2 v[152:153], v14, s[32:35], s77 offen
    s_waitcnt lgkmcnt(9)
    v_mfma_f32_32x32x16_bf16 v[208:223], v[148:151], v[132:135], v[208:223]
    s_add_u32 s77, s76, 131072
    ds_read_b128 v[132:135], v232
    ds_read_b64_tr_b16 v[136:137], v233 offset:12288
    ds_read_b64_tr_b16 v[138:139], v233 offset:13312
    ds_read_b64_tr_b16 v[140:141], v234 offset:12288
    ds_read_b64_tr_b16 v[142:143], v234 offset:13312
    ds_read_b64_tr_b16 v[144:145], v235 offset:12288
    ds_read_b64_tr_b16 v[146:147], v235 offset:13312
    ds_read_b64_tr_b16 v[148:149], v236 offset:12288
    ds_read_b64_tr_b16 v[150:151], v236 offset:13312
    s_waitcnt lgkmcnt(15)
    v_mfma_f32_32x32x16_bf16 v[160:175], v[116:119], v[112:115], v[160:175]
    s_waitcnt lgkmcnt(13)
    v_mfma_f32_32x32x16_bf16 v[176:191], v[120:123], v[112:115], v[176:191]
    buffer_store_dwordx2 v[154:155], v14, s[32:35], s77 offen
    s_waitcnt lgkmcnt(11)
    v_mfma_f32_32x32x16_bf16 v[192:207], v[124:127], v[112:115], v[192:207]
    s_add_u32 s77, s76, 262144
    s_waitcnt lgkmcnt(9)
    v_mfma_f32_32x32x16_bf16 v[208:223], v[128:131], v[112:115], v[208:223]
    s_waitcnt lgkmcnt(8)
    s_waitcnt lgkmcnt(6)
    v_mfma_f32_32x32x16_bf16 v[160:175], v[136:139], v[132:135], v[160:175]
    buffer_store_dwordx2 v[156:157], v14, s[32:35], s77 offen
    s_waitcnt lgkmcnt(4)
    v_mfma_f32_32x32x16_bf16 v[176:191], v[140:143], v[132:135], v[176:191]
    s_add_u32 s77, s76, 393216
    s_waitcnt lgkmcnt(2)
    v_mfma_f32_32x32x16_bf16 v[192:207], v[144:147], v[132:135], v[192:207]
    s_waitcnt lgkmcnt(0)
    v_mfma_f32_32x32x16_bf16 v[208:223], v[148:151], v[132:135], v[208:223]
    buffer_store_dwordx2 v[158:159], v14, s[32:35], s77 offen
    s_waitcnt vmcnt(4)
    s_barrier
    s_cmp_eq_u32 s39, 0
    s_cbranch_scc1 L_k2_nodma_3
    s_lshl_b32 s45, s38, 14
    s_add_u32 s46, s45, s36
    s_mov_b32 m0, s40
    s_add_u32 s45, s45, s37
    buffer_load_dwordx4 v6, s[32:35], s46 offen offset:0 lds
    buffer_load_dwordx4 v6, s[32:35], s46 offen offset:1024 lds
    buffer_load_dwordx4 v6, s[32:35], s46 offen offset:2048 lds
    buffer_load_dwordx4 v6, s[32:35], s46 offen offset:3072 lds
    s_mov_b32 m0, s41
    s_sub_u32 s39, s39, 1
    buffer_load_dwordx4 v6, s[32:35], s45 offen offset:0 lds
    buffer_load_dwordx4 v6, s[32:35], s45 offen offset:1024 lds
    buffer_load_dwordx4 v6, s[32:35], s45 offen offset:2048 lds
    buffer_load_dwordx4 v6, s[32:35], s45 offen offset:3072 lds
    s_add_u32 s38, s38, 1
L_k2_nodma_3:
    s_xor_b32 s40, s40, 0x8000
    s_xor_b32 s41, s41, 0x8000
    s_nop 9
    v_cvt_pk_bf16_f32 v16, v160, v161
    v_cvt_pk_bf16_f32 v17, v162, v163
    v_cvt_pk_bf16_f32 v18, v164, v165
    v_cvt_pk_bf16_f32 v19, v166, v167
    v_cvt_pk_bf16_f32 v20, v168, v169
    v_cvt_pk_bf16_f32 v21, v170, v171
    v_cvt_pk_bf16_f32 v22, v172, v173
    v_cvt_pk_bf16_f32 v23, v174, v175
    v_cvt_pk_bf16_f32 v24, v176, v177
    v_cvt_pk_bf16_f32 v25, v178, v179
    v_cvt_pk_bf16_f32 v26, v180, v181
    v_cvt_pk_bf16_f32 v27, v182, v183
    v_cvt_pk_bf16_f32 v28, v184, v185
    v_cvt_pk_bf16_f32 v29, v186, v187
    v_cvt_pk_bf16_f32 v30, v188, v189
    v_cvt_pk_bf16_f32 v31, v190, v191
    v_cvt_pk_bf16_f32 v32, v192, v193
    v_cvt_pk_bf16_f32 v33, v194, v195
    v_cvt_pk_bf16_f32 v34, v196, v197
    v_cvt_pk_bf16_f32 v35, v198, v199
    v_cvt_pk_bf16_f32 v36, v200, v201
    v_cvt_pk_bf16_f32 v37, v202, v203
    v_cvt_pk_bf16_f32 v38, v204, v205
    v_cvt_pk_bf16_f32 v39, v206, v207
    v_cvt_pk_bf16_f32 v40, v208, v209
    v_cvt_pk_bf16_f32 v41, v210, v211
    v_cvt_pk_bf16_f32 v42, v212, v213
    v_cvt_pk_bf16_f32 v43, v214, v215
    v_cvt_pk_bf16_f32 v44, v216, v217
    v_cvt_pk_bf16_f32 v45, v218, v219
    v_cvt_pk_bf16_f32 v46, v220, v221
    v_cvt_pk_bf16_f32 v47, v222, v223
    s_cmp_eq_u32 s7, 0
    s_cbranch_scc1 L_k2_noqst
    s_lshl_b32 s46, s4, 13
    s_add_u32 s46, s46, 131072
    v_add_u32 v13, s46, v4
    ds_write_b128 v13, v[16:19] offset:0
    ds_write_b128 v13, v[20:23] offset:1024
    ds_write_b128 v13, v[24:27] offset:2048
    ds_write_b128 v13, v[28:31] offset:3072
    ds_write_b128 v13, v[32:35] offset:4096
    ds_write_b128 v13, v[36:39] offset:5120
    ds_write_b128 v13, v[40:43] offset:6144
    ds_write_b128 v13, v[44:47] offset:7168
L_k2_noqst:
    s_mov_b32 s30, 0
    v_mov_b32 v224, 0
    v_mov_b32 v225, 0
    v_mov_b32 v226, 0
    v_mov_b32 v227, 0
    v_mov_b32 v228, 0
    v_mov_b32 v229, 0
    v_mov_b32 v230, 0
    v_mov_b32 v231, 0
    v_mov_b32 v232, 0
    v_mov_b32 v233, 0
    v_mov_b32 v234, 0
    v_mov_b32 v235, 0
    v_mov_b32 v236, 0
    v_mov_b32 v237, 0
    v_mov_b32 v238, 0
    v_mov_b32 v239, 0
    v_mov_b32 v7, 0
    v_mov_b32 v248, 0
    v_mov_b32 v249, 0
    s_mov_b32 s49, 1
    s_mov_b32 s50, 0xff61b1e6
L_k2_prodone:
    ds_read_b128 v[96:99], v5 offset:0
    ds_read_b128 v[100:103], v5 offset:1024
    ds_read_b128 v[104:107], v5 offset:2048
    ds_read_b128 v[108:111], v5 offset:3072
    ds_read_b128 v[112:115], v5 offset:4096
    ds_read_b128 v[116:119], v5 offset:5120
    ds_read_b128 v[120:123], v5 offset:6144
    ds_read_b128 v[124:127], v5 offset:7168
    ds_read_b128 v[128:131], v5 offset:8192
    ds_read_b128 v[132:135], v5 offset:9216
    ds_read_b128 v[136:139], v5 offset:10240
    ds_read_b128 v[140:143], v5 offset:11264
    ds_read_b128 v[144:147], v5 offset:12288
    ds_read_b128 v[148:151], v5 offset:13312
    ds_read_b128 v[152:155], v5 offset:14336
    ds_read_b128 v[156:159], v5 offset:15360
    s_cmp_eq_u32 s7, 0
    s_cbranch_scc0 L_k2_groupB
    s_lshl_b32 s43, s6, 1
    s_cmp_lt_i32 s43, 1
    s_cbranch_scc1 L_k2_loopdone_5
L_k2_loop_4:
    s_waitcnt lgkmcnt(15)
    v_mfma_f32_32x32x16_bf16 v[48:63], v[96:99], v[16:19], v[224:239]
    ds_read_b128 v[96:99], v5 offset:16384
    s_waitcnt lgkmcnt(15)
    v_mfma_f32_32x32x16_bf16 v[48:63], v[100:103], v[20:23], v[48:63]
    ds_read_b128 v[100:103], v5 offset:20480
    s_waitcnt lgkmcnt(15)
    v_mfma_f32_32x32x16_bf16 v[48:63], v[104:107], v[24:27], v[48:63]
    ds_read_b128 v[104:107], v5 offset:24576
    s_waitcnt lgkmcnt(15)
    v_mfma_f32_32x32x16_bf16 v[48:63], v[108:111], v[28:31], v[48:63]
    ds_read_b128 v[108:111], v5 offset:28672
    s_waitcnt lgkmcnt(15)
    v_mfma_f32_32x32x16_bf16 v[48:63], v[112:115], v[32:35], v[48:63]
    ds_read_b128 v[112:115], v5 offset:17408
    s_waitcnt lgkmcnt(15)
    v_mfma_f32_32x32x16_bf16 v[48:63], v[116:119], v[36:39], v[48:63]
    ds_read_b128 v[116:119], v5 offset:21504
    s_waitcnt lgkmcnt(15)
    v_mfma_f32_32x32x16_bf16 v[48:63], v[120:123], v[40:43], v[48:63]
    ds_read_b128 v[120:123], v5 offset:25600
    s_waitcnt lgkmcnt(15)
    v_mfma_f32_32x32x16_bf16 v[48:63], v[124:127], v[44:47], v[48:63]
    ds_read_b128 v[124:127], v5 offset:29696
    s_waitcnt lgkmcnt(15)
    v_mfma_f32_32x32x16_bf16 v[64:79], v[128:131], v[16:19], v[224:239]
    ds_read_b128 v[128:131], v5 offset:18432
    s_waitcnt lgkmcnt(15)
    v_mfma_f32_32x32x16_bf16 v[64:79], v[132:135], v[20:23], v[64:79]
    ds_read_b128 v[132:135], v5 offset:22528
    s_waitcnt lgkmcnt(15)
    v_mfma_f32_32x32x16_bf16 v[64:79], v[136:139], v[24:27], v[64:79]
    ds_read_b128 v[136:139], v5 offset:26624
    s_waitcnt lgkmcnt(15)
    v_mfma_f32_32x32x16_bf16 v[64:79], v[140:143], v[28:31], v[64:79]
    ds_read_b128 v[140:143], v5 offset:30720
    s_waitcnt lgkmcnt(15)
    v_mfma_f32_32x32x16_bf16 v[64:79], v[144:147], v[32:35], v[64:79]
    ds_read_b128 v[144:147], v5 offset:19456
    s_waitcnt lgkmcnt(15)
    v_mfma_f32_32x32x16_bf16 v[64:79], v[148:151], v[36:39], v[64:79]
    ds_read_b128 v[148:151], v5 offset:23552
    s_waitcnt lgkmcnt(15)
    v_mfma_f32_32x32x16_bf16 v[64:79], v[152:155], v[40:43], v[64:79]
    ds_read_b128 v[152:155], v5 offset:27648
    s_waitcnt lgkmcnt(15)
    v_mfma_f32_32x32x16_bf16 v[64:79], v[156:159], v[44:47], v[64:79]
    ds_read_b128 v[156:159], v5 offset:31744
    s_setprio 3
    s_cmp_lg_u32 s49, 0
    s_cbranch_scc1 L_k2_rare_6
L_k2_exp_7:
    v_exp_f32 v250, v48
    v_exp_f32 v251, v49
    v_exp_f32 v252, v50
    v_cvt_pk_bf16_f32 v80, v250, v251
    v_exp_f32 v253, v51
    v_exp_f32 v254, v52
    v_cvt_pk_bf16_f32 v81, v252, v253
    v_exp_f32 v255, v53
    v_exp_f32 v250, v54
    v_cvt_pk_bf16_f32 v82, v254, v255
    v_exp_f32 v251, v55
    v_exp_f32 v252, v56
    v_cvt_pk_bf16_f32 v83, v250, v251
    v_exp_f32 v253, v57
    v_exp_f32 v254, v58
    v_cvt_pk_bf16_f32 v84, v252, v253
    v_exp_f32 v255, v59
    v_mfma_f32_16x16x32_bf16 v[244:247], v[240:243], v[80:83], 0
    v_exp_f32 v250, v60
    v_cvt_pk_bf16_f32 v85, v254, v255
    v_exp_f32 v251, v61
    v_exp_f32 v252, v62
    v_cvt_pk_bf16_f32 v86, v250, v251
    v_exp_f32 v253, v63
    v_exp_f32 v254, v64
    v_cvt_pk_bf16_f32 v87, v252, v253
    v_exp_f32 v255, v65
    v_exp_f32 v250, v66
    v_cvt_pk_bf16_f32 v88, v254, v255
    v_exp_f32 v251, v67
    v_mfma_f32_16x16x32_bf16 v[244:247], v[240:243], v[84:87], v[244:247]
    v_exp_f32 v252, v68
    v_cvt_pk_bf16_f32 v89, v250, v251
    v_exp_f32 v253, v69
    v_exp_f32 v254, v70
    v_cvt_pk_bf16_f32 v90, v252, v253
    v_exp_f32 v255, v71
    v_exp_f32 v250, v72
    v_cvt_pk_bf16_f32 v91, v254, v255
    v_exp_f32 v251, v73
    v_exp_f32 v252, v74
    v_cvt_pk_bf16_f32 v92, v250, v251
    v_exp_f32 v253, v75
    v_mfma_f32_16x16x32_bf16 v[244:247], v[240:243], v[88:91], v[244:247]
    v_exp_f32 v254, v76
    v_cvt_pk_bf16_f32 v93, v252, v253
    v_exp_f32 v255, v77
    v_exp_f32 v250, v78
    v_cvt_pk_bf16_f32 v94, v254, v255
    v_exp_f32 v251, v79
    s_nop 0
    v_cvt_pk_bf16_f32 v95, v250, v251
    s_nop 1
    v_mfma_f32_16x16x32_bf16 v[244:247], v[240:243], v[92:95], v[244:247]
    s_nop 7
    v_max_f32 v9, v244, v245
    v_cmp_nge_f32 vcc, s42, v9
    s_cbranch_vccnz L_k2_rare_6
    v_add_f32 v248, v248, v244
    v_add_f32 v249, v249, v245
    s_setprio 0
    s_waitcnt vmcnt(0) lgkmcnt(0)
    s_barrier
    s_xor_b32 s48, s48, 0x8000
    v_add_u32 v5, s48, v4
    v_mfma_f32_32x32x16_bf16 v[160:175], v[96:99], v[80:83], v[160:175]
    ds_read_b128 v[96:99], v5 offset:0
    v_mfma_f32_32x32x16_bf16 v[176:191], v[100:103], v[80:83], v[176:191]
    ds_read_b128 v[100:103], v5 offset:1024
    v_mfma_f32_32x32x16_bf16 v[192:207], v[104:107], v[80:83], v[192:207]
    ds_read_b128 v[104:107], v5 offset:2048
    v_mfma_f32_32x32x16_bf16 v[208:223], v[108:111], v[80:83], v[208:223]
    ds_read_b128 v[108:111], v5 offset:3072
    v_mfma_f32_32x32x16_bf16 v[160:175], v[112:115], v[84:87], v[160:175]
    ds_read_b128 v[112:115], v5 offset:4096
    v_mfma_f32_32x32x16_bf16 v[176:191], v[116:119], v[84:87], v[176:191]
    ds_read_b128 v[116:119], v5 offset:5120
    v_mfma_f32_32x32x16_bf16 v[192:207], v[120:123], v[84:87], v[192:207]
    ds_read_b128 v[120:123], v5 offset:6144
    v_mfma_f32_32x32x16_bf16 v[208:223], v[124:127], v[84:87], v[208:223]
    ds_read_b128 v[124:127], v5 offset:7168
    v_mfma_f32_32x32x16_bf16 v[160:175], v[128:131], v[88:91], v[160:175]
    ds_read_b128 v[128:131], v5 offset:8192
    v_mfma_f32_32x32x16_bf16 v[176:191], v[132:135], v[88:91], v[176:191]
    ds_read_b128 v[132:135], v5 offset:9216
    v_mfma_f32_32x32x16_bf16 v[192:207], v[136:139], v[88:91], v[192:207]
    ds_read_b128 v[136:139], v5 offset:10240
    v_mfma_f32_32x32x16_bf16 v[208:223], v[140:143], v[88:91], v[208:223]
    ds_read_b128 v[140:143], v5 offset:11264
    v_mfma_f32_32x32x16_bf16 v[160:175], v[144:147], v[92:95], v[160:175]
    ds_read_b128 v[144:147], v5 offset:12288
    v_mfma_f32_32x32x16_bf16 v[176:191], v[148:151], v[92:95], v[176:191]
    ds_read_b128 v[148:151], v5 offset:13312
    v_mfma_f32_32x32x16_bf16 v[192:207], v[152:155], v[92:95], v[192:207]
    ds_read_b128 v[152:155], v5 offset:14336
    v_mfma_f32_32x32x16_bf16 v[208:223], v[156:159], v[92:95], v[208:223]
    ds_read_b128 v[156:159], v5 offset:15360
    s_sub_u32 s43, s43, 1
    s_cmp_lg_u32 s43, 0
    s_cbranch_scc1 L_k2_loop_4
L_k2_loopdone_5:
    s_mov_b32 s43, 2
    s_lshl_b32 s44, s4, 5
L_k2_loop_8:
    s_waitcnt lgkmcnt(15)
    v_mfma_f32_32x32x16_bf16 v[48:63], v[96:99], v[16:19], v[224:239]
    ds_read_b128 v[96:99], v5 offset:16384
    s_waitcnt lgkmcnt(15)
    v_mfma_f32_32x32x16_bf16 v[48:63], v[100:103], v[20:23], v[48:63]
    ds_read_b128 v[100:103], v5 offset:20480
    s_waitcnt lgkmcnt(15)
    v_mfma_f32_32x32x16_bf16 v[48:63], v[104:107], v[24:27], v[48:63]
    ds_read_b128 v[104:107], v5 offset:24576
    s_waitcnt lgkmcnt(15)
    v_mfma_f32_32x32x16_bf16 v[48:63], v[108:111], v[28:31], v[48:63]
    ds_read_b128 v[108:111], v5 offset:28672
    s_waitcnt lgkmcnt(15)
    v_mfma_f32_32x32x16_bf16 v[48:63], v[112:115], v[32:35], v[48:63]
    ds_read_b128 v[112:115], v5 offset:17408
    s_waitcnt lgkmcnt(15)
    v_mfma_f32_32x32x16_bf16 v[48:63], v[116:119], v[36:39], v[48:63]
    ds_read_b128 v[116:119], v5 offset:21504
    s_waitcnt lgkmcnt(15)
    v_mfma_f32_32x32x16_bf16 v[48:63], v[120:123], v[40:43], v[48:63]
    ds_read_b128 v[120:123], v5 offset:25600
    s_waitcnt lgkmcnt(15)
    v_mfma_f32_32x32x16_bf16 v[48:63], v[124:127], v[44:47], v[48:63]
    ds_read_b128 v[124:127], v5 offset:29696
    s_waitcnt lgkmcnt(15)
    v_mfma_f32_32x32x16_bf16 v[64:79], v[128:131], v[16:19], v[224:239]
    ds_read_b128 v[128:131], v5 offset:18432
    s_waitcnt lgkmcnt(15)
    v_mfma_f32_32x32x16_bf16 v[64:79], v[132:135], v[20:23], v[64:79]
    ds_read_b128 v[132:135], v5 offset:22528
    s_waitcnt lgkmcnt(15)
    v_mfma_f32_32x32x16_bf16 v[64:79], v[136:139], v[24:27], v[64:79]
    ds_read_b128 v[136:139], v5 offset:26624
    s_waitcnt lgkmcnt(15)
    v_mfma_f32_32x32x16_bf16 v[64:79], v[140:143], v[28:31], v[64:79]
    ds_read_b128 v[140:143], v5 offset:30720
    s_waitcnt lgkmcnt(15)
    v_mfma_f32_32x32x16_bf16 v[64:79], v[144:147], v[32:35], v[64:79]
    ds_read_b128 v[144:147], v5 offset:19456
    s_waitcnt lgkmcnt(15)
    v_mfma_f32_32x32x16_bf16 v[64:79], v[148:151], v[36:39], v[64:79]
    ds_read_b128 v[148:151], v5 offset:23552
    s_waitcnt lgkmcnt(15)
    v_mfma_f32_32x32x16_bf16 v[64:79], v[152:155], v[40:43], v[64:79]
    ds_read_b128 v[152:155], v5 offset:27648
    s_waitcnt lgkmcnt(15)
    v_mfma_f32_32x32x16_bf16 v[64:79], v[156:159], v[44:47], v[64:79]
    ds_read_b128 v[156:159], v5 offset:31744
    s_setprio 3
    v_add_u32 v11, s44, v12
    s_nop 11
    v_cmp_gt_i32 s[52:53], 0, v11
    v_cmp_gt_i32 s[54:55], 1, v11
    v_cmp_gt_i32 s[56:57], 2, v11
    v_cmp_gt_i32 s[58:59], 3, v11
    v_cndmask_b32 v48, v48, v10, s[52:53]
    v_cndmask_b32 v49, v49, v10, s[54:55]
    v_cndmask_b32 v50, v50, v10, s[56:57]
    v_cndmask_b32 v51, v51, v10, s[58:59]
    v_cmp_gt_i32 s[52:53], 8, v11
    v_cmp_gt_i32 s[54:55], 9, v11
    v_cmp_gt_i32 s[56:57], 10, v11
    v_cmp_gt_i32 s[58:59], 11, v11
    v_cndmask_b32 v52, v52, v10, s[52:53]
    v_cndmask_b32 v53, v53, v10, s[54:55]
    v_cndmask_b32 v54, v54, v10, s[56:57]
    v_cndmask_b32 v55, v55, v10, s[58:59]
    v_cmp_gt_i32 s[52:53], 16, v11
    v_cmp_gt_i32 s[54:55], 17, v11
    v_cmp_gt_i32 s[56:57], 18, v11
    v_cmp_gt_i32 s[58:59], 19, v11
    v_cndmask_b32 v56, v56, v10, s[52:53]
    v_cndmask_b32 v57, v57, v10, s[54:55]
    v_cndmask_b32 v58, v58, v10, s[56:57]
    v_cndmask_b32 v59, v59, v10, s[58:59]
    v_cmp_gt_i32 s[52:53], 24, v11
    v_cmp_gt_i32 s[54:55], 25, v11
    v_cmp_gt_i32 s[56:57], 26, v11
    v_cmp_gt_i32 s[58:59], 27, v11
    v_cndmask_b32 v60, v60, v10, s[52:53]
    v_cndmask_b32 v61, v61, v10, s[54:55]
    v_cndmask_b32 v62, v62, v10, s[56:57]
    v_cndmask_b32 v63, v63, v10, s[58:59]
    v_cmp_gt_i32 s[52:53], 32, v11
    v_cmp_gt_i32 s[54:55], 33, v11
    v_cmp_gt_i32 s[56:57], 34, v11
    v_cmp_gt_i32 s[58:59], 35, v11
    v_cndmask_b32 v64, v64, v10, s[52:53]
    v_cndmask_b32 v65, v65, v10, s[54:55]
    v_cndmask_b32 v66, v66, v10, s[56:57]
    v_cndmask_b32 v67, v67, v10, s[58:59]
    v_cmp_gt_i32 s[52:53], 40, v11
    v_cmp_gt_i32 s[54:55], 41, v11
    v_cmp_gt_i32 s[56:57], 42, v11
    v_cmp_gt_i32 s[58:59], 43, v11
    v_cndmask_b32 v68, v68, v10, s[52:53]
    v_cndmask_b32 v69, v69, v10, s[54:55]
    v_cndmask_b32 v70, v70, v10, s[56:57]
    v_cndmask_b32 v71, v71, v10, s[58:59]
    v_cmp_gt_i32 s[52:53], 48, v11
    v_cmp_gt_i32 s[54:55], 49, v11
    v_cmp_gt_i32 s[56:57], 50, v11
    v_cmp_gt_i32 s[58:59], 51, v11
    v_cndmask_b32 v72, v72, v10, s[52:53]
    v_cndmask_b32 v73, v73, v10, s[54:55]
    v_cndmask_b32 v74, v74, v10, s[56:57]
    v_cndmask_b32 v75, v75, v10, s[58:59]
    v_cmp_gt_i32 s[52:53], 56, v11
    v_cmp_gt_i32 s[54:55], 57, v11
    v_cmp_gt_i32 s[56:57], 58, v11
    v_cmp_gt_i32 s[58:59], 59, v11
    v_cndmask_b32 v76, v76, v10, s[52:53]
    v_cndmask_b32 v77, v77, v10, s[54:55]
    v_cndmask_b32 v78, v78, v10, s[56:57]
    v_cndmask_b32 v79, v79, v10, s[58:59]
    s_cmp_lg_u32 s49, 0
    s_cbranch_scc1 L_k2_rare_10
L_k2_exp_11:
    v_exp_f32 v250, v48
    v_exp_f32 v251, v49
    v_exp_f32 v252, v50
    v_cvt_pk_bf16_f32 v80, v250, v251
    v_exp_f32 v253, v51
    v_exp_f32 v254, v52
    v_cvt_pk_bf16_f32 v81, v252, v253
    v_exp_f32 v255, v53
    v_exp_f32 v250, v54
    v_cvt_pk_bf16_f32 v82, v254, v255
    v_exp_f32 v251, v55
    v_exp_f32 v252, v56
    v_cvt_pk_bf16_f32 v83, v250, v251
    v_exp_f32 v253, v57
    v_exp_f32 v254, v58
    v_cvt_pk_bf16_f32 v84, v252, v253
    v_exp_f32 v255, v59
    v_mfma_f32_16x16x32_bf16 v[244:247], v[240:243], v[80:83], 0
    v_exp_f32 v250, v60
    v_cvt_pk_bf16_f32 v85, v254, v255
    v_exp_f32 v251, v61
    v_exp_f32 v252, v62
    v_cvt_pk_bf16_f32 v86, v250, v251
    v_exp_f32 v253, v63
    v_exp_f32 v254, v64
    v_cvt_pk_bf16_f32 v87, v252, v253
    v_exp_f32 v255, v65
    v_exp_f32 v250, v66
    v_cvt_pk_bf16_f32 v88, v254, v255
    v_exp_f32 v251, v67
    v_mfma_f32_16x16x32_bf16 v[244:247], v[240:243], v[84:87], v[244:247]
    v_exp_f32 v252, v68
    v_cvt_pk_bf16_f32 v89, v250, v251
    v_exp_f32 v253, v69
    v_exp_f32 v254, v70
    v_cvt_pk_bf16_f32 v90, v252, v253
    v_exp_f32 v255, v71
    v_exp_f32 v250, v72
    v_cvt_pk_bf16_f32 v91, v254, v255
    v_exp_f32 v251, v73
    v_exp_f32 v252, v74
    v_cvt_pk_bf16_f32 v92, v250, v251
    v_exp_f32 v253, v75
    v_mfma_f32_16x16x32_bf16 v[244:247], v[240:243], v[88:91], v[244:247]
    v_exp_f32 v254, v76
    v_cvt_pk_bf16_f32 v93, v252, v253
    v_exp_f32 v255, v77
    v_exp_f32 v250, v78
    v_cvt_pk_bf16_f32 v94, v254, v255
    v_exp_f32 v251, v79
    s_nop 0
    v_cvt_pk_bf16_f32 v95, v250, v251
    s_nop 1
    v_mfma_f32_16x16x32_bf16 v[244:247], v[240:243], v[92:95], v[244:247]
    s_nop 7
    v_max_f32 v9, v244, v245
    v_cmp_nge_f32 vcc, s42, v9
    s_cbranch_vccnz L_k2_rare_10
    v_add_f32 v248, v248, v244
    v_add_f32 v249, v249, v245
    s_setprio 0
    s_waitcnt vmcnt(0) lgkmcnt(0)
    s_barrier
    s_xor_b32 s48, s48, 0x8000
    s_cmp_eq_u32 s43, 1
    s_cselect_b32 s48, 0, s48
    v_add_u32 v5, s48, v4
    v_mfma_f32_32x32x16_bf16 v[160:175], v[96:99], v[80:83], v[160:175]
    ds_read_b128 v[96:99], v5 offset:0
    v_mfma_f32_32x32x16_bf16 v[176:191], v[100:103], v[80:83], v[176:191]
    ds_read_b128 v[100:103], v5 offset:1024
    v_mfma_f32_32x32x16_bf16 v[192:207], v[104:107], v[80:83], v[192:207]
    ds_read_b128 v[104:107], v5 offset:2048
    v_mfma_f32_32x32x16_bf16 v[208:223], v[108:111], v[80:83], v[208:223]
    ds_read_b128 v[108:111], v5 offset:3072
    v_mfma_f32_32x32x16_bf16 v[160:175], v[112:115], v[84:87], v[160:175]
    ds_read_b128 v[112:115], v5 offset:4096
    v_mfma_f32_32x32x16_bf16 v[176:191], v[116:119], v[84:87], v[176:191]
    ds_read_b128 v[116:119], v5 offset:5120
    v_mfma_f32_32x32x16_bf16 v[192:207], v[120:123], v[84:87], v[192:207]
    ds_read_b128 v[120:123], v5 offset:6144
    v_mfma_f32_32x32x16_bf16 v[208:223], v[124:127], v[84:87], v[208:223]
    ds_read_b128 v[124:127], v5 offset:7168
    v_mfma_f32_32x32x16_bf16 v[160:175], v[128:131], v[88:91], v[160:175]
    ds_read_b128 v[128:131], v5 offset:8192
    v_mfma_f32_32x32x16_bf16 v[176:191], v[132:135], v[88:91], v[176:191]
    ds_read_b128 v[132:135], v5 offset:9216
    v_mfma_f32_32x32x16_bf16 v[192:207], v[136:139], v[88:91], v[192:207]
    ds_read_b128 v[136:139], v5 offset:10240
    v_mfma_f32_32x32x16_bf16 v[208:223], v[140:143], v[88:91], v[208:223]
    ds_read_b128 v[140:143], v5 offset:11264
    v_mfma_f32_32x32x16_bf16 v[160:175], v[144:147], v[92:95], v[160:175]
    ds_read_b128 v[144:147], v5 offset:12288
    v_mfma_f32_32x32x16_bf16 v[176:191], v[148:151], v[92:95], v[176:191]
    ds_read_b128 v[148:151], v5 offset:13312
    v_mfma_f32_32x32x16_bf16 v[192:207], v[152:155], v[92:95], v[192:207]
    ds_read_b128 v[152:155], v5 offset:14336
    v_mfma_f32_32x32x16_bf16 v[208:223], v[156:159], v[92:95], v[208:223]
    ds_read_b128 v[156:159], v5 offset:15360
    s_sub_u32 s44, s44, 64
    s_sub_u32 s43, s43, 1
    s_cmp_lg_u32 s43, 0
    s_cbranch_scc1 L_k2_loop_8
L_k2_loopdone_9:
    s_lshl_b32 s46, s4, 13
    s_add_u32 s46, s46, 131072
    v_add_u32 v13, s46, v4
    ds_read_b128 v[16:19], v13 offset:0
    ds_read_b128 v[20:23], v13 offset:1024
    ds_read_b128 v[24:27], v13 offset:2048
    ds_read_b128 v[28:31], v13 offset:3072
    ds_read_b128 v[32:35], v13 offset:4096
    ds_read_b128 v[36:39], v13 offset:5120
    ds_read_b128 v[40:43], v13 offset:6144
    ds_read_b128 v[44:47], v13 offset:7168
    s_mov_b32 s45, s6
    s_lshl_b32 s45, s45, 2
    s_add_u32 s45, s45, s4
    s_lshl_b32 s45, s45, 5
    s_add_u32 s45, s45, s5
    s_lshl_b32 s45, s45, 13
    s_add_u32 s80, s45, 0x3000000
    s_add_u32 s81, s80, 4096
    v_and_b32 v13, 15, v1
    v_lshlrev_b32 v13, 2, v13
    ds_bpermute_b32 v14, v13, v248
    ds_bpermute_b32 v15, v13, v249
    v_and_b32 v13, 16, v1
    v_cmp_ne_u32 vcc, 0, v13
    s_waitcnt lgkmcnt(0)
    s_nop 1
    v_cndmask_b32 v8, v14, v15, vcc
    v_rcp_f32 v8, v8
    s_nop 0
    v_mul_f32 v48, v160, v8
    v_mul_f32 v49, v161, v8
    v_mul_f32 v50, v162, v8
    v_mul_f32 v51, v163, v8
    v_mul_f32 v52, v164, v8
    v_mul_f32 v53, v165, v8
    v_mul_f32 v54, v166, v8
    v_mul_f32 v55, v167, v8
    v_cvt_pk_bf16_f32 v48, v48, v49
    v_cvt_pk_bf16_f32 v49, v50, v51
    v_cvt_pk_bf16_f32 v50, v52, v53
    v_cvt_pk_bf16_f32 v51, v54, v55
    buffer_store_dwordx4 v[48:51], v4, s[32:35], s80 offen offset:0 sc1
    v_mul_f32 v56, v168, v8
    v_mul_f32 v57, v169, v8
    v_mul_f32 v58, v170, v8
    v_mul_f32 v59, v171, v8
    v_mul_f32 v60, v172, v8
    v_mul_f32 v61, v173, v8
    v_mul_f32 v62, v174, v8
    v_mul_f32 v63, v175, v8
    v_cvt_pk_bf16_f32 v56, v56, v57
    v_cvt_pk_bf16_f32 v57, v58, v59
    v_cvt_pk_bf16_f32 v58, v60, v61
    v_cvt_pk_bf16_f32 v59, v62, v63
    buffer_store_dwordx4 v[56:59], v4, s[32:35], s80 offen offset:1024 sc1
    v_mul_f32 v64, v176, v8
    v_mul_f32 v65, v177, v8
    v_mul_f32 v66, v178, v8
    v_mul_f32 v67, v179, v8
    v_mul_f32 v68, v180, v8
    v_mul_f32 v69, v181, v8
    v_mul_f32 v70, v182, v8
    v_mul_f32 v71, v183, v8
    v_cvt_pk_bf16_f32 v64, v64, v65
    v_cvt_pk_bf16_f32 v65, v66, v67
    v_cvt_pk_bf16_f32 v66, v68, v69
    v_cvt_pk_bf16_f32 v67, v70, v71
    buffer_store_dwordx4 v[64:67], v4, s[32:35], s80 offen offset:2048 sc1
    v_mul_f32 v72, v184, v8
    v_mul_f32 v73, v185, v8
    v_mul_f32 v74, v186, v8
    v_mul_f32 v75, v187, v8
    v_mul_f32 v76, v188, v8
    v_mul_f32 v77, v189, v8
    v_mul_f32 v78, v190, v8
    v_mul_f32 v79, v191, v8
    v_cvt_pk_bf16_f32 v72, v72, v73
    v_cvt_pk_bf16_f32 v73, v74, v75
    v_cvt_pk_bf16_f32 v74, v76, v77
    v_cvt_pk_bf16_f32 v75, v78, v79
    buffer_store_dwordx4 v[72:75], v4, s[32:35], s80 offen offset:3072 sc1
    v_mul_f32 v48, v192, v8
    v_mul_f32 v49, v193, v8
    v_mul_f32 v50, v194, v8
    v_mul_f32 v51, v195, v8
    v_mul_f32 v52, v196, v8
    v_mul_f32 v53, v197, v8
    v_mul_f32 v54, v198, v8
    v_mul_f32 v55, v199, v8
    v_cvt_pk_bf16_f32 v48, v48, v49
    v_cvt_pk_bf16_f32 v49, v50, v51
    v_cvt_pk_bf16_f32 v50, v52, v53
    v_cvt_pk_bf16_f32 v51, v54, v55
    buffer_store_dwordx4 v[48:51], v4, s[32:35], s81 offen offset:0 sc1
    v_mul_f32 v56, v200, v8
    v_mul_f32 v57, v201, v8
    v_mul_f32 v58, v202, v8
    v_mul_f32 v59, v203, v8
    v_mul_f32 v60, v204, v8
    v_mul_f32 v61, v205, v8
    v_mul_f32 v62, v206, v8
    v_mul_f32 v63, v207, v8
    v_cvt_pk_bf16_f32 v56, v56, v57
    v_cvt_pk_bf16_f32 v57, v58, v59
    v_cvt_pk_bf16_f32 v58, v60, v61
    v_cvt_pk_bf16_f32 v59, v62, v63
    buffer_store_dwordx4 v[56:59], v4, s[32:35], s81 offen offset:1024 sc1
    v_mul_f32 v64, v208, v8
    v_mul_f32 v65, v209, v8
    v_mul_f32 v66, v210, v8
    v_mul_f32 v67, v211, v8
    v_mul_f32 v68, v212, v8
    v_mul_f32 v69, v213, v8
    v_mul_f32 v70, v214, v8
    v_mul_f32 v71, v215, v8
    v_cvt_pk_bf16_f32 v64, v64, v65
    v_cvt_pk_bf16_f32 v65, v66, v67
    v_cvt_pk_bf16_f32 v66, v68, v69
    v_cvt_pk_bf16_f32 v67, v70, v71
    buffer_store_dwordx4 v[64:67], v4, s[32:35], s81 offen offset:2048 sc1
    v_mul_f32 v72, v216, v8
    v_mul_f32 v73, v217, v8
    v_mul_f32 v74, v218, v8
    v_mul_f32 v75, v219, v8
    v_mul_f32 v76, v220, v8
    v_mul_f32 v77, v221, v8
    v_mul_f32 v78, v222, v8
    v_mul_f32 v79, v223, v8
    v_cvt_pk_bf16_f32 v72, v72, v73
    v_cvt_pk_bf16_f32 v73, v74, v75
    v_cvt_pk_bf16_f32 v74, v76, v77
    v_cvt_pk_bf16_f32 v75, v78, v79
    buffer_store_dwordx4 v[72:75], v4, s[32:35], s81 offen offset:3072 sc1
    s_mov_b32 s30, 0
    v_mov_b32 v224, 0
    v_mov_b32 v225, 0
    v_mov_b32 v226, 0
    v_mov_b32 v227, 0
    v_mov_b32 v228, 0
    v_mov_b32 v229, 0
    v_mov_b32 v230, 0
    v_mov_b32 v231, 0
    v_mov_b32 v232, 0
    v_mov_b32 v233, 0
    v_mov_b32 v234, 0
    v_mov_b32 v235, 0
    v_mov_b32 v236, 0
    v_mov_b32 v237, 0
    v_mov_b32 v238, 0
    v_mov_b32 v239, 0
    v_mov_b32 v7, 0
    v_mov_b32 v248, 0
    v_mov_b32 v249, 0
    s_mov_b32 s49, 1
    s_mov_b32 s50, 0xff61b1e6
    s_lshl_b32 s45, s6, 1
    s_sub_u32 s43, 13, s45
    s_cmp_lt_i32 s43, 1
    s_cbranch_scc1 L_k2_loopdone_13
L_k2_loop_12:
    s_waitcnt lgkmcnt(15)
    v_mfma_f32_32x32x16_bf16 v[48:63], v[96:99], v[16:19], v[224:239]
    ds_read_b128 v[96:99], v5 offset:16384
    s_waitcnt lgkmcnt(15)
    v_mfma_f32_32x32x16_bf16 v[48:63], v[100:103], v[20:23], v[48:63]
    ds_read_b128 v[100:103], v5 offset:20480
    s_waitcnt lgkmcnt(15)
    v_mfma_f32_32x32x16_bf16 v[48:63], v[104:107], v[24:27], v[48:63]
    ds_read_b128 v[104:107], v5 offset:24576
    s_waitcnt lgkmcnt(15)
    v_mfma_f32_32x32x16_bf16 v[48:63], v[108:111], v[28:31], v[48:63]
    ds_read_b128 v[108:111], v5 offset:28672
    s_waitcnt lgkmcnt(15)
    v_mfma_f32_32x32x16_bf16 v[48:63], v[112:115], v[32:35], v[48:63]
    ds_read_b128 v[112:115], v5 offset:17408
    s_waitcnt lgkmcnt(15)
    v_mfma_f32_32x32x16_bf16 v[48:63], v[116:119], v[36:39], v[48:63]
    ds_read_b128 v[116:119], v5 offset:21504
    s_waitcnt lgkmcnt(15)
    v_mfma_f32_32x32x16_bf16 v[48:63], v[120:123], v[40:43], v[48:63]
    ds_read_b128 v[120:123], v5 offset:25600
    s_waitcnt lgkmcnt(15)
    v_mfma_f32_32x32x16_bf16 v[48:63], v[124:127], v[44:47], v[48:63]
    ds_read_b128 v[124:127], v5 offset:29696
    s_waitcnt lgkmcnt(15)
    v_mfma_f32_32x32x16_bf16 v[64:79], v[128:131], v[16:19], v[224:239]
    ds_read_b128 v[128:131], v5 offset:18432
    s_waitcnt lgkmcnt(15)
    v_mfma_f32_32x32x16_bf16 v[64:79], v[132:135], v[20:23], v[64:79]
    ds_read_b128 v[132:135], v5 offset:22528
    s_waitcnt lgkmcnt(15)
    v_mfma_f32_32x32x16_bf16 v[64:79], v[136:139], v[24:27], v[64:79]
    ds_read_b128 v[136:139], v5 offset:26624
    s_waitcnt lgkmcnt(15)
    v_mfma_f32_32x32x16_bf16 v[64:79], v[140:143], v[28:31], v[64:79]
    ds_read_b128 v[140:143], v5 offset:30720
    s_waitcnt lgkmcnt(15)
    v_mfma_f32_32x32x16_bf16 v[64:79], v[144:147], v[32:35], v[64:79]
    ds_read_b128 v[144:147], v5 offset:19456
    s_waitcnt lgkmcnt(15)
    v_mfma_f32_32x32x16_bf16 v[64:79], v[148:151], v[36:39], v[64:79]
    ds_read_b128 v[148:151], v5 offset:23552
    s_waitcnt lgkmcnt(15)
    v_mfma_f32_32x32x16_bf16 v[64:79], v[152:155], v[40:43], v[64:79]
    ds_read_b128 v[152:155], v5 offset:27648
    s_waitcnt lgkmcnt(15)
    v_mfma_f32_32x32x16_bf16 v[64:79], v[156:159], v[44:47], v[64:79]
    ds_read_b128 v[156:159], v5 offset:31744
    s_setprio 3
    s_cmp_lg_u32 s49, 0
    s_cbranch_scc1 L_k2_rare_14
L_k2_exp_15:
    v_exp_f32 v250, v48
    v_exp_f32 v251, v49
    v_exp_f32 v252, v50
    v_cvt_pk_bf16_f32 v80, v250, v251
    v_exp_f32 v253, v51
    v_exp_f32 v254, v52
    v_cvt_pk_bf16_f32 v81, v252, v253
    v_exp_f32 v255, v53
    v_exp_f32 v250, v54
    v_cvt_pk_bf16_f32 v82, v254, v255
    v_exp_f32 v251, v55
    v_exp_f32 v252, v56
    v_cvt_pk_bf16_f32 v83, v250, v251
    v_exp_f32 v253, v57
    v_exp_f32 v254, v58
    v_cvt_pk_bf16_f32 v84, v252, v253
    v_exp_f32 v255, v59
    v_mfma_f32_16x16x32_bf16 v[244:247], v[240:243], v[80:83], 0
    v_exp_f32 v250, v60
    v_cvt_pk_bf16_f32 v85, v254, v255
    v_exp_f32 v251, v61
    v_exp_f32 v252, v62
    v_cvt_pk_bf16_f32 v86, v250, v251
    v_exp_f32 v253, v63
    v_exp_f32 v254, v64
    v_cvt_pk_bf16_f32 v87, v252, v253
    v_exp_f32 v255, v65
    v_exp_f32 v250, v66
    v_cvt_pk_bf16_f32 v88, v254, v255
    v_exp_f32 v251, v67
    v_mfma_f32_16x16x32_bf16 v[244:247], v[240:243], v[84:87], v[244:247]
    v_exp_f32 v252, v68
    v_cvt_pk_bf16_f32 v89, v250, v251
    v_exp_f32 v253, v69
    v_exp_f32 v254, v70
    v_cvt_pk_bf16_f32 v90, v252, v253
    v_exp_f32 v255, v71
    v_exp_f32 v250, v72
    v_cvt_pk_bf16_f32 v91, v254, v255
    v_exp_f32 v251, v73
    v_exp_f32 v252, v74
    v_cvt_pk_bf16_f32 v92, v250, v251
    v_exp_f32 v253, v75
    v_mfma_f32_16x16x32_bf16 v[244:247], v[240:243], v[88:91], v[244:247]
    v_exp_f32 v254, v76
    v_cvt_pk_bf16_f32 v93, v252, v253
    v_exp_f32 v255, v77
    v_exp_f32 v250, v78
    v_cvt_pk_bf16_f32 v94, v254, v255
    v_exp_f32 v251, v79
    s_nop 0
    v_cvt_pk_bf16_f32 v95, v250, v251
    s_nop 1
    v_mfma_f32_16x16x32_bf16 v[244:247], v[240:243], v[92:95], v[244:247]
    s_nop 7
    v_max_f32 v9, v244, v245
    v_cmp_nge_f32 vcc, s42, v9
    s_cbranch_vccnz L_k2_rare_14
    v_add_f32 v248, v248, v244
    v_add_f32 v249, v249, v245
    s_setprio 0
    s_waitcnt vmcnt(0) lgkmcnt(0)
    s_barrier
    s_xor_b32 s48, s48, 0x8000
    v_add_u32 v5, s48, v4
    s_lshl_b32 s45, s38, 14
    s_add_u32 s63, s45, s36
    s_add_u32 s51, s45, s37
    s_mov_b32 m0, s40
    s_add_u32 s38, s38, 1
    v_mfma_f32_32x32x16_bf16 v[160:175], v[96:99], v[80:83], v[160:175]
    ds_read_b128 v[96:99], v5 offset:0
    buffer_load_dwordx4 v6, s[32:35], s63 offen offset:0 lds
    v_mfma_f32_32x32x16_bf16 v[176:191], v[100:103], v[80:83], v[176:191]
    ds_read_b128 v[100:103], v5 offset:1024
    v_mfma_f32_32x32x16_bf16 v[192:207], v[104:107], v[80:83], v[192:207]
    ds_read_b128 v[104:107], v5 offset:2048
    buffer_load_dwordx4 v6, s[32:35], s63 offen offset:1024 lds
    v_mfma_f32_32x32x16_bf16 v[208:223], v[108:111], v[80:83], v[208:223]
    ds_read_b128 v[108:111], v5 offset:3072
    v_mfma_f32_32x32x16_bf16 v[160:175], v[112:115], v[84:87], v[160:175]
    ds_read_b128 v[112:115], v5 offset:4096
    buffer_load_dwordx4 v6, s[32:35], s63 offen offset:2048 lds
    v_mfma_f32_32x32x16_bf16 v[176:191], v[116:119], v[84:87], v[176:191]
    ds_read_b128 v[116:119], v5 offset:5120
    v_mfma_f32_32x32x16_bf16 v[192:207], v[120:123], v[84:87], v[192:207]
    ds_read_b128 v[120:123], v5 offset:6144
    buffer_load_dwordx4 v6, s[32:35], s63 offen offset:3072 lds
    s_mov_b32 m0, s41
    v_mfma_f32_32x32x16_bf16 v[208:223], v[124:127], v[84:87], v[208:223]
    ds_read_b128 v[124:127], v5 offset:7168
    v_mfma_f32_32x32x16_bf16 v[160:175], v[128:131], v[88:91], v[160:175]
    ds_read_b128 v[128:131], v5 offset:8192
    buffer_load_dwordx4 v6, s[32:35], s51 offen offset:0 lds
    v_mfma_f32_32x32x16_bf16 v[176:191], v[132:135], v[88:91], v[176:191]
    ds_read_b128 v[132:135], v5 offset:9216
    v_mfma_f32_32x32x16_bf16 v[192:207], v[136:139], v[88:91], v[192:207]
    ds_read_b128 v[136:139], v5 offset:10240
    buffer_load_dwordx4 v6, s[32:35], s51 offen offset:1024 lds
    v_mfma_f32_32x32x16_bf16 v[208:223], v[140:143], v[88:91], v[208:223]
    ds_read_b128 v[140:143], v5 offset:11264
    v_mfma_f32_32x32x16_bf16 v[160:175], v[144:147], v[92:95], v[160:175]
    ds_read_b128 v[144:147], v5 offset:12288
    buffer_load_dwordx4 v6, s[32:35], s51 offen offset:2048 lds
    v_mfma_f32_32x32x16_bf16 v[176:191], v[148:151], v[92:95], v[176:191]
    ds_read_b128 v[148:151], v5 offset:13312
    v_mfma_f32_32x32x16_bf16 v[192:207], v[152:155], v[92:95], v[192:207]
    ds_read_b128 v[152:155], v5 offset:14336
    buffer_load_dwordx4 v6, s[32:35], s51 offen offset:3072 lds
    v_mfma_f32_32x32x16_bf16 v[208:223], v[156:159], v[92:95], v[208:223]
    ds_read_b128 v[156:159], v5 offset:15360
    s_xor_b32 s40, s40, 0x8000
    s_xor_b32 s41, s41, 0x8000
    s_sub_u32 s43, s43, 1
    s_cmp_lg_u32 s43, 0
    s_cbranch_scc1 L_k2_loop_12
L_k2_loopdone_13:
    s_lshl_b32 s44, s4, 5
    s_sub_u32 s45, s44, 64
    s_cmp_eq_u32 s6, 7
    s_cselect_b32 s43, 1, 2
    s_cselect_b32 s44, s45, s44
L_k2_loop_16:
    s_waitcnt lgkmcnt(15)
    v_mfma_f32_32x32x16_bf16 v[48:63], v[96:99], v[16:19], v[224:239]
    ds_read_b128 v[96:99], v5 offset:16384
    s_waitcnt lgkmcnt(15)
    v_mfma_f32_32x32x16_bf16 v[48:63], v[100:103], v[20:23], v[48:63]
    ds_read_b128 v[100:103], v5 offset:20480
    s_waitcnt lgkmcnt(15)
    v_mfma_f32_32x32x16_bf16 v[48:63], v[104:107], v[24:27], v[48:63]
    ds_read_b128 v[104:107], v5 offset:24576
    s_waitcnt lgkmcnt(15)
    v_mfma_f32_32x32x16_bf16 v[48:63], v[108:111], v[28:31], v[48:63]
    ds_read_b128 v[108:111], v5 offset:28672
    s_waitcnt lgkmcnt(15)
    v_mfma_f32_32x32x16_bf16 v[48:63], v[112:115], v[32:35], v[48:63]
    ds_read_b128 v[112:115], v5 offset:17408
    s_waitcnt lgkmcnt(15)
    v_mfma_f32_32x32x16_bf16 v[48:63], v[116:119], v[36:39], v[48:63]
    ds_read_b128 v[116:119], v5 offset:21504
    s_waitcnt lgkmcnt(15)
    v_mfma_f32_32x32x16_bf16 v[48:63], v[120:123], v[40:43], v[48:63]
    ds_read_b128 v[120:123], v5 offset:25600
    s_waitcnt lgkmcnt(15)
    v_mfma_f32_32x32x16_bf16 v[48:63], v[124:127], v[44:47], v[48:63]
    ds_read_b128 v[124:127], v5 offset:29696
    s_waitcnt lgkmcnt(15)
    v_mfma_f32_32x32x16_bf16 v[64:79], v[128:131], v[16:19], v[224:239]
    ds_read_b128 v[128:131], v5 offset:18432
    s_waitcnt lgkmcnt(15)
    v_mfma_f32_32x32x16_bf16 v[64:79], v[132:135], v[20:23], v[64:79]
    ds_read_b128 v[132:135], v5 offset:22528
    s_waitcnt lgkmcnt(15)
    v_mfma_f32_32x32x16_bf16 v[64:79], v[136:139], v[24:27], v[64:79]
    ds_read_b128 v[136:139], v5 offset:26624
    s_waitcnt lgkmcnt(15)
    v_mfma_f32_32x32x16_bf16 v[64:79], v[140:143], v[28:31], v[64:79]
    ds_read_b128 v[140:143], v5 offset:30720
    s_waitcnt lgkmcnt(15)
    v_mfma_f32_32x32x16_bf16 v[64:79], v[144:147], v[32:35], v[64:79]
    ds_read_b128 v[144:147], v5 offset:19456
    s_waitcnt lgkmcnt(15)
    v_mfma_f32_32x32x16_bf16 v[64:79], v[148:151], v[36:39], v[64:79]
    ds_read_b128 v[148:151], v5 offset:23552
    s_waitcnt lgkmcnt(15)
    v_mfma_f32_32x32x16_bf16 v[64:79], v[152:155], v[40:43], v[64:79]
    ds_read_b128 v[152:155], v5 offset:27648
    s_waitcnt lgkmcnt(15)
    v_mfma_f32_32x32x16_bf16 v[64:79], v[156:159], v[44:47], v[64:79]
    ds_read_b128 v[156:159], v5 offset:31744
    s_setprio 3
    v_add_u32 v11, s44, v12
    s_nop 11
    v_cmp_gt_i32 s[52:53], 0, v11
    v_cmp_gt_i32 s[54:55], 1, v11
    v_cmp_gt_i32 s[56:57], 2, v11
    v_cmp_gt_i32 s[58:59], 3, v11
    v_cndmask_b32 v48, v48, v10, s[52:53]
    v_cndmask_b32 v49, v49, v10, s[54:55]
    v_cndmask_b32 v50, v50, v10, s[56:57]
    v_cndmask_b32 v51, v51, v10, s[58:59]
    v_cmp_gt_i32 s[52:53], 8, v11
    v_cmp_gt_i32 s[54:55], 9, v11
    v_cmp_gt_i32 s[56:57], 10, v11
    v_cmp_gt_i32 s[58:59], 11, v11
    v_cndmask_b32 v52, v52, v10, s[52:53]
    v_cndmask_b32 v53, v53, v10, s[54:55]
    v_cndmask_b32 v54, v54, v10, s[56:57]
    v_cndmask_b32 v55, v55, v10, s[58:59]
    v_cmp_gt_i32 s[52:53], 16, v11
    v_cmp_gt_i32 s[54:55], 17, v11
    v_cmp_gt_i32 s[56:57], 18, v11
    v_cmp_gt_i32 s[58:59], 19, v11
    v_cndmask_b32 v56, v56, v10, s[52:53]
    v_cndmask_b32 v57, v57, v10, s[54:55]
    v_cndmask_b32 v58, v58, v10, s[56:57]
    v_cndmask_b32 v59, v59, v10, s[58:59]
    v_cmp_gt_i32 s[52:53], 24, v11
    v_cmp_gt_i32 s[54:55], 25, v11
    v_cmp_gt_i32 s[56:57], 26, v11
    v_cmp_gt_i32 s[58:59], 27, v11
    v_cndmask_b32 v60, v60, v10, s[52:53]
    v_cndmask_b32 v61, v61, v10, s[54:55]
    v_cndmask_b32 v62, v62, v10, s[56:57]
    v_cndmask_b32 v63, v63, v10, s[58:59]
    v_cmp_gt_i32 s[52:53], 32, v11
    v_cmp_gt_i32 s[54:55], 33, v11
    v_cmp_gt_i32 s[56:57], 34, v11
    v_cmp_gt_i32 s[58:59], 35, v11
    v_cndmask_b32 v64, v64, v10, s[52:53]
    v_cndmask_b32 v65, v65, v10, s[54:55]
    v_cndmask_b32 v66, v66, v10, s[56:57]
    v_cndmask_b32 v67, v67, v10, s[58:59]
    v_cmp_gt_i32 s[52:53], 40, v11
    v_cmp_gt_i32 s[54:55], 41, v11
    v_cmp_gt_i32 s[56:57], 42, v11
    v_cmp_gt_i32 s[58:59], 43, v11
    v_cndmask_b32 v68, v68, v10, s[52:53]
    v_cndmask_b32 v69, v69, v10, s[54:55]
    v_cndmask_b32 v70, v70, v10, s[56:57]
    v_cndmask_b32 v71, v71, v10, s[58:59]
    v_cmp_gt_i32 s[52:53], 48, v11
    v_cmp_gt_i32 s[54:55], 49, v11
    v_cmp_gt_i32 s[56:57], 50, v11
    v_cmp_gt_i32 s[58:59], 51, v11
    v_cndmask_b32 v72, v72, v10, s[52:53]
    v_cndmask_b32 v73, v73, v10, s[54:55]
    v_cndmask_b32 v74, v74, v10, s[56:57]
    v_cndmask_b32 v75, v75, v10, s[58:59]
    v_cmp_gt_i32 s[52:53], 56, v11
    v_cmp_gt_i32 s[54:55], 57, v11
    v_cmp_gt_i32 s[56:57], 58, v11
    v_cmp_gt_i32 s[58:59], 59, v11
    v_cndmask_b32 v76, v76, v10, s[52:53]
    v_cndmask_b32 v77, v77, v10, s[54:55]
    v_cndmask_b32 v78, v78, v10, s[56:57]
    v_cndmask_b32 v79, v79, v10, s[58:59]
    s_cmp_lg_u32 s49, 0
    s_cbranch_scc1 L_k2_rare_18
L_k2_exp_19:
    v_exp_f32 v250, v48
    v_exp_f32 v251, v49
    v_exp_f32 v252, v50
    v_cvt_pk_bf16_f32 v80, v250, v251
    v_exp_f32 v253, v51
    v_exp_f32 v254, v52
    v_cvt_pk_bf16_f32 v81, v252, v253
    v_exp_f32 v255, v53
    v_exp_f32 v250, v54
    v_cvt_pk_bf16_f32 v82, v254, v255
    v_exp_f32 v251, v55
    v_exp_f32 v252, v56
    v_cvt_pk_bf16_f32 v83, v250, v251
    v_exp_f32 v253, v57
    v_exp_f32 v254, v58
    v_cvt_pk_bf16_f32 v84, v252, v253
    v_exp_f32 v255, v59
    v_mfma_f32_16x16x32_bf16 v[244:247], v[240:243], v[80:83], 0
    v_exp_f32 v250, v60
    v_cvt_pk_bf16_f32 v85, v254, v255
    v_exp_f32 v251, v61
    v_exp_f32 v252, v62
    v_cvt_pk_bf16_f32 v86, v250, v251
    v_exp_f32 v253, v63
    v_exp_f32 v254, v64
    v_cvt_pk_bf16_f32 v87, v252, v253
    v_exp_f32 v255, v65
    v_exp_f32 v250, v66
    v_cvt_pk_bf16_f32 v88, v254, v255
    v_exp_f32 v251, v67
    v_mfma_f32_16x16x32_bf16 v[244:247], v[240:243], v[84:87], v[244:247]
    v_exp_f32 v252, v68
    v_cvt_pk_bf16_f32 v89, v250, v251
    v_exp_f32 v253, v69
    v_exp_f32 v254, v70
    v_cvt_pk_bf16_f32 v90, v252, v253
    v_exp_f32 v255, v71
    v_exp_f32 v250, v72
    v_cvt_pk_bf16_f32 v91, v254, v255
    v_exp_f32 v251, v73
    v_exp_f32 v252, v74
    v_cvt_pk_bf16_f32 v92, v250, v251
    v_exp_f32 v253, v75
    v_mfma_f32_16x16x32_bf16 v[244:247], v[240:243], v[88:91], v[244:247]
    v_exp_f32 v254, v76
    v_cvt_pk_bf16_f32 v93, v252, v253
    v_exp_f32 v255, v77
    v_exp_f32 v250, v78
    v_cvt_pk_bf16_f32 v94, v254, v255
    v_exp_f32 v251, v79
    s_nop 0
    v_cvt_pk_bf16_f32 v95, v250, v251
    s_nop 1
    v_mfma_f32_16x16x32_bf16 v[244:247], v[240:243], v[92:95], v[244:247]
    s_nop 7
    v_max_f32 v9, v244, v245
    v_cmp_nge_f32 vcc, s42, v9
    s_cbranch_vccnz L_k2_rare_18
    v_add_f32 v248, v248, v244
    v_add_f32 v249, v249, v245
    s_setprio 0
    s_waitcnt vmcnt(0) lgkmcnt(0)
    s_barrier
    s_xor_b32 s48, s48, 0x8000
    v_add_u32 v5, s48, v4
    v_mfma_f32_32x32x16_bf16 v[160:175], v[96:99], v[80:83], v[160:175]
    ds_read_b128 v[96:99], v5 offset:0
    v_mfma_f32_32x32x16_bf16 v[176:191], v[100:103], v[80:83], v[176:191]
    ds_read_b128 v[100:103], v5 offset:1024
    v_mfma_f32_32x32x16_bf16 v[192:207], v[104:107], v[80:83], v[192:207]
    ds_read_b128 v[104:107], v5 offset:2048
    v_mfma_f32_32x32x16_bf16 v[208:223], v[108:111], v[80:83], v[208:223]
    ds_read_b128 v[108:111], v5 offset:3072
    v_mfma_f32_32x32x16_bf16 v[160:175], v[112:115], v[84:87], v[160:175]
    ds_read_b128 v[112:115], v5 offset:4096
    v_mfma_f32_32x32x16_bf16 v[176:191], v[116:119], v[84:87], v[176:191]
    ds_read_b128 v[116:119], v5 offset:5120
    v_mfma_f32_32x32x16_bf16 v[192:207], v[120:123], v[84:87], v[192:207]
    ds_read_b128 v[120:123], v5 offset:6144
    v_mfma_f32_32x32x16_bf16 v[208:223], v[124:127], v[84:87], v[208:223]
    ds_read_b128 v[124:127], v5 offset:7168
    v_mfma_f32_32x32x16_bf16 v[160:175], v[128:131], v[88:91], v[160:175]
    ds_read_b128 v[128:131], v5 offset:8192
    v_mfma_f32_32x32x16_bf16 v[176:191], v[132:135], v[88:91], v[176:191]
    ds_read_b128 v[132:135], v5 offset:9216
    v_mfma_f32_32x32x16_bf16 v[192:207], v[136:139], v[88:91], v[192:207]
    ds_read_b128 v[136:139], v5 offset:10240
    v_mfma_f32_32x32x16_bf16 v[208:223], v[140:143], v[88:91], v[208:223]
    ds_read_b128 v[140:143], v5 offset:11264
    v_mfma_f32_32x32x16_bf16 v[160:175], v[144:147], v[92:95], v[160:175]
    ds_read_b128 v[144:147], v5 offset:12288
    v_mfma_f32_32x32x16_bf16 v[176:191], v[148:151], v[92:95], v[176:191]
    ds_read_b128 v[148:151], v5 offset:13312
    v_mfma_f32_32x32x16_bf16 v[192:207], v[152:155], v[92:95], v[192:207]
    ds_read_b128 v[152:155], v5 offset:14336
    v_mfma_f32_32x32x16_bf16 v[208:223], v[156:159], v[92:95], v[208:223]
    ds_read_b128 v[156:159], v5 offset:15360
    s_sub_u32 s44, s44, 64
    s_sub_u32 s43, s43, 1
    s_cmp_lg_u32 s43, 0
    s_cbranch_scc1 L_k2_loop_16
L_k2_loopdone_17:
    s_branch L_k2_merge
L_k2_groupB:
    s_mov_b32 s43, 15
L_k2_loop_20:
    s_setprio 0
    s_waitcnt lgkmcnt(15)
    v_mfma_f32_32x32x16_bf16 v[48:63], v[96:99], v[16:19], v[224:239]
    ds_read_b128 v[96:99], v5 offset:16384
    s_waitcnt lgkmcnt(15)
    v_mfma_f32_32x32x16_bf16 v[48:63], v[100:103], v[20:23], v[48:63]
    ds_read_b128 v[100:103], v5 offset:20480
    s_waitcnt lgkmcnt(15)
    v_mfma_f32_32x32x16_bf16 v[48:63], v[104:107], v[24:27], v[48:63]
    ds_read_b128 v[104:107], v5 offset:24576
    s_waitcnt lgkmcnt(15)
    v_mfma_f32_32x32x16_bf16 v[48:63], v[108:111], v[28:31], v[48:63]
    ds_read_b128 v[108:111], v5 offset:28672
    s_waitcnt lgkmcnt(15)
    v_mfma_f32_32x32x16_bf16 v[48:63], v[112:115], v[32:35], v[48:63]
    ds_read_b128 v[112:115], v5 offset:17408
    s_waitcnt lgkmcnt(15)
    v_mfma_f32_32x32x16_bf16 v[48:63], v[116:119], v[36:39], v[48:63]
    ds_read_b128 v[116:119], v5 offset:21504
    s_waitcnt lgkmcnt(15)
    v_mfma_f32_32x32x16_bf16 v[48:63], v[120:123], v[40:43], v[48:63]
    ds_read_b128 v[120:123], v5 offset:25600
    s_waitcnt lgkmcnt(15)
    v_mfma_f32_32x32x16_bf16 v[48:63], v[124:127], v[44:47], v[48:63]
    ds_read_b128 v[124:127], v5 offset:29696
    s_waitcnt lgkmcnt(15)
    v_mfma_f32_32x32x16_bf16 v[64:79], v[128:131], v[16:19], v[224:239]
    ds_read_b128 v[128:131], v5 offset:18432
    s_waitcnt lgkmcnt(15)
    v_mfma_f32_32x32x16_bf16 v[64:79], v[132:135], v[20:23], v[64:79]
    ds_read_b128 v[132:135], v5 offset:22528
    s_waitcnt lgkmcnt(15)
    v_mfma_f32_32x32x16_bf16 v[64:79], v[136:139], v[24:27], v[64:79]
    ds_read_b128 v[136:139], v5 offset:26624
    s_waitcnt lgkmcnt(15)
    v_mfma_f32_32x32x16_bf16 v[64:79], v[140:143], v[28:31], v[64:79]
    ds_read_b128 v[140:143], v5 offset:30720
    s_waitcnt lgkmcnt(15)
    v_mfma_f32_32x32x16_bf16 v[64:79], v[144:147], v[32:35], v[64:79]
    ds_read_b128 v[144:147], v5 offset:19456
    s_waitcnt lgkmcnt(15)
    v_mfma_f32_32x32x16_bf16 v[64:79], v[148:151], v[36:39], v[64:79]
    ds_read_b128 v[148:151], v5 offset:23552
    s_waitcnt lgkmcnt(15)
    v_mfma_f32_32x32x16_bf16 v[64:79], v[152:155], v[40:43], v[64:79]
    ds_read_b128 v[152:155], v5 offset:27648
    s_waitcnt lgkmcnt(15)
    v_mfma_f32_32x32x16_bf16 v[64:79], v[156:159], v[44:47], v[64:79]
    ds_read_b128 v[156:159], v5 offset:31744
    s_waitcnt vmcnt(0) lgkmcnt(0)
    s_barrier
    s_xor_b32 s48, s48, 0x8000
    v_add_u32 v5, s48, v4
    s_setprio 3
    s_cmp_lg_u32 s49, 0
    s_cbranch_scc1 L_k2_rare_22
L_k2_exp_23:
    v_exp_f32 v250, v48
    v_exp_f32 v251, v49
    v_exp_f32 v252, v50
    v_cvt_pk_bf16_f32 v80, v250, v251
    v_exp_f32 v253, v51
    v_exp_f32 v254, v52
    v_cvt_pk_bf16_f32 v81, v252, v253
    v_exp_f32 v255, v53
    v_exp_f32 v250, v54
    v_cvt_pk_bf16_f32 v82, v254, v255
    v_exp_f32 v251, v55
    v_exp_f32 v252, v56
    v_cvt_pk_bf16_f32 v83, v250, v251
    v_exp_f32 v253, v57
    v_exp_f32 v254, v58
    v_cvt_pk_bf16_f32 v84, v252, v253
    v_exp_f32 v255, v59
    v_mfma_f32_16x16x32_bf16 v[244:247], v[240:243], v[80:83], 0
    v_exp_f32 v250, v60
    v_cvt_pk_bf16_f32 v85, v254, v255
    v_exp_f32 v251, v61
    v_exp_f32 v252, v62
    v_cvt_pk_bf16_f32 v86, v250, v251
    v_exp_f32 v253, v63
    v_exp_f32 v254, v64
    v_cvt_pk_bf16_f32 v87, v252, v253
    v_exp_f32 v255, v65
    v_exp_f32 v250, v66
    v_cvt_pk_bf16_f32 v88, v254, v255
    v_exp_f32 v251, v67
    v_mfma_f32_16x16x32_bf16 v[244:247], v[240:243], v[84:87], v[244:247]
    v_exp_f32 v252, v68
    v_cvt_pk_bf16_f32 v89, v250, v251
    v_exp_f32 v253, v69
    v_exp_f32 v254, v70
    v_cvt_pk_bf16_f32 v90, v252, v253
    v_exp_f32 v255, v71
    v_exp_f32 v250, v72
    v_cvt_pk_bf16_f32 v91, v254, v255
    v_exp_f32 v251, v73
    v_exp_f32 v252, v74
    v_cvt_pk_bf16_f32 v92, v250, v251
    v_exp_f32 v253, v75
    v_mfma_f32_16x16x32_bf16 v[244:247], v[240:243], v[88:91], v[244:247]
    v_exp_f32 v254, v76
    v_cvt_pk_bf16_f32 v93, v252, v253
    v_exp_f32 v255, v77
    v_exp_f32 v250, v78
    v_cvt_pk_bf16_f32 v94, v254, v255
    v_exp_f32 v251, v79
    s_nop 0
    v_cvt_pk_bf16_f32 v95, v250, v251
    s_nop 1
    v_mfma_f32_16x16x32_bf16 v[244:247], v[240:243], v[92:95], v[244:247]
    s_nop 7
    v_max_f32 v9, v244, v245
    v_cmp_nge_f32 vcc, s42, v9
    s_cbranch_vccnz L_k2_rare_22
    v_add_f32 v248, v248, v244
    v_add_f32 v249, v249, v245
    s_setprio 1
    s_lshl_b32 s45, s38, 14
    s_add_u32 s63, s45, s36
    s_add_u32 s51, s45, s37
    s_mov_b32 m0, s40
    s_add_u32 s38, s38, 1
    v_mfma_f32_32x32x16_bf16 v[160:175], v[96:99], v[80:83], v[160:175]
    ds_read_b128 v[96:99], v5 offset:0
    buffer_load_dwordx4 v6, s[32:35], s63 offen offset:0 lds
    v_mfma_f32_32x32x16_bf16 v[176:191], v[100:103], v[80:83], v[176:191]
    ds_read_b128 v[100:103], v5 offset:1024
    v_mfma_f32_32x32x16_bf16 v[192:207], v[104:107], v[80:83], v[192:207]
    ds_read_b128 v[104:107], v5 offset:2048
    buffer_load_dwordx4 v6, s[32:35], s63 offen offset:1024 lds
    v_mfma_f32_32x32x16_bf16 v[208:223], v[108:111], v[80:83], v[208:223]
    ds_read_b128 v[108:111], v5 offset:3072
    v_mfma_f32_32x32x16_bf16 v[160:175], v[112:115], v[84:87], v[160:175]
    ds_read_b128 v[112:115], v5 offset:4096
    buffer_load_dwordx4 v6, s[32:35], s63 offen offset:2048 lds
    v_mfma_f32_32x32x16_bf16 v[176:191], v[116:119], v[84:87], v[176:191]
    ds_read_b128 v[116:119], v5 offset:5120
    v_mfma_f32_32x32x16_bf16 v[192:207], v[120:123], v[84:87], v[192:207]
    ds_read_b128 v[120:123], v5 offset:6144
    buffer_load_dwordx4 v6, s[32:35], s63 offen offset:3072 lds
    s_mov_b32 m0, s41
    v_mfma_f32_32x32x16_bf16 v[208:223], v[124:127], v[84:87], v[208:223]
    ds_read_b128 v[124:127], v5 offset:7168
    v_mfma_f32_32x32x16_bf16 v[160:175], v[128:131], v[88:91], v[160:175]
    ds_read_b128 v[128:131], v5 offset:8192
    buffer_load_dwordx4 v6, s[32:35], s51 offen offset:0 lds
    v_mfma_f32_32x32x16_bf16 v[176:191], v[132:135], v[88:91], v[176:191]
    ds_read_b128 v[132:135], v5 offset:9216
    v_mfma_f32_32x32x16_bf16 v[192:207], v[136:139], v[88:91], v[192:207]
    ds_read_b128 v[136:139], v5 offset:10240
    buffer_load_dwordx4 v6, s[32:35], s51 offen offset:1024 lds
    v_mfma_f32_32x32x16_bf16 v[208:223], v[140:143], v[88:91], v[208:223]
    ds_read_b128 v[140:143], v5 offset:11264
    v_mfma_f32_32x32x16_bf16 v[160:175], v[144:147], v[92:95], v[160:175]
    ds_read_b128 v[144:147], v5 offset:12288
    buffer_load_dwordx4 v6, s[32:35], s51 offen offset:2048 lds
    v_mfma_f32_32x32x16_bf16 v[176:191], v[148:151], v[92:95], v[176:191]
    ds_read_b128 v[148:151], v5 offset:13312
    v_mfma_f32_32x32x16_bf16 v[192:207], v[152:155], v[92:95], v[192:207]
    ds_read_b128 v[152:155], v5 offset:14336
    buffer_load_dwordx4 v6, s[32:35], s51 offen offset:3072 lds
    v_mfma_f32_32x32x16_bf16 v[208:223], v[156:159], v[92:95], v[208:223]
    ds_read_b128 v[156:159], v5 offset:15360
    s_xor_b32 s40, s40, 0x8000
    s_xor_b32 s41, s41, 0x8000
    s_sub_u32 s43, s43, 1
    s_cmp_lg_u32 s43, 0
    s_cbranch_scc1 L_k2_loop_20
L_k2_loopdone_21:
    s_sub_u32 s45, 7, s6
    s_lshl_b32 s45, s45, 7
    s_lshl_b32 s44, s4, 5
    s_add_u32 s44, s44, s45
    s_add_u32 s44, s44, 64
    s_mov_b32 s43, 2
L_k2_loop_24:
    s_setprio 0
    s_waitcnt lgkmcnt(15)
    v_mfma_f32_32x32x16_bf16 v[48:63], v[96:99], v[16:19], v[224:239]
    ds_read_b128 v[96:99], v5 offset:16384
    s_waitcnt lgkmcnt(15)
    v_mfma_f32_32x32x16_bf16 v[48:63], v[100:103], v[20:23], v[48:63]
    ds_read_b128 v[100:103], v5 offset:20480
    s_waitcnt lgkmcnt(15)
    v_mfma_f32_32x32x16_bf16 v[48:63], v[104:107], v[24:27], v[48:63]
    ds_read_b128 v[104:107], v5 offset:24576
    s_waitcnt lgkmcnt(15)
    v_mfma_f32_32x32x16_bf16 v[48:63], v[108:111], v[28:31], v[48:63]
    ds_read_b128 v[108:111], v5 offset:28672
    s_waitcnt lgkmcnt(15)
    v_mfma_f32_32x32x16_bf16 v[48:63], v[112:115], v[32:35], v[48:63]
    ds_read_b128 v[112:115], v5 offset:17408
    s_waitcnt lgkmcnt(15)
    v_mfma_f32_32x32x16_bf16 v[48:63], v[116:119], v[36:39], v[48:63]
    ds_read_b128 v[116:119], v5 offset:21504
    s_waitcnt lgkmcnt(15)
    v_mfma_f32_32x32x16_bf16 v[48:63], v[120:123], v[40:43], v[48:63]
    ds_read_b128 v[120:123], v5 offset:25600
    s_waitcnt lgkmcnt(15)
    v_mfma_f32_32x32x16_bf16 v[48:63], v[124:127], v[44:47], v[48:63]
    ds_read_b128 v[124:127], v5 offset:29696
    s_waitcnt lgkmcnt(15)
    v_mfma_f32_32x32x16_bf16 v[64:79], v[128:131], v[16:19], v[224:239]
    ds_read_b128 v[128:131], v5 offset:18432
    s_waitcnt lgkmcnt(15)
    v_mfma_f32_32x32x16_bf16 v[64:79], v[132:135], v[20:23], v[64:79]
    ds_read_b128 v[132:135], v5 offset:22528
    s_waitcnt lgkmcnt(15)
    v_mfma_f32_32x32x16_bf16 v[64:79], v[136:139], v[24:27], v[64:79]
    ds_read_b128 v[136:139], v5 offset:26624
    s_waitcnt lgkmcnt(15)
    v_mfma_f32_32x32x16_bf16 v[64:79], v[140:143], v[28:31], v[64:79]
    ds_read_b128 v[140:143], v5 offset:30720
    s_waitcnt lgkmcnt(15)
    v_mfma_f32_32x32x16_bf16 v[64:79], v[144:147], v[32:35], v[64:79]
    ds_read_b128 v[144:147], v5 offset:19456
    s_waitcnt lgkmcnt(15)
    v_mfma_f32_32x32x16_bf16 v[64:79], v[148:151], v[36:39], v[64:79]
    ds_read_b128 v[148:151], v5 offset:23552
    s_waitcnt lgkmcnt(15)
    v_mfma_f32_32x32x16_bf16 v[64:79], v[152:155], v[40:43], v[64:79]
    ds_read_b128 v[152:155], v5 offset:27648
    s_waitcnt lgkmcnt(15)
    v_mfma_f32_32x32x16_bf16 v[64:79], v[156:159], v[44:47], v[64:79]
    ds_read_b128 v[156:159], v5 offset:31744
    s_waitcnt vmcnt(0) lgkmcnt(0)
    s_barrier
    s_xor_b32 s48, s48, 0x8000
    v_add_u32 v5, s48, v4
    s_setprio 3
    v_add_u32 v11, s44, v12
    s_nop 11
    v_cmp_gt_i32 s[52:53], 0, v11
    v_cmp_gt_i32 s[54:55], 1, v11
    v_cmp_gt_i32 s[56:57], 2, v11
    v_cmp_gt_i32 s[58:59], 3, v11
    v_cndmask_b32 v48, v48, v10, s[52:53]
    v_cndmask_b32 v49, v49, v10, s[54:55]
    v_cndmask_b32 v50, v50, v10, s[56:57]
    v_cndmask_b32 v51, v51, v10, s[58:59]
    v_cmp_gt_i32 s[52:53], 8, v11
    v_cmp_gt_i32 s[54:55], 9, v11
    v_cmp_gt_i32 s[56:57], 10, v11
    v_cmp_gt_i32 s[58:59], 11, v11
    v_cndmask_b32 v52, v52, v10, s[52:53]
    v_cndmask_b32 v53, v53, v10, s[54:55]
    v_cndmask_b32 v54, v54, v10, s[56:57]
    v_cndmask_b32 v55, v55, v10, s[58:59]
    v_cmp_gt_i32 s[52:53], 16, v11
    v_cmp_gt_i32 s[54:55], 17, v11
    v_cmp_gt_i32 s[56:57], 18, v11
    v_cmp_gt_i32 s[58:59], 19, v11
    v_cndmask_b32 v56, v56, v10, s[52:53]
    v_cndmask_b32 v57, v57, v10, s[54:55]
    v_cndmask_b32 v58, v58, v10, s[56:57]
    v_cndmask_b32 v59, v59, v10, s[58:59]
    v_cmp_gt_i32 s[52:53], 24, v11
    v_cmp_gt_i32 s[54:55], 25, v11
    v_cmp_gt_i32 s[56:57], 26, v11
    v_cmp_gt_i32 s[58:59], 27, v11
    v_cndmask_b32 v60, v60, v10, s[52:53]
    v_cndmask_b32 v61, v61, v10, s[54:55]
    v_cndmask_b32 v62, v62, v10, s[56:57]
    v_cndmask_b32 v63, v63, v10, s[58:59]
    v_cmp_gt_i32 s[52:53], 32, v11
    v_cmp_gt_i32 s[54:55], 33, v11
    v_cmp_gt_i32 s[56:57], 34, v11
    v_cmp_gt_i32 s[58:59], 35, v11
    v_cndmask_b32 v64, v64, v10, s[52:53]
    v_cndmask_b32 v65, v65, v10, s[54:55]
    v_cndmask_b32 v66, v66, v10, s[56:57]
    v_cndmask_b32 v67, v67, v10, s[58:59]
    v_cmp_gt_i32 s[52:53], 40, v11
    v_cmp_gt_i32 s[54:55], 41, v11
    v_cmp_gt_i32 s[56:57], 42, v11
    v_cmp_gt_i32 s[58:59], 43, v11
    v_cndmask_b32 v68, v68, v10, s[52:53]
    v_cndmask_b32 v69, v69, v10, s[54:55]
    v_cndmask_b32 v70, v70, v10, s[56:57]
    v_cndmask_b32 v71, v71, v10, s[58:59]
    v_cmp_gt_i32 s[52:53], 48, v11
    v_cmp_gt_i32 s[54:55], 49, v11
    v_cmp_gt_i32 s[56:57], 50, v11
    v_cmp_gt_i32 s[58:59], 51, v11
    v_cndmask_b32 v72, v72, v10, s[52:53]
    v_cndmask_b32 v73, v73, v10, s[54:55]
    v_cndmask_b32 v74, v74, v10, s[56:57]
    v_cndmask_b32 v75, v75, v10, s[58:59]
    v_cmp_gt_i32 s[52:53], 56, v11
    v_cmp_gt_i32 s[54:55], 57, v11
    v_cmp_gt_i32 s[56:57], 58, v11
    v_cmp_gt_i32 s[58:59], 59, v11
    v_cndmask_b32 v76, v76, v10, s[52:53]
    v_cndmask_b32 v77, v77, v10, s[54:55]
    v_cndmask_b32 v78, v78, v10, s[56:57]
    v_cndmask_b32 v79, v79, v10, s[58:59]
    s_cmp_lg_u32 s49, 0
    s_cbranch_scc1 L_k2_rare_26
L_k2_exp_27:
    v_exp_f32 v250, v48
    v_exp_f32 v251, v49
    v_exp_f32 v252, v50
    v_cvt_pk_bf16_f32 v80, v250, v251
    v_exp_f32 v253, v51
    v_exp_f32 v254, v52
    v_cvt_pk_bf16_f32 v81, v252, v253
    v_exp_f32 v255, v53
    v_exp_f32 v250, v54
    v_cvt_pk_bf16_f32 v82, v254, v255
    v_exp_f32 v251, v55
    v_exp_f32 v252, v56
    v_cvt_pk_bf16_f32 v83, v250, v251
    v_exp_f32 v253, v57
    v_exp_f32 v254, v58
    v_cvt_pk_bf16_f32 v84, v252, v253
    v_exp_f32 v255, v59
    v_mfma_f32_16x16x32_bf16 v[244:247], v[240:243], v[80:83], 0
    v_exp_f32 v250, v60
    v_cvt_pk_bf16_f32 v85, v254, v255
    v_exp_f32 v251, v61
    v_exp_f32 v252, v62
    v_cvt_pk_bf16_f32 v86, v250, v251
    v_exp_f32 v253, v63
    v_exp_f32 v254, v64
    v_cvt_pk_bf16_f32 v87, v252, v253
    v_exp_f32 v255, v65
    v_exp_f32 v250, v66
    v_cvt_pk_bf16_f32 v88, v254, v255
    v_exp_f32 v251, v67
    v_mfma_f32_16x16x32_bf16 v[244:247], v[240:243], v[84:87], v[244:247]
    v_exp_f32 v252, v68
    v_cvt_pk_bf16_f32 v89, v250, v251
    v_exp_f32 v253, v69
    v_exp_f32 v254, v70
    v_cvt_pk_bf16_f32 v90, v252, v253
    v_exp_f32 v255, v71
    v_exp_f32 v250, v72
    v_cvt_pk_bf16_f32 v91, v254, v255
    v_exp_f32 v251, v73
    v_exp_f32 v252, v74
    v_cvt_pk_bf16_f32 v92, v250, v251
    v_exp_f32 v253, v75
    v_mfma_f32_16x16x32_bf16 v[244:247], v[240:243], v[88:91], v[244:247]
    v_exp_f32 v254, v76
    v_cvt_pk_bf16_f32 v93, v252, v253
    v_exp_f32 v255, v77
    v_exp_f32 v250, v78
    v_cvt_pk_bf16_f32 v94, v254, v255
    v_exp_f32 v251, v79
    s_nop 0
    v_cvt_pk_bf16_f32 v95, v250, v251
    s_nop 1
    v_mfma_f32_16x16x32_bf16 v[244:247], v[240:243], v[92:95], v[244:247]
    s_nop 7
    v_max_f32 v9, v244, v245
    v_cmp_nge_f32 vcc, s42, v9
    s_cbranch_vccnz L_k2_rare_26
    v_add_f32 v248, v248, v244
    v_add_f32 v249, v249, v245
    s_setprio 1
    v_mfma_f32_32x32x16_bf16 v[160:175], v[96:99], v[80:83], v[160:175]
    ds_read_b128 v[96:99], v5 offset:0
    v_mfma_f32_32x32x16_bf16 v[176:191], v[100:103], v[80:83], v[176:191]
    ds_read_b128 v[100:103], v5 offset:1024
    v_mfma_f32_32x32x16_bf16 v[192:207], v[104:107], v[80:83], v[192:207]
    ds_read_b128 v[104:107], v5 offset:2048
    v_mfma_f32_32x32x16_bf16 v[208:223], v[108:111], v[80:83], v[208:223]
    ds_read_b128 v[108:111], v5 offset:3072
    v_mfma_f32_32x32x16_bf16 v[160:175], v[112:115], v[84:87], v[160:175]
    ds_read_b128 v[112:115], v5 offset:4096
    v_mfma_f32_32x32x16_bf16 v[176:191], v[116:119], v[84:87], v[176:191]
    ds_read_b128 v[116:119], v5 offset:5120
    v_mfma_f32_32x32x16_bf16 v[192:207], v[120:123], v[84:87], v[192:207]
    ds_read_b128 v[120:123], v5 offset:6144
    v_mfma_f32_32x32x16_bf16 v[208:223], v[124:127], v[84:87], v[208:223]
    ds_read_b128 v[124:127], v5 offset:7168
    v_mfma_f32_32x32x16_bf16 v[160:175], v[128:131], v[88:91], v[160:175]
    ds_read_b128 v[128:131], v5 offset:8192
    v_mfma_f32_32x32x16_bf16 v[176:191], v[132:135], v[88:91], v[176:191]
    ds_read_b128 v[132:135], v5 offset:9216
    v_mfma_f32_32x32x16_bf16 v[192:207], v[136:139], v[88:91], v[192:207]
    ds_read_b128 v[136:139], v5 offset:10240
    v_mfma_f32_32x32x16_bf16 v[208:223], v[140:143], v[88:91], v[208:223]
    ds_read_b128 v[140:143], v5 offset:11264
    v_mfma_f32_32x32x16_bf16 v[160:175], v[144:147], v[92:95], v[160:175]
    ds_read_b128 v[144:147], v5 offset:12288
    v_mfma_f32_32x32x16_bf16 v[176:191], v[148:151], v[92:95], v[176:191]
    ds_read_b128 v[148:151], v5 offset:13312
    v_mfma_f32_32x32x16_bf16 v[192:207], v[152:155], v[92:95], v[192:207]
    ds_read_b128 v[152:155], v5 offset:14336
    v_mfma_f32_32x32x16_bf16 v[208:223], v[156:159], v[92:95], v[208:223]
    ds_read_b128 v[156:159], v5 offset:15360
    s_sub_u32 s44, s44, 64
    s_sub_u32 s43, s43, 1
    s_cmp_lg_u32 s43, 0
    s_cbranch_scc1 L_k2_loop_24
L_k2_loopdone_25:
L_k2_merge:
    s_waitcnt lgkmcnt(0)
    s_sub_u32 s45, 15, s6
    s_lshl_b32 s45, s45, 2
    s_add_u32 s45, s45, s4
    s_lshl_b32 s45, s45, 5
    s_add_u32 s45, s45, s5
    s_lshl_b32 s45, s45, 13
    s_add_u32 s80, s45, 0x3000000
    s_add_u32 s81, s80, 4096
    v_and_b32 v13, 15, v1
    v_lshlrev_b32 v13, 2, v13
    ds_bpermute_b32 v14, v13, v248
    ds_bpermute_b32 v15, v13, v249
    v_and_b32 v13, 16, v1
    v_cmp_ne_u32 vcc, 0, v13
    s_waitcnt lgkmcnt(0)
    s_nop 1
    v_cndmask_b32 v250, v14, v15, vcc
    v_cmp_lt_f32 vcc, 0, v250
    v_mov_b32 v13, 0xf149f2ca
    s_mul_i32 s45, s3, 8704
    v_cndmask_b32 v7, v13, v7, vcc
    v_add_u32 v14, s45, v4
    s_xor_b32 s46, s3, 4
    s_mul_i32 s46, s46, 8704
    v_add_u32 v15, s46, v4
    v_lshlrev_b32 v11, 2, v1
    v_add_u32 v12, s45, v11
    v_add_u32 v11, s46, v11
    ds_write_b32 v12, v7 offset:8192
    ds_write_b32 v12, v250 offset:8448
    s_cmp_eq_u32 s7, 0
    s_cbranch_scc0 L_k2_mergeB
    ds_write_b128 v14, v[192:195] offset:0
    ds_write_b128 v14, v[196:199] offset:1024
    ds_write_b128 v14, v[200:203] offset:2048
    ds_write_b128 v14, v[204:207] offset:3072
    ds_write_b128 v14, v[208:211] offset:4096
    ds_write_b128 v14, v[212:215] offset:5120
    ds_write_b128 v14, v[216:219] offset:6144
    ds_write_b128 v14, v[220:223] offset:7168
    s_waitcnt lgkmcnt(0)
    s_barrier
    ds_read_b32 v48, v11 offset:8192
    ds_read_b32 v49, v11 offset:8448
    ds_read_b128 v[96:99], v15 offset:0
    ds_read_b128 v[100:103], v15 offset:1024
    ds_read_b128 v[104:107], v15 offset:2048
    ds_read_b128 v[108:111], v15 offset:3072
    ds_read_b128 v[112:115], v15 offset:4096
    ds_read_b128 v[116:119], v15 offset:5120
    ds_read_b128 v[120:123], v15 offset:6144
    ds_read_b128 v[124:127], v15 offset:7168
    s_waitcnt lgkmcnt(8)
    v_max_f32 v8, v7, v48
    v_sub_f32 v50, v7, v8
    v_sub_f32 v51, v48, v8
    v_exp_f32 v50, v50
    v_exp_f32 v51, v51
    s_nop 0
    v_mul_f32 v8, v250, v50
    v_fma_f32 v8, v49, v51, v8
    v_rcp_f32 v8, v8
    s_nop 0
    v_mul_f32 v50, v50, v8
    v_mul_f32 v51, v51, v8
    s_waitcnt lgkmcnt(0)
    v_mul_f32 v56, v160, v50
    v_fma_f32 v56, v96, v51, v56
    v_mul_f32 v57, v161, v50
    v_fma_f32 v57, v97, v51, v57
    v_mul_f32 v58, v162, v50
    v_fma_f32 v58, v98, v51, v58
    v_mul_f32 v59, v163, v50
    v_fma_f32 v59, v99, v51, v59
    v_mul_f32 v60, v164, v50
    v_fma_f32 v60, v100, v51, v60
    v_mul_f32 v61, v165, v50
    v_fma_f32 v61, v101, v51, v61
    v_mul_f32 v62, v166, v50
    v_fma_f32 v62, v102, v51, v62
    v_mul_f32 v63, v167, v50
    v_fma_f32 v63, v103, v51, v63
    v_cvt_pk_bf16_f32 v56, v56, v57
    v_cvt_pk_bf16_f32 v57, v58, v59
    v_cvt_pk_bf16_f32 v58, v60, v61
    v_cvt_pk_bf16_f32 v59, v62, v63
    buffer_store_dwordx4 v[56:59], v4, s[32:35], s80 offen offset:0 sc1
    v_mul_f32 v64, v168, v50
    v_fma_f32 v64, v104, v51, v64
    v_mul_f32 v65, v169, v50
    v_fma_f32 v65, v105, v51, v65
    v_mul_f32 v66, v170, v50
    v_fma_f32 v66, v106, v51, v66
    v_mul_f32 v67, v171, v50
    v_fma_f32 v67, v107, v51, v67
    v_mul_f32 v68, v172, v50
    v_fma_f32 v68, v108, v51, v68
    v_mul_f32 v69, v173, v50
    v_fma_f32 v69, v109, v51, v69
    v_mul_f32 v70, v174, v50
    v_fma_f32 v70, v110, v51, v70
    v_mul_f32 v71, v175, v50
    v_fma_f32 v71, v111, v51, v71
    v_cvt_pk_bf16_f32 v64, v64, v65
    v_cvt_pk_bf16_f32 v65, v66, v67
    v_cvt_pk_bf16_f32 v66, v68, v69
    v_cvt_pk_bf16_f32 v67, v70, v71
    buffer_store_dwordx4 v[64:67], v4, s[32:35], s80 offen offset:1024 sc1
    v_mul_f32 v56, v176, v50
    v_fma_f32 v56, v112, v51, v56
    v_mul_f32 v57, v177, v50
    v_fma_f32 v57, v113, v51, v57
    v_mul_f32 v58, v178, v50
    v_fma_f32 v58, v114, v51, v58
    v_mul_f32 v59, v179, v50
    v_fma_f32 v59, v115, v51, v59
    v_mul_f32 v60, v180, v50
    v_fma_f32 v60, v116, v51, v60
    v_mul_f32 v61, v181, v50
    v_fma_f32 v61, v117, v51, v61
    v_mul_f32 v62, v182, v50
    v_fma_f32 v62, v118, v51, v62
    v_mul_f32 v63, v183, v50
    v_fma_f32 v63, v119, v51, v63
    v_cvt_pk_bf16_f32 v56, v56, v57
    v_cvt_pk_bf16_f32 v57, v58, v59
    v_cvt_pk_bf16_f32 v58, v60, v61
    v_cvt_pk_bf16_f32 v59, v62, v63
    buffer_store_dwordx4 v[56:59], v4, s[32:35], s80 offen offset:2048 sc1
    v_mul_f32 v64, v184, v50
    v_fma_f32 v64, v120, v51, v64
    v_mul_f32 v65, v185, v50
    v_fma_f32 v65, v121, v51, v65
    v_mul_f32 v66, v186, v50
    v_fma_f32 v66, v122, v51, v66
    v_mul_f32 v67, v187, v50
    v_fma_f32 v67, v123, v51, v67
    v_mul_f32 v68, v188, v50
    v_fma_f32 v68, v124, v51, v68
    v_mul_f32 v69, v189, v50
    v_fma_f32 v69, v125, v51, v69
    v_mul_f32 v70, v190, v50
    v_fma_f32 v70, v126, v51, v70
    v_mul_f32 v71, v191, v50
    v_fma_f32 v71, v127, v51, v71
    v_cvt_pk_bf16_f32 v64, v64, v65
    v_cvt_pk_bf16_f32 v65, v66, v67
    v_cvt_pk_bf16_f32 v66, v68, v69
    v_cvt_pk_bf16_f32 v67, v70, v71
    buffer_store_dwordx4 v[64:67], v4, s[32:35], s80 offen offset:3072 sc1
    s_branch L_k2_scan
L_k2_mergeB:
    ds_write_b128 v14, v[160:163] offset:0
    ds_write_b128 v14, v[164:167] offset:1024
    ds_write_b128 v14, v[168:171] offset:2048
    ds_write_b128 v14, v[172:175] offset:3072
    ds_write_b128 v14, v[176:179] offset:4096
    ds_write_b128 v14, v[180:183] offset:5120
    ds_write_b128 v14, v[184:187] offset:6144
    ds_write_b128 v14, v[188:191] offset:7168
    s_waitcnt lgkmcnt(0)
    s_barrier
    ds_read_b32 v48, v11 offset:8192
    ds_read_b32 v49, v11 offset:8448
    ds_read_b128 v[96:99], v15 offset:0
    ds_read_b128 v[100:103], v15 offset:1024
    ds_read_b128 v[104:107], v15 offset:2048
    ds_read_b128 v[108:111], v15 offset:3072
    ds_read_b128 v[112:115], v15 offset:4096
    ds_read_b128 v[116:119], v15 offset:5120
    ds_read_b128 v[120:123], v15 offset:6144
    ds_read_b128 v[124:127], v15 offset:7168
    s_waitcnt lgkmcnt(8)
    v_max_f32 v8, v7, v48
    v_sub_f32 v50, v7, v8
    v_sub_f32 v51, v48, v8
    v_exp_f32 v50, v50
    v_exp_f32 v51, v51
    s_nop 0
    v_mul_f32 v8, v250, v50
    v_fma_f32 v8, v49, v51, v8
    v_rcp_f32 v8, v8
    s_nop 0
    v_mul_f32 v50, v50, v8
    v_mul_f32 v51, v51, v8
    s_waitcnt lgkmcnt(0)
    v_mul_f32 v56, v192, v50
    v_fma_f32 v56, v96, v51, v56
    v_mul_f32 v57, v193, v50
    v_fma_f32 v57, v97, v51, v57
    v_mul_f32 v58, v194, v50
    v_fma_f32 v58, v98, v51, v58
    v_mul_f32 v59, v195, v50
    v_fma_f32 v59, v99, v51, v59
    v_mul_f32 v60, v196, v50
    v_fma_f32 v60, v100, v51, v60
    v_mul_f32 v61, v197, v50
    v_fma_f32 v61, v101, v51, v61
    v_mul_f32 v62, v198, v50
    v_fma_f32 v62, v102, v51, v62
    v_mul_f32 v63, v199, v50
    v_fma_f32 v63, v103, v51, v63
    v_cvt_pk_bf16_f32 v56, v56, v57
    v_cvt_pk_bf16_f32 v57, v58, v59
    v_cvt_pk_bf16_f32 v58, v60, v61
    v_cvt_pk_bf16_f32 v59, v62, v63
    buffer_store_dwordx4 v[56:59], v4, s[32:35], s81 offen offset:0 sc1
    v_mul_f32 v64, v200, v50
    v_fma_f32 v64, v104, v51, v64
    v_mul_f32 v65, v201, v50
    v_fma_f32 v65, v105, v51, v65
    v_mul_f32 v66, v202, v50
    v_fma_f32 v66, v106, v51, v66
    v_mul_f32 v67, v203, v50
    v_fma_f32 v67, v107, v51, v67
    v_mul_f32 v68, v204, v50
    v_fma_f32 v68, v108, v51, v68
    v_mul_f32 v69, v205, v50
    v_fma_f32 v69, v109, v51, v69
    v_mul_f32 v70, v206, v50
    v_fma_f32 v70, v110, v51, v70
    v_mul_f32 v71, v207, v50
    v_fma_f32 v71, v111, v51, v71
    v_cvt_pk_bf16_f32 v64, v64, v65
    v_cvt_pk_bf16_f32 v65, v66, v67
    v_cvt_pk_bf16_f32 v66, v68, v69
    v_cvt_pk_bf16_f32 v67, v70, v71
    buffer_store_dwordx4 v[64:67], v4, s[32:35], s81 offen offset:1024 sc1
    v_mul_f32 v56, v208, v50
    v_fma_f32 v56, v112, v51, v56
    v_mul_f32 v57, v209, v50
    v_fma_f32 v57, v113, v51, v57
    v_mul_f32 v58, v210, v50
    v_fma_f32 v58, v114, v51, v58
    v_mul_f32 v59, v211, v50
    v_fma_f32 v59, v115, v51, v59
    v_mul_f32 v60, v212, v50
    v_fma_f32 v60, v116, v51, v60
    v_mul_f32 v61, v213, v50
    v_fma_f32 v61, v117, v51, v61
    v_mul_f32 v62, v214, v50
    v_fma_f32 v62, v118, v51, v62
    v_mul_f32 v63, v215, v50
    v_fma_f32 v63, v119, v51, v63
    v_cvt_pk_bf16_f32 v56, v56, v57
    v_cvt_pk_bf16_f32 v57, v58, v59
    v_cvt_pk_bf16_f32 v58, v60, v61
    v_cvt_pk_bf16_f32 v59, v62, v63
    buffer_store_dwordx4 v[56:59], v4, s[32:35], s81 offen offset:2048 sc1
    v_mul_f32 v64, v216, v50
    v_fma_f32 v64, v120, v51, v64
    v_mul_f32 v65, v217, v50
    v_fma_f32 v65, v121, v51, v65
    v_mul_f32 v66, v218, v50
    v_fma_f32 v66, v122, v51, v66
    v_mul_f32 v67, v219, v50
    v_fma_f32 v67, v123, v51, v67
    v_mul_f32 v68, v220, v50
    v_fma_f32 v68, v124, v51, v68
    v_mul_f32 v69, v221, v50
    v_fma_f32 v69, v125, v51, v69
    v_mul_f32 v70, v222, v50
    v_fma_f32 v70, v126, v51, v70
    v_mul_f32 v71, v223, v50
    v_fma_f32 v71, v127, v51, v71
    v_cvt_pk_bf16_f32 v64, v64, v65
    v_cvt_pk_bf16_f32 v65, v66, v67
    v_cvt_pk_bf16_f32 v66, v68, v69
    v_cvt_pk_bf16_f32 v67, v70, v71
    buffer_store_dwordx4 v[64:67], v4, s[32:35], s81 offen offset:3072 sc1
L_k2_scan:
    s_branch L_k2_end
L_k2_rare_6:
    s_nop 11
    v_max3_f32 v8, v48, v49, v50
    v_max3_f32 v8, v8, v51, v52
    v_max3_f32 v8, v8, v53, v54
    v_max3_f32 v8, v8, v55, v56
    v_max3_f32 v8, v8, v57, v58
    v_max3_f32 v8, v8, v59, v60
    v_max3_f32 v8, v8, v61, v62
    v_max3_f32 v8, v8, v63, v64
    v_max3_f32 v8, v8, v65, v66
    v_max3_f32 v8, v8, v67, v68
    v_max3_f32 v8, v8, v69, v70
    v_max3_f32 v8, v8, v71, v72
    v_max3_f32 v8, v8, v73, v74
    v_max3_f32 v8, v8, v75, v76
    v_max3_f32 v8, v8, v77, v78
    v_max_f32 v8, v8, v79
    v_mov_b32 v9, v8
    s_nop 1
    v_permlane32_swap_b32 v8, v9
    v_max_f32 v8, v8, v9
    v_max_f32 v8, s50, v8
    v_mov_b32 v13, 0xf149f2ca
    v_cmp_lt_f32 vcc, v13, v8
    s_mov_b32 s49, 0
    s_mov_b32 s50, 0
    v_cndmask_b32 v8, 0, v8, vcc
    v_max_f32 v13, 0, v8
    v_exp_f32 v13, -v13
    v_add_f32 v7, v7, v8
    v_mul_f32 v13, s30, v13
    s_mov_b32 s30, 1.0
    v_mov_b32 v14, v13
    v_mov_b32 v15, v13
    v_sub_f32 v224, 0, v7
    v_sub_f32 v225, 0, v7
    v_sub_f32 v226, 0, v7
    v_sub_f32 v227, 0, v7
    v_sub_f32 v228, 0, v7
    v_sub_f32 v229, 0, v7
    v_sub_f32 v230, 0, v7
    v_sub_f32 v231, 0, v7
    v_sub_f32 v232, 0, v7
    v_sub_f32 v233, 0, v7
    v_sub_f32 v234, 0, v7
    v_sub_f32 v235, 0, v7
    v_sub_f32 v236, 0, v7
    v_sub_f32 v237, 0, v7
    v_sub_f32 v238, 0, v7
    v_sub_f32 v239, 0, v7
    v_permlane16_swap_b32 v14, v15
    v_mul_f32 v248, v248, v13
    v_mul_f32 v249, v249, v15
    v_sub_f32 v48, v48, v8
    v_sub_f32 v49, v49, v8
    v_sub_f32 v50, v50, v8
    v_sub_f32 v51, v51, v8
    v_sub_f32 v52, v52, v8
    v_sub_f32 v53, v53, v8
    v_sub_f32 v54, v54, v8
    v_sub_f32 v55, v55, v8
    v_sub_f32 v56, v56, v8
    v_sub_f32 v57, v57, v8
    v_sub_f32 v58, v58, v8
    v_sub_f32 v59, v59, v8
    v_sub_f32 v60, v60, v8
    v_sub_f32 v61, v61, v8
    v_sub_f32 v62, v62, v8
    v_sub_f32 v63, v63, v8
    v_sub_f32 v64, v64, v8
    v_sub_f32 v65, v65, v8
    v_sub_f32 v66, v66, v8
    v_sub_f32 v67, v67, v8
    v_sub_f32 v68, v68, v8
    v_sub_f32 v69, v69, v8
    v_sub_f32 v70, v70, v8
    v_sub_f32 v71, v71, v8
    v_sub_f32 v72, v72, v8
    v_sub_f32 v73, v73, v8
    v_sub_f32 v74, v74, v8
    v_sub_f32 v75, v75, v8
    v_sub_f32 v76, v76, v8
    v_sub_f32 v77, v77, v8
    v_sub_f32 v78, v78, v8
    v_sub_f32 v79, v79, v8
    v_mul_f32 v160, v160, v13
    v_mul_f32 v161, v161, v13
    v_mul_f32 v162, v162, v13
    v_mul_f32 v163, v163, v13
    v_mul_f32 v164, v164, v13
    v_mul_f32 v165, v165, v13
    v_mul_f32 v166, v166, v13
    v_mul_f32 v167, v167, v13
    v_mul_f32 v168, v168, v13
    v_mul_f32 v169, v169, v13
    v_mul_f32 v170, v170, v13
    v_mul_f32 v171, v171, v13
    v_mul_f32 v172, v172, v13
    v_mul_f32 v173, v173, v13
    v_mul_f32 v174, v174, v13
    v_mul_f32 v175, v175, v13
    v_mul_f32 v176, v176, v13
    v_mul_f32 v177, v177, v13
    v_mul_f32 v178, v178, v13
    v_mul_f32 v179, v179, v13
    v_mul_f32 v180, v180, v13
    v_mul_f32 v181, v181, v13
    v_mul_f32 v182, v182, v13
    v_mul_f32 v183, v183, v13
    v_mul_f32 v184, v184, v13
    v_mul_f32 v185, v185, v13
    v_mul_f32 v186, v186, v13
    v_mul_f32 v187, v187, v13
    v_mul_f32 v188, v188, v13
    v_mul_f32 v189, v189, v13
    v_mul_f32 v190, v190, v13
    v_mul_f32 v191, v191, v13
    v_mul_f32 v192, v192, v13
    v_mul_f32 v193, v193, v13
    v_mul_f32 v194, v194, v13
    v_mul_f32 v195, v195, v13
    v_mul_f32 v196, v196, v13
    v_mul_f32 v197, v197, v13
    v_mul_f32 v198, v198, v13
    v_mul_f32 v199, v199, v13
    v_mul_f32 v200, v200, v13
    v_mul_f32 v201, v201, v13
    v_mul_f32 v202, v202, v13
    v_mul_f32 v203, v203, v13
    v_mul_f32 v204, v204, v13
    v_mul_f32 v205, v205, v13
    v_mul_f32 v206, v206, v13
    v_mul_f32 v207, v207, v13
    v_mul_f32 v208, v208, v13
    v_mul_f32 v209, v209, v13
    v_mul_f32 v210, v210, v13
    v_mul_f32 v211, v211, v13
    v_mul_f32 v212, v212, v13
    v_mul_f32 v213, v213, v13
    v_mul_f32 v214, v214, v13
    v_mul_f32 v215, v215, v13
    v_mul_f32 v216, v216, v13
    v_mul_f32 v217, v217, v13
    v_mul_f32 v218, v218, v13
    v_mul_f32 v219, v219, v13
    v_mul_f32 v220, v220, v13
    v_mul_f32 v221, v221, v13
    v_mul_f32 v222, v222, v13
    v_mul_f32 v223, v223, v13
    s_branch L_k2_exp_7
L_k2_rare_10:
    s_nop 11
    v_max3_f32 v8, v48, v49, v50
    v_max3_f32 v8, v8, v51, v52
    v_max3_f32 v8, v8, v53, v54
    v_max3_f32 v8, v8, v55, v56
    v_max3_f32 v8, v8, v57, v58
    v_max3_f32 v8, v8, v59, v60
    v_max3_f32 v8, v8, v61, v62
    v_max3_f32 v8, v8, v63, v64
    v_max3_f32 v8, v8, v65, v66
    v_max3_f32 v8, v8, v67, v68
    v_max3_f32 v8, v8, v69, v70
    v_max3_f32 v8, v8, v71, v72
    v_max3_f32 v8, v8, v73, v74
    v_max3_f32 v8, v8, v75, v76
    v_max3_f32 v8, v8, v77, v78
    v_max_f32 v8, v8, v79
    v_mov_b32 v9, v8
    s_nop 1
    v_permlane32_swap_b32 v8, v9
    v_max_f32 v8, v8, v9
    v_max_f32 v8, s50, v8
    v_mov_b32 v13, 0xf149f2ca
    v_cmp_lt_f32 vcc, v13, v8
    s_mov_b32 s49, 0
    s_mov_b32 s50, 0
    v_cndmask_b32 v8, 0, v8, vcc
    v_max_f32 v13, 0, v8
    v_exp_f32 v13, -v13
    v_add_f32 v7, v7, v8
    v_mul_f32 v13, s30, v13
    s_mov_b32 s30, 1.0
    v_mov_b32 v14, v13
    v_mov_b32 v15, v13
    v_sub_f32 v224, 0, v7
    v_sub_f32 v225, 0, v7
    v_sub_f32 v226, 0, v7
    v_sub_f32 v227, 0, v7
    v_sub_f32 v228, 0, v7
    v_sub_f32 v229, 0, v7
    v_sub_f32 v230, 0, v7
    v_sub_f32 v231, 0, v7
    v_sub_f32 v232, 0, v7
    v_sub_f32 v233, 0, v7
    v_sub_f32 v234, 0, v7
    v_sub_f32 v235, 0, v7
    v_sub_f32 v236, 0, v7
    v_sub_f32 v237, 0, v7
    v_sub_f32 v238, 0, v7
    v_sub_f32 v239, 0, v7
    v_permlane16_swap_b32 v14, v15
    v_mul_f32 v248, v248, v13
    v_mul_f32 v249, v249, v15
    v_sub_f32 v48, v48, v8
    v_sub_f32 v49, v49, v8
    v_sub_f32 v50, v50, v8
    v_sub_f32 v51, v51, v8
    v_sub_f32 v52, v52, v8
    v_sub_f32 v53, v53, v8
    v_sub_f32 v54, v54, v8
    v_sub_f32 v55, v55, v8
    v_sub_f32 v56, v56, v8
    v_sub_f32 v57, v57, v8
    v_sub_f32 v58, v58, v8
    v_sub_f32 v59, v59, v8
    v_sub_f32 v60, v60, v8
    v_sub_f32 v61, v61, v8
    v_sub_f32 v62, v62, v8
    v_sub_f32 v63, v63, v8
    v_sub_f32 v64, v64, v8
    v_sub_f32 v65, v65, v8
    v_sub_f32 v66, v66, v8
    v_sub_f32 v67, v67, v8
    v_sub_f32 v68, v68, v8
    v_sub_f32 v69, v69, v8
    v_sub_f32 v70, v70, v8
    v_sub_f32 v71, v71, v8
    v_sub_f32 v72, v72, v8
    v_sub_f32 v73, v73, v8
    v_sub_f32 v74, v74, v8
    v_sub_f32 v75, v75, v8
    v_sub_f32 v76, v76, v8
    v_sub_f32 v77, v77, v8
    v_sub_f32 v78, v78, v8
    v_sub_f32 v79, v79, v8
    v_mul_f32 v160, v160, v13
    v_mul_f32 v161, v161, v13
    v_mul_f32 v162, v162, v13
    v_mul_f32 v163, v163, v13
    v_mul_f32 v164, v164, v13
    v_mul_f32 v165, v165, v13
    v_mul_f32 v166, v166, v13
    v_mul_f32 v167, v167, v13
    v_mul_f32 v168, v168, v13
    v_mul_f32 v169, v169, v13
    v_mul_f32 v170, v170, v13
    v_mul_f32 v171, v171, v13
    v_mul_f32 v172, v172, v13
    v_mul_f32 v173, v173, v13
    v_mul_f32 v174, v174, v13
    v_mul_f32 v175, v175, v13
    v_mul_f32 v176, v176, v13
    v_mul_f32 v177, v177, v13
    v_mul_f32 v178, v178, v13
    v_mul_f32 v179, v179, v13
    v_mul_f32 v180, v180, v13
    v_mul_f32 v181, v181, v13
    v_mul_f32 v182, v182, v13
    v_mul_f32 v183, v183, v13
    v_mul_f32 v184, v184, v13
    v_mul_f32 v185, v185, v13
    v_mul_f32 v186, v186, v13
    v_mul_f32 v187, v187, v13
    v_mul_f32 v188, v188, v13
    v_mul_f32 v189, v189, v13
    v_mul_f32 v190, v190, v13
    v_mul_f32 v191, v191, v13
    v_mul_f32 v192, v192, v13
    v_mul_f32 v193, v193, v13
    v_mul_f32 v194, v194, v13
    v_mul_f32 v195, v195, v13
    v_mul_f32 v196, v196, v13
    v_mul_f32 v197, v197, v13
    v_mul_f32 v198, v198, v13
    v_mul_f32 v199, v199, v13
    v_mul_f32 v200, v200, v13
    v_mul_f32 v201, v201, v13
    v_mul_f32 v202, v202, v13
    v_mul_f32 v203, v203, v13
    v_mul_f32 v204, v204, v13
    v_mul_f32 v205, v205, v13
    v_mul_f32 v206, v206, v13
    v_mul_f32 v207, v207, v13
    v_mul_f32 v208, v208, v13
    v_mul_f32 v209, v209, v13
    v_mul_f32 v210, v210, v13
    v_mul_f32 v211, v211, v13
    v_mul_f32 v212, v212, v13
    v_mul_f32 v213, v213, v13
    v_mul_f32 v214, v214, v13
    v_mul_f32 v215, v215, v13
    v_mul_f32 v216, v216, v13
    v_mul_f32 v217, v217, v13
    v_mul_f32 v218, v218, v13
    v_mul_f32 v219, v219, v13
    v_mul_f32 v220, v220, v13
    v_mul_f32 v221, v221, v13
    v_mul_f32 v222, v222, v13
    v_mul_f32 v223, v223, v13
    s_branch L_k2_exp_11
L_k2_rare_14:
    s_nop 11
    v_max3_f32 v8, v48, v49, v50
    v_max3_f32 v8, v8, v51, v52
    v_max3_f32 v8, v8, v53, v54
    v_max3_f32 v8, v8, v55, v56
    v_max3_f32 v8, v8, v57, v58
    v_max3_f32 v8, v8, v59, v60
    v_max3_f32 v8, v8, v61, v62
    v_max3_f32 v8, v8, v63, v64
    v_max3_f32 v8, v8, v65, v66
    v_max3_f32 v8, v8, v67, v68
    v_max3_f32 v8, v8, v69, v70
    v_max3_f32 v8, v8, v71, v72
    v_max3_f32 v8, v8, v73, v74
    v_max3_f32 v8, v8, v75, v76
    v_max3_f32 v8, v8, v77, v78
    v_max_f32 v8, v8, v79
    v_mov_b32 v9, v8
    s_nop 1
    v_permlane32_swap_b32 v8, v9
    v_max_f32 v8, v8, v9
    v_max_f32 v8, s50, v8
    v_mov_b32 v13, 0xf149f2ca
    v_cmp_lt_f32 vcc, v13, v8
    s_mov_b32 s49, 0
    s_mov_b32 s50, 0
    v_cndmask_b32 v8, 0, v8, vcc
    v_max_f32 v13, 0, v8
    v_exp_f32 v13, -v13
    v_add_f32 v7, v7, v8
    v_mul_f32 v13, s30, v13
    s_mov_b32 s30, 1.0
    v_mov_b32 v14, v13
    v_mov_b32 v15, v13
    v_sub_f32 v224, 0, v7
    v_sub_f32 v225, 0, v7
    v_sub_f32 v226, 0, v7
    v_sub_f32 v227, 0, v7
    v_sub_f32 v228, 0, v7
    v_sub_f32 v229, 0, v7
    v_sub_f32 v230, 0, v7
    v_sub_f32 v231, 0, v7
    v_sub_f32 v232, 0, v7
    v_sub_f32 v233, 0, v7
    v_sub_f32 v234, 0, v7
    v_sub_f32 v235, 0, v7
    v_sub_f32 v236, 0, v7
    v_sub_f32 v237, 0, v7
    v_sub_f32 v238, 0, v7
    v_sub_f32 v239, 0, v7
    v_permlane16_swap_b32 v14, v15
    v_mul_f32 v248, v248, v13
    v_mul_f32 v249, v249, v15
    v_sub_f32 v48, v48, v8
    v_sub_f32 v49, v49, v8
    v_sub_f32 v50, v50, v8
    v_sub_f32 v51, v51, v8
    v_sub_f32 v52, v52, v8
    v_sub_f32 v53, v53, v8
    v_sub_f32 v54, v54, v8
    v_sub_f32 v55, v55, v8
    v_sub_f32 v56, v56, v8
    v_sub_f32 v57, v57, v8
    v_sub_f32 v58, v58, v8
    v_sub_f32 v59, v59, v8
    v_sub_f32 v60, v60, v8
    v_sub_f32 v61, v61, v8
    v_sub_f32 v62, v62, v8
    v_sub_f32 v63, v63, v8
    v_sub_f32 v64, v64, v8
    v_sub_f32 v65, v65, v8
    v_sub_f32 v66, v66, v8
    v_sub_f32 v67, v67, v8
    v_sub_f32 v68, v68, v8
    v_sub_f32 v69, v69, v8
    v_sub_f32 v70, v70, v8
    v_sub_f32 v71, v71, v8
    v_sub_f32 v72, v72, v8
    v_sub_f32 v73, v73, v8
    v_sub_f32 v74, v74, v8
    v_sub_f32 v75, v75, v8
    v_sub_f32 v76, v76, v8
    v_sub_f32 v77, v77, v8
    v_sub_f32 v78, v78, v8
    v_sub_f32 v79, v79, v8
    v_mul_f32 v160, v160, v13
    v_mul_f32 v161, v161, v13
    v_mul_f32 v162, v162, v13
    v_mul_f32 v163, v163, v13
    v_mul_f32 v164, v164, v13
    v_mul_f32 v165, v165, v13
    v_mul_f32 v166, v166, v13
    v_mul_f32 v167, v167, v13
    v_mul_f32 v168, v168, v13
    v_mul_f32 v169, v169, v13
    v_mul_f32 v170, v170, v13
    v_mul_f32 v171, v171, v13
    v_mul_f32 v172, v172, v13
    v_mul_f32 v173, v173, v13
    v_mul_f32 v174, v174, v13
    v_mul_f32 v175, v175, v13
    v_mul_f32 v176, v176, v13
    v_mul_f32 v177, v177, v13
    v_mul_f32 v178, v178, v13
    v_mul_f32 v179, v179, v13
    v_mul_f32 v180, v180, v13
    v_mul_f32 v181, v181, v13
    v_mul_f32 v182, v182, v13
    v_mul_f32 v183, v183, v13
    v_mul_f32 v184, v184, v13
    v_mul_f32 v185, v185, v13
    v_mul_f32 v186, v186, v13
    v_mul_f32 v187, v187, v13
    v_mul_f32 v188, v188, v13
    v_mul_f32 v189, v189, v13
    v_mul_f32 v190, v190, v13
    v_mul_f32 v191, v191, v13
    v_mul_f32 v192, v192, v13
    v_mul_f32 v193, v193, v13
    v_mul_f32 v194, v194, v13
    v_mul_f32 v195, v195, v13
    v_mul_f32 v196, v196, v13
    v_mul_f32 v197, v197, v13
    v_mul_f32 v198, v198, v13
    v_mul_f32 v199, v199, v13
    v_mul_f32 v200, v200, v13
    v_mul_f32 v201, v201, v13
    v_mul_f32 v202, v202, v13
    v_mul_f32 v203, v203, v13
    v_mul_f32 v204, v204, v13
    v_mul_f32 v205, v205, v13
    v_mul_f32 v206, v206, v13
    v_mul_f32 v207, v207, v13
    v_mul_f32 v208, v208, v13
    v_mul_f32 v209, v209, v13
    v_mul_f32 v210, v210, v13
    v_mul_f32 v211, v211, v13
    v_mul_f32 v212, v212, v13
    v_mul_f32 v213, v213, v13
    v_mul_f32 v214, v214, v13
    v_mul_f32 v215, v215, v13
    v_mul_f32 v216, v216, v13
    v_mul_f32 v217, v217, v13
    v_mul_f32 v218, v218, v13
    v_mul_f32 v219, v219, v13
    v_mul_f32 v220, v220, v13
    v_mul_f32 v221, v221, v13
    v_mul_f32 v222, v222, v13
    v_mul_f32 v223, v223, v13
    s_branch L_k2_exp_15
L_k2_rare_18:
    s_nop 11
    v_max3_f32 v8, v48, v49, v50
    v_max3_f32 v8, v8, v51, v52
    v_max3_f32 v8, v8, v53, v54
    v_max3_f32 v8, v8, v55, v56
    v_max3_f32 v8, v8, v57, v58
    v_max3_f32 v8, v8, v59, v60
    v_max3_f32 v8, v8, v61, v62
    v_max3_f32 v8, v8, v63, v64
    v_max3_f32 v8, v8, v65, v66
    v_max3_f32 v8, v8, v67, v68
    v_max3_f32 v8, v8, v69, v70
    v_max3_f32 v8, v8, v71, v72
    v_max3_f32 v8, v8, v73, v74
    v_max3_f32 v8, v8, v75, v76
    v_max3_f32 v8, v8, v77, v78
    v_max_f32 v8, v8, v79
    v_mov_b32 v9, v8
    s_nop 1
    v_permlane32_swap_b32 v8, v9
    v_max_f32 v8, v8, v9
    v_max_f32 v8, s50, v8
    v_mov_b32 v13, 0xf149f2ca
    v_cmp_lt_f32 vcc, v13, v8
    s_mov_b32 s49, 0
    s_mov_b32 s50, 0
    v_cndmask_b32 v8, 0, v8, vcc
    v_max_f32 v13, 0, v8
    v_exp_f32 v13, -v13
    v_add_f32 v7, v7, v8
    v_mul_f32 v13, s30, v13
    s_mov_b32 s30, 1.0
    v_mov_b32 v14, v13
    v_mov_b32 v15, v13
    v_sub_f32 v224, 0, v7
    v_sub_f32 v225, 0, v7
    v_sub_f32 v226, 0, v7
    v_sub_f32 v227, 0, v7
    v_sub_f32 v228, 0, v7
    v_sub_f32 v229, 0, v7
    v_sub_f32 v230, 0, v7
    v_sub_f32 v231, 0, v7
    v_sub_f32 v232, 0, v7
    v_sub_f32 v233, 0, v7
    v_sub_f32 v234, 0, v7
    v_sub_f32 v235, 0, v7
    v_sub_f32 v236, 0, v7
    v_sub_f32 v237, 0, v7
    v_sub_f32 v238, 0, v7
    v_sub_f32 v239, 0, v7
    v_permlane16_swap_b32 v14, v15
    v_mul_f32 v248, v248, v13
    v_mul_f32 v249, v249, v15
    v_sub_f32 v48, v48, v8
    v_sub_f32 v49, v49, v8
    v_sub_f32 v50, v50, v8
    v_sub_f32 v51, v51, v8
    v_sub_f32 v52, v52, v8
    v_sub_f32 v53, v53, v8
    v_sub_f32 v54, v54, v8
    v_sub_f32 v55, v55, v8
    v_sub_f32 v56, v56, v8
    v_sub_f32 v57, v57, v8
    v_sub_f32 v58, v58, v8
    v_sub_f32 v59, v59, v8
    v_sub_f32 v60, v60, v8
    v_sub_f32 v61, v61, v8
    v_sub_f32 v62, v62, v8
    v_sub_f32 v63, v63, v8
    v_sub_f32 v64, v64, v8
    v_sub_f32 v65, v65, v8
    v_sub_f32 v66, v66, v8
    v_sub_f32 v67, v67, v8
    v_sub_f32 v68, v68, v8
    v_sub_f32 v69, v69, v8
    v_sub_f32 v70, v70, v8
    v_sub_f32 v71, v71, v8
    v_sub_f32 v72, v72, v8
    v_sub_f32 v73, v73, v8
    v_sub_f32 v74, v74, v8
    v_sub_f32 v75, v75, v8
    v_sub_f32 v76, v76, v8
    v_sub_f32 v77, v77, v8
    v_sub_f32 v78, v78, v8
    v_sub_f32 v79, v79, v8
    v_mul_f32 v160, v160, v13
    v_mul_f32 v161, v161, v13
    v_mul_f32 v162, v162, v13
    v_mul_f32 v163, v163, v13
    v_mul_f32 v164, v164, v13
    v_mul_f32 v165, v165, v13
    v_mul_f32 v166, v166, v13
    v_mul_f32 v167, v167, v13
    v_mul_f32 v168, v168, v13
    v_mul_f32 v169, v169, v13
    v_mul_f32 v170, v170, v13
    v_mul_f32 v171, v171, v13
    v_mul_f32 v172, v172, v13
    v_mul_f32 v173, v173, v13
    v_mul_f32 v174, v174, v13
    v_mul_f32 v175, v175, v13
    v_mul_f32 v176, v176, v13
    v_mul_f32 v177, v177, v13
    v_mul_f32 v178, v178, v13
    v_mul_f32 v179, v179, v13
    v_mul_f32 v180, v180, v13
    v_mul_f32 v181, v181, v13
    v_mul_f32 v182, v182, v13
    v_mul_f32 v183, v183, v13
    v_mul_f32 v184, v184, v13
    v_mul_f32 v185, v185, v13
    v_mul_f32 v186, v186, v13
    v_mul_f32 v187, v187, v13
    v_mul_f32 v188, v188, v13
    v_mul_f32 v189, v189, v13
    v_mul_f32 v190, v190, v13
    v_mul_f32 v191, v191, v13
    v_mul_f32 v192, v192, v13
    v_mul_f32 v193, v193, v13
    v_mul_f32 v194, v194, v13
    v_mul_f32 v195, v195, v13
    v_mul_f32 v196, v196, v13
    v_mul_f32 v197, v197, v13
    v_mul_f32 v198, v198, v13
    v_mul_f32 v199, v199, v13
    v_mul_f32 v200, v200, v13
    v_mul_f32 v201, v201, v13
    v_mul_f32 v202, v202, v13
    v_mul_f32 v203, v203, v13
    v_mul_f32 v204, v204, v13
    v_mul_f32 v205, v205, v13
    v_mul_f32 v206, v206, v13
    v_mul_f32 v207, v207, v13
    v_mul_f32 v208, v208, v13
    v_mul_f32 v209, v209, v13
    v_mul_f32 v210, v210, v13
    v_mul_f32 v211, v211, v13
    v_mul_f32 v212, v212, v13
    v_mul_f32 v213, v213, v13
    v_mul_f32 v214, v214, v13
    v_mul_f32 v215, v215, v13
    v_mul_f32 v216, v216, v13
    v_mul_f32 v217, v217, v13
    v_mul_f32 v218, v218, v13
    v_mul_f32 v219, v219, v13
    v_mul_f32 v220, v220, v13
    v_mul_f32 v221, v221, v13
    v_mul_f32 v222, v222, v13
    v_mul_f32 v223, v223, v13
    s_branch L_k2_exp_19
L_k2_rare_22:
    s_nop 11
    v_max3_f32 v8, v48, v49, v50
    v_max3_f32 v8, v8, v51, v52
    v_max3_f32 v8, v8, v53, v54
    v_max3_f32 v8, v8, v55, v56
    v_max3_f32 v8, v8, v57, v58
    v_max3_f32 v8, v8, v59, v60
    v_max3_f32 v8, v8, v61, v62
    v_max3_f32 v8, v8, v63, v64
    v_max3_f32 v8, v8, v65, v66
    v_max3_f32 v8, v8, v67, v68
    v_max3_f32 v8, v8, v69, v70
    v_max3_f32 v8, v8, v71, v72
    v_max3_f32 v8, v8, v73, v74
    v_max3_f32 v8, v8, v75, v76
    v_max3_f32 v8, v8, v77, v78
    v_max_f32 v8, v8, v79
    v_mov_b32 v9, v8
    s_nop 1
    v_permlane32_swap_b32 v8, v9
    v_max_f32 v8, v8, v9
    v_max_f32 v8, s50, v8
    v_mov_b32 v13, 0xf149f2ca
    v_cmp_lt_f32 vcc, v13, v8
    s_mov_b32 s49, 0
    s_mov_b32 s50, 0
    v_cndmask_b32 v8, 0, v8, vcc
    v_max_f32 v13, 0, v8
    v_exp_f32 v13, -v13
    v_add_f32 v7, v7, v8
    v_mul_f32 v13, s30, v13
    s_mov_b32 s30, 1.0
    v_mov_b32 v14, v13
    v_mov_b32 v15, v13
    v_sub_f32 v224, 0, v7
    v_sub_f32 v225, 0, v7
    v_sub_f32 v226, 0, v7
    v_sub_f32 v227, 0, v7
    v_sub_f32 v228, 0, v7
    v_sub_f32 v229, 0, v7
    v_sub_f32 v230, 0, v7
    v_sub_f32 v231, 0, v7
    v_sub_f32 v232, 0, v7
    v_sub_f32 v233, 0, v7
    v_sub_f32 v234, 0, v7
    v_sub_f32 v235, 0, v7
    v_sub_f32 v236, 0, v7
    v_sub_f32 v237, 0, v7
    v_sub_f32 v238, 0, v7
    v_sub_f32 v239, 0, v7
    v_permlane16_swap_b32 v14, v15
    v_mul_f32 v248, v248, v13
    v_mul_f32 v249, v249, v15
    v_sub_f32 v48, v48, v8
    v_sub_f32 v49, v49, v8
    v_sub_f32 v50, v50, v8
    v_sub_f32 v51, v51, v8
    v_sub_f32 v52, v52, v8
    v_sub_f32 v53, v53, v8
    v_sub_f32 v54, v54, v8
    v_sub_f32 v55, v55, v8
    v_sub_f32 v56, v56, v8
    v_sub_f32 v57, v57, v8
    v_sub_f32 v58, v58, v8
    v_sub_f32 v59, v59, v8
    v_sub_f32 v60, v60, v8
    v_sub_f32 v61, v61, v8
    v_sub_f32 v62, v62, v8
    v_sub_f32 v63, v63, v8
    v_sub_f32 v64, v64, v8
    v_sub_f32 v65, v65, v8
    v_sub_f32 v66, v66, v8
    v_sub_f32 v67, v67, v8
    v_sub_f32 v68, v68, v8
    v_sub_f32 v69, v69, v8
    v_sub_f32 v70, v70, v8
    v_sub_f32 v71, v71, v8
    v_sub_f32 v72, v72, v8
    v_sub_f32 v73, v73, v8
    v_sub_f32 v74, v74, v8
    v_sub_f32 v75, v75, v8
    v_sub_f32 v76, v76, v8
    v_sub_f32 v77, v77, v8
    v_sub_f32 v78, v78, v8
    v_sub_f32 v79, v79, v8
    v_mul_f32 v160, v160, v13
    v_mul_f32 v161, v161, v13
    v_mul_f32 v162, v162, v13
    v_mul_f32 v163, v163, v13
    v_mul_f32 v164, v164, v13
    v_mul_f32 v165, v165, v13
    v_mul_f32 v166, v166, v13
    v_mul_f32 v167, v167, v13
    v_mul_f32 v168, v168, v13
    v_mul_f32 v169, v169, v13
    v_mul_f32 v170, v170, v13
    v_mul_f32 v171, v171, v13
    v_mul_f32 v172, v172, v13
    v_mul_f32 v173, v173, v13
    v_mul_f32 v174, v174, v13
    v_mul_f32 v175, v175, v13
    v_mul_f32 v176, v176, v13
    v_mul_f32 v177, v177, v13
    v_mul_f32 v178, v178, v13
    v_mul_f32 v179, v179, v13
    v_mul_f32 v180, v180, v13
    v_mul_f32 v181, v181, v13
    v_mul_f32 v182, v182, v13
    v_mul_f32 v183, v183, v13
    v_mul_f32 v184, v184, v13
    v_mul_f32 v185, v185, v13
    v_mul_f32 v186, v186, v13
    v_mul_f32 v187, v187, v13
    v_mul_f32 v188, v188, v13
    v_mul_f32 v189, v189, v13
    v_mul_f32 v190, v190, v13
    v_mul_f32 v191, v191, v13
    v_mul_f32 v192, v192, v13
    v_mul_f32 v193, v193, v13
    v_mul_f32 v194, v194, v13
    v_mul_f32 v195, v195, v13
    v_mul_f32 v196, v196, v13
    v_mul_f32 v197, v197, v13
    v_mul_f32 v198, v198, v13
    v_mul_f32 v199, v199, v13
    v_mul_f32 v200, v200, v13
    v_mul_f32 v201, v201, v13
    v_mul_f32 v202, v202, v13
    v_mul_f32 v203, v203, v13
    v_mul_f32 v204, v204, v13
    v_mul_f32 v205, v205, v13
    v_mul_f32 v206, v206, v13
    v_mul_f32 v207, v207, v13
    v_mul_f32 v208, v208, v13
    v_mul_f32 v209, v209, v13
    v_mul_f32 v210, v210, v13
    v_mul_f32 v211, v211, v13
    v_mul_f32 v212, v212, v13
    v_mul_f32 v213, v213, v13
    v_mul_f32 v214, v214, v13
    v_mul_f32 v215, v215, v13
    v_mul_f32 v216, v216, v13
    v_mul_f32 v217, v217, v13
    v_mul_f32 v218, v218, v13
    v_mul_f32 v219, v219, v13
    v_mul_f32 v220, v220, v13
    v_mul_f32 v221, v221, v13
    v_mul_f32 v222, v222, v13
    v_mul_f32 v223, v223, v13
    s_branch L_k2_exp_23
L_k2_rare_26:
    s_nop 11
    v_max3_f32 v8, v48, v49, v50
    v_max3_f32 v8, v8, v51, v52
    v_max3_f32 v8, v8, v53, v54
    v_max3_f32 v8, v8, v55, v56
    v_max3_f32 v8, v8, v57, v58
    v_max3_f32 v8, v8, v59, v60
    v_max3_f32 v8, v8, v61, v62
    v_max3_f32 v8, v8, v63, v64
    v_max3_f32 v8, v8, v65, v66
    v_max3_f32 v8, v8, v67, v68
    v_max3_f32 v8, v8, v69, v70
    v_max3_f32 v8, v8, v71, v72
    v_max3_f32 v8, v8, v73, v74
    v_max3_f32 v8, v8, v75, v76
    v_max3_f32 v8, v8, v77, v78
    v_max_f32 v8, v8, v79
    v_mov_b32 v9, v8
    s_nop 1
    v_permlane32_swap_b32 v8, v9
    v_max_f32 v8, v8, v9
    v_max_f32 v8, s50, v8
    v_mov_b32 v13, 0xf149f2ca
    v_cmp_lt_f32 vcc, v13, v8
    s_mov_b32 s49, 0
    s_mov_b32 s50, 0
    v_cndmask_b32 v8, 0, v8, vcc
    v_max_f32 v13, 0, v8
    v_exp_f32 v13, -v13
    v_add_f32 v7, v7, v8
    v_mul_f32 v13, s30, v13
    s_mov_b32 s30, 1.0
    v_mov_b32 v14, v13
    v_mov_b32 v15, v13
    v_sub_f32 v224, 0, v7
    v_sub_f32 v225, 0, v7
    v_sub_f32 v226, 0, v7
    v_sub_f32 v227, 0, v7
    v_sub_f32 v228, 0, v7
    v_sub_f32 v229, 0, v7
    v_sub_f32 v230, 0, v7
    v_sub_f32 v231, 0, v7
    v_sub_f32 v232, 0, v7
    v_sub_f32 v233, 0, v7
    v_sub_f32 v234, 0, v7
    v_sub_f32 v235, 0, v7
    v_sub_f32 v236, 0, v7
    v_sub_f32 v237, 0, v7
    v_sub_f32 v238, 0, v7
    v_sub_f32 v239, 0, v7
    v_permlane16_swap_b32 v14, v15
    v_mul_f32 v248, v248, v13
    v_mul_f32 v249, v249, v15
    v_sub_f32 v48, v48, v8
    v_sub_f32 v49, v49, v8
    v_sub_f32 v50, v50, v8
    v_sub_f32 v51, v51, v8
    v_sub_f32 v52, v52, v8
    v_sub_f32 v53, v53, v8
    v_sub_f32 v54, v54, v8
    v_sub_f32 v55, v55, v8
    v_sub_f32 v56, v56, v8
    v_sub_f32 v57, v57, v8
    v_sub_f32 v58, v58, v8
    v_sub_f32 v59, v59, v8
    v_sub_f32 v60, v60, v8
    v_sub_f32 v61, v61, v8
    v_sub_f32 v62, v62, v8
    v_sub_f32 v63, v63, v8
    v_sub_f32 v64, v64, v8
    v_sub_f32 v65, v65, v8
    v_sub_f32 v66, v66, v8
    v_sub_f32 v67, v67, v8
    v_sub_f32 v68, v68, v8
    v_sub_f32 v69, v69, v8
    v_sub_f32 v70, v70, v8
    v_sub_f32 v71, v71, v8
    v_sub_f32 v72, v72, v8
    v_sub_f32 v73, v73, v8
    v_sub_f32 v74, v74, v8
    v_sub_f32 v75, v75, v8
    v_sub_f32 v76, v76, v8
    v_sub_f32 v77, v77, v8
    v_sub_f32 v78, v78, v8
    v_sub_f32 v79, v79, v8
    v_mul_f32 v160, v160, v13
    v_mul_f32 v161, v161, v13
    v_mul_f32 v162, v162, v13
    v_mul_f32 v163, v163, v13
    v_mul_f32 v164, v164, v13
    v_mul_f32 v165, v165, v13
    v_mul_f32 v166, v166, v13
    v_mul_f32 v167, v167, v13
    v_mul_f32 v168, v168, v13
    v_mul_f32 v169, v169, v13
    v_mul_f32 v170, v170, v13
    v_mul_f32 v171, v171, v13
    v_mul_f32 v172, v172, v13
    v_mul_f32 v173, v173, v13
    v_mul_f32 v174, v174, v13
    v_mul_f32 v175, v175, v13
    v_mul_f32 v176, v176, v13
    v_mul_f32 v177, v177, v13
    v_mul_f32 v178, v178, v13
    v_mul_f32 v179, v179, v13
    v_mul_f32 v180, v180, v13
    v_mul_f32 v181, v181, v13
    v_mul_f32 v182, v182, v13
    v_mul_f32 v183, v183, v13
    v_mul_f32 v184, v184, v13
    v_mul_f32 v185, v185, v13
    v_mul_f32 v186, v186, v13
    v_mul_f32 v187, v187, v13
    v_mul_f32 v188, v188, v13
    v_mul_f32 v189, v189, v13
    v_mul_f32 v190, v190, v13
    v_mul_f32 v191, v191, v13
    v_mul_f32 v192, v192, v13
    v_mul_f32 v193, v193, v13
    v_mul_f32 v194, v194, v13
    v_mul_f32 v195, v195, v13
    v_mul_f32 v196, v196, v13
    v_mul_f32 v197, v197, v13
    v_mul_f32 v198, v198, v13
    v_mul_f32 v199, v199, v13
    v_mul_f32 v200, v200, v13
    v_mul_f32 v201, v201, v13
    v_mul_f32 v202, v202, v13
    v_mul_f32 v203, v203, v13
    v_mul_f32 v204, v204, v13
    v_mul_f32 v205, v205, v13
    v_mul_f32 v206, v206, v13
    v_mul_f32 v207, v207, v13
    v_mul_f32 v208, v208, v13
    v_mul_f32 v209, v209, v13
    v_mul_f32 v210, v210, v13
    v_mul_f32 v211, v211, v13
    v_mul_f32 v212, v212, v13
    v_mul_f32 v213, v213, v13
    v_mul_f32 v214, v214, v13
    v_mul_f32 v215, v215, v13
    v_mul_f32 v216, v216, v13
    v_mul_f32 v217, v217, v13
    v_mul_f32 v218, v218, v13
    v_mul_f32 v219, v219, v13
    v_mul_f32 v220, v220, v13
    v_mul_f32 v221, v221, v13
    v_mul_f32 v222, v222, v13
    v_mul_f32 v223, v223, v13
    s_branch L_k2_exp_27
L_k2_end:
    s_endpgm
.globl outp_kernel
.p2align 8
.type outp_kernel,@function
outp_kernel:
    s_cmp_ge_u32 s2, 256
    s_cbranch_scc1 L_k3_end
    s_load_dwordx2 s[10:11], s[0:1], 48
    s_load_dwordx4 s[16:19], s[0:1], 112
    s_load_dwordx2 s[28:29], s[0:1], 136
    v_and_b32 v1, 63, v0
    v_lshrrev_b32 v2, 6, v0
    s_nop 0
    v_readfirstlane_b32 s3, v2
    v_and_b32 v2, 31, v1
    v_lshrrev_b32 v3, 5, v1
    v_lshlrev_b32 v4, 4, v1
    s_and_b32 s56, s2, 7
    s_lshl_b32 s56, s56, 2
    s_lshr_b32 s57, s2, 3
    s_and_b32 s57, s57, 3
    s_add_u32 s4, s56, s57
    s_lshr_b32 s5, s2, 5
    s_lshl_b32 s66, s3, 14
    v_lshlrev_b32 v13, 4, v3
    v_lshl_add_u32 v5, v2, 12, v13
    s_lshl_b32 s56, s4, 19
    s_lshl_b32 s57, s3, 15
    s_add_u32 s56, s56, s57
    s_add_u32 s58, s56, 0x3000000
    s_add_u32 s59, s58, 0x40000
    s_lshl_b32 s56, s5, 19
    s_add_u32 s56, s56, s57
    s_add_u32 s60, s56, 0x5000000
    s_add_u32 s61, s60, 0x40000
    s_lshl_b32 s56, s4, 17
    s_lshl_b32 s57, s3, 13
    s_add_u32 s56, s56, s57
    s_add_u32 s62, s56, 0x4800000
    s_add_u32 s63, s62, 0x10000
    s_lshl_b32 s56, s5, 17
    s_add_u32 s56, s56, s57
    s_add_u32 s64, s56, 0x4c00000
    s_add_u32 s65, s64, 0x10000
    s_waitcnt lgkmcnt(0)
    s_mov_b32 s32, s28
    s_mov_b32 s33, s29
    s_mov_b32 s34, 0x10000000
    s_mov_b32 s35, 0x00020000
    s_mov_b32 s44, s10
    s_mov_b32 s45, s11
    s_mov_b32 s46, 0x200000
    s_mov_b32 s47, 0x00020000
    s_mov_b32 s48, s16
    s_mov_b32 s49, s17
    s_mov_b32 s50, 0x400
    s_mov_b32 s51, 0x00020000
    s_mov_b32 s52, s18
    s_mov_b32 s53, s19
    s_mov_b32 s54, 0x800000
    s_mov_b32 s55, 0x00020000
    buffer_load_dwordx4 v[32:35], v4, s[32:35], s62 offen offset:0
    buffer_load_dwordx4 v[36:39], v4, s[32:35], s63 offen offset:0
    buffer_load_dwordx4 v[40:43], v4, s[32:35], s64 offen offset:0
    buffer_load_dwordx4 v[44:47], v4, s[32:35], s65 offen offset:0
    buffer_load_dwordx4 v[48:51], v4, s[32:35], s62 offen offset:1024
    buffer_load_dwordx4 v[52:55], v4, s[32:35], s63 offen offset:1024
    buffer_load_dwordx4 v[56:59], v4, s[32:35], s64 offen offset:1024
    buffer_load_dwordx4 v[60:63], v4, s[32:35], s65 offen offset:1024
    buffer_load_dwordx4 v[64:67], v4, s[32:35], s62 offen offset:2048
    buffer_load_dwordx4 v[68:71], v4, s[32:35], s63 offen offset:2048
    buffer_load_dwordx4 v[72:75], v4, s[32:35], s64 offen offset:2048
    buffer_load_dwordx4 v[76:79], v4, s[32:35], s65 offen offset:2048
    buffer_load_dwordx4 v[80:83], v4, s[32:35], s62 offen offset:3072
    buffer_load_dwordx4 v[84:87], v4, s[32:35], s63 offen offset:3072
    buffer_load_dwordx4 v[88:91], v4, s[32:35], s64 offen offset:3072
    buffer_load_dwordx4 v[92:95], v4, s[32:35], s65 offen offset:3072
    s_add_u32 s56, s62, 4096
    buffer_load_dwordx4 v[96:99], v4, s[32:35], s56 offen offset:0
    s_add_u32 s56, s63, 4096
    buffer_load_dwordx4 v[100:103], v4, s[32:35], s56 offen offset:0
    s_add_u32 s56, s64, 4096
    buffer_load_dwordx4 v[104:107], v4, s[32:35], s56 offen offset:0
    s_add_u32 s56, s65, 4096
    buffer_load_dwordx4 v[108:111], v4, s[32:35], s56 offen offset:0
    s_add_u32 s56, s62, 4096
    buffer_load_dwordx4 v[112:115], v4, s[32:35], s56 offen offset:1024
    s_add_u32 s56, s63, 4096
    buffer_load_dwordx4 v[116:119], v4, s[32:35], s56 offen offset:1024
    s_add_u32 s56, s64, 4096
    buffer_load_dwordx4 v[120:123], v4, s[32:35], s56 offen offset:1024
    s_add_u32 s56, s65, 4096
    buffer_load_dwordx4 v[124:127], v4, s[32:35], s56 offen offset:1024
    s_lshl_b32 s56, s4, 6
    s_lshl_b32 s57, s3, 3
    s_add_u32 s56, s56, s57
    s_lshl_b32 s67, s56, 12
    s_lshl_b32 s57, s5, 8
    s_add_u32 s67, s67, s57
    s_add_u32 s68, s67, 16384
    s_lshl_b32 s56, s56, 10
    s_lshl_b32 s57, s5, 7
    s_add_u32 s56, s56, s57
    v_and_b32 v6, 15, v1
    v_lshrrev_b32 v7, 4, v1
    v_lshlrev_b32 v13, 3, v6
    v_lshl_add_u32 v14, v7, 10, v13
    v_lshlrev_b32 v5, 4, v6
    v_lshl_add_u32 v5, v7, 12, v5
    s_add_u32 s69, s56, 4096
    buffer_load_dwordx2 v[16:17], v14, s[44:47], s56 offen
    buffer_load_dwordx2 v[18:19], v14, s[44:47], s69 offen
    buffer_load_dwordx2 v[20:21], v13, s[48:51], s57 offen
    v_lshlrev_b32 v15, 4, v3
    v_xor_b32 v15, v15, v4
    v_add_u32 v15, s66, v15
    s_lshr_b32 s56, s3, 2
    s_lshl_b32 s56, s56, 13
    s_and_b32 s57, s3, 3
    s_lshl_b32 s57, s57, 3
    v_lshrrev_b32 v8, 1, v6
    v_lshlrev_b32 v8, 10, v8
    v_and_b32 v9, 1, v6
    v_lshl_add_u32 v8, v9, 9, v8
    v_add_u32 v8, s56, v8
    v_add_u32 v9, s57, v7
    v_xor_b32 v9, v9, v6
    v_lshl_add_u32 v10, v9, 4, v8
    v_add_u32 v11, 0x10000, v10
    v_add_u32 v9, s57, v7
    v_add_u32 v9, 4, v9
    v_xor_b32 v9, v9, v6
    v_lshl_add_u32 v12, v9, 4, v8
    v_add_u32 v13, 0x10000, v12
    s_waitcnt vmcnt(23)
    v_mfma_f32_32x32x16_bf16 v[192:207], v[40:43], v[32:35], 0
    v_mfma_f32_32x32x16_bf16 v[208:223], v[44:47], v[32:35], 0
    v_mfma_f32_32x32x16_bf16 v[224:239], v[40:43], v[36:39], 0
    v_mfma_f32_32x32x16_bf16 v[240:255], v[44:47], v[36:39], 0
    s_add_u32 s56, s62, 4096
    buffer_load_dwordx4 v[32:35], v4, s[32:35], s56 offen offset:2048
    s_add_u32 s56, s63, 4096
    buffer_load_dwordx4 v[36:39], v4, s[32:35], s56 offen offset:2048
    s_add_u32 s56, s64, 4096
    buffer_load_dwordx4 v[40:43], v4, s[32:35], s56 offen offset:2048
    s_add_u32 s56, s65, 4096
    buffer_load_dwordx4 v[44:47], v4, s[32:35], s56 offen offset:2048
    s_waitcnt vmcnt(23)
    v_mfma_f32_32x32x16_bf16 v[192:207], v[56:59], v[48:51], v[192:207]
    v_mfma_f32_32x32x16_bf16 v[208:223], v[60:63], v[48:51], v[208:223]
    v_mfma_f32_32x32x16_bf16 v[224:239], v[56:59], v[52:55], v[224:239]
    v_mfma_f32_32x32x16_bf16 v[240:255], v[60:63], v[52:55], v[240:255]
    s_add_u32 s56, s62, 4096
    buffer_load_dwordx4 v[48:51], v4, s[32:35], s56 offen offset:3072
    s_add_u32 s56, s63, 4096
    buffer_load_dwordx4 v[52:55], v4, s[32:35], s56 offen offset:3072
    s_add_u32 s56, s64, 4096
    buffer_load_dwordx4 v[56:59], v4, s[32:35], s56 offen offset:3072
    s_add_u32 s56, s65, 4096
    buffer_load_dwordx4 v[60:63], v4, s[32:35], s56 offen offset:3072
    s_waitcnt vmcnt(23)
    v_mfma_f32_32x32x16_bf16 v[192:207], v[72:75], v[64:67], v[192:207]
    v_mfma_f32_32x32x16_bf16 v[208:223], v[76:79], v[64:67], v[208:223]
    v_mfma_f32_32x32x16_bf16 v[224:239], v[72:75], v[68:71], v[224:239]
    v_mfma_f32_32x32x16_bf16 v[240:255], v[76:79], v[68:71], v[240:255]
    buffer_load_dwordx4 v[64:67], v4, s[32:35], s58 offen offset:0
    buffer_load_dwordx4 v[68:71], v4, s[32:35], s59 offen offset:0
    buffer_load_dwordx4 v[72:75], v4, s[32:35], s60 offen offset:0
    buffer_load_dwordx4 v[76:79], v4, s[32:35], s61 offen offset:0
    s_waitcnt vmcnt(23)
    v_mfma_f32_32x32x16_bf16 v[192:207], v[88:91], v[80:83], v[192:207]
    v_mfma_f32_32x32x16_bf16 v[208:223], v[92:95], v[80:83], v[208:223]
    v_mfma_f32_32x32x16_bf16 v[224:239], v[88:91], v[84:87], v[224:239]
    v_mfma_f32_32x32x16_bf16 v[240:255], v[92:95], v[84:87], v[240:255]
    buffer_load_dwordx4 v[80:83], v4, s[32:35], s58 offen offset:1024
    buffer_load_dwordx4 v[84:87], v4, s[32:35], s59 offen offset:1024
    buffer_load_dwordx4 v[88:91], v4, s[32:35], s60 offen offset:1024
    buffer_load_dwordx4 v[92:95], v4, s[32:35], s61 offen offset:1024
    s_waitcnt vmcnt(23)
    v_mfma_f32_32x32x16_bf16 v[192:207], v[104:107], v[96:99], v[192:207]
    v_mfma_f32_32x32x16_bf16 v[208:223], v[108:111], v[96:99], v[208:223]
    v_mfma_f32_32x32x16_bf16 v[224:239], v[104:107], v[100:103], v[224:239]
    v_mfma_f32_32x32x16_bf16 v[240:255], v[108:111], v[100:103], v[240:255]
    buffer_load_dwordx4 v[96:99], v4, s[32:35], s58 offen offset:2048
    buffer_load_dwordx4 v[100:103], v4, s[32:35], s59 offen offset:2048
    buffer_load_dwordx4 v[104:107], v4, s[32:35], s60 offen offset:2048
    buffer_load_dwordx4 v[108:111], v4, s[32:35], s61 offen offset:2048
    s_waitcnt vmcnt(23)
    v_mfma_f32_32x32x16_bf16 v[192:207], v[120:123], v[112:115], v[192:207]
    v_mfma_f32_32x32x16_bf16 v[208:223], v[124:127], v[112:115], v[208:223]
    v_mfma_f32_32x32x16_bf16 v[224:239], v[120:123], v[116:119], v[224:239]
    v_mfma_f32_32x32x16_bf16 v[240:255], v[124:127], v[116:119], v[240:255]
    buffer_load_dwordx4 v[112:115], v4, s[32:35], s58 offen offset:3072
    buffer_load_dwordx4 v[116:119], v4, s[32:35], s59 offen offset:3072
    buffer_load_dwordx4 v[120:123], v4, s[32:35], s60 offen offset:3072
    buffer_load_dwordx4 v[124:127], v4, s[32:35], s61 offen offset:3072
    s_waitcnt vmcnt(20)
    v_mfma_f32_32x32x16_bf16 v[192:207], v[40:43], v[32:35], v[192:207]
    v_mfma_f32_32x32x16_bf16 v[208:223], v[44:47], v[32:35], v[208:223]
    v_mfma_f32_32x32x16_bf16 v[224:239], v[40:43], v[36:39], v[224:239]
    v_mfma_f32_32x32x16_bf16 v[240:255], v[44:47], v[36:39], v[240:255]
    s_add_u32 s56, s58, 4096
    buffer_load_dwordx4 v[32:35], v4, s[32:35], s56 offen offset:0
    s_add_u32 s56, s59, 4096
    buffer_load_dwordx4 v[36:39], v4, s[32:35], s56 offen offset:0
    s_add_u32 s56, s60, 4096
    buffer_load_dwordx4 v[40:43], v4, s[32:35], s56 offen offset:0
    s_add_u32 s56, s61, 4096
    buffer_load_dwordx4 v[44:47], v4, s[32:35], s56 offen offset:0
    s_waitcnt vmcnt(20)
    v_mfma_f32_32x32x16_bf16 v[192:207], v[56:59], v[48:51], v[192:207]
    v_mfma_f32_32x32x16_bf16 v[208:223], v[60:63], v[48:51], v[208:223]
    v_mfma_f32_32x32x16_bf16 v[224:239], v[56:59], v[52:55], v[224:239]
    v_mfma_f32_32x32x16_bf16 v[240:255], v[60:63], v[52:55], v[240:255]
    s_add_u32 s56, s58, 4096
    buffer_load_dwordx4 v[48:51], v4, s[32:35], s56 offen offset:1024
    s_add_u32 s56, s59, 4096
    buffer_load_dwordx4 v[52:55], v4, s[32:35], s56 offen offset:1024
    s_add_u32 s56, s60, 4096
    buffer_load_dwordx4 v[56:59], v4, s[32:35], s56 offen offset:1024
    s_add_u32 s56, s61, 4096
    buffer_load_dwordx4 v[60:63], v4, s[32:35], s56 offen offset:1024
    s_waitcnt vmcnt(20)
    v_mfma_f32_32x32x16_bf16 v[128:143], v[72:75], v[64:67], 0
    v_mfma_f32_32x32x16_bf16 v[144:159], v[76:79], v[64:67], 0
    v_mfma_f32_32x32x16_bf16 v[160:175], v[72:75], v[68:71], 0
    v_mfma_f32_32x32x16_bf16 v[176:191], v[76:79], v[68:71], 0
    s_add_u32 s56, s58, 4096
    buffer_load_dwordx4 v[64:67], v4, s[32:35], s56 offen offset:2048
    s_add_u32 s56, s59, 4096
    buffer_load_dwordx4 v[68:71], v4, s[32:35], s56 offen offset:2048
    s_add_u32 s56, s60, 4096
    buffer_load_dwordx4 v[72:75], v4, s[32:35], s56 offen offset:2048
    s_add_u32 s56, s61, 4096
    buffer_load_dwordx4 v[76:79], v4, s[32:35], s56 offen offset:2048
    s_waitcnt vmcnt(20)
    v_mfma_f32_32x32x16_bf16 v[128:143], v[88:91], v[80:83], v[128:143]
    v_mfma_f32_32x32x16_bf16 v[144:159], v[92:95], v[80:83], v[144:159]
    v_mfma_f32_32x32x16_bf16 v[160:175], v[88:91], v[84:87], v[160:175]
    v_mfma_f32_32x32x16_bf16 v[176:191], v[92:95], v[84:87], v[176:191]
    s_add_u32 s56, s58, 4096
    buffer_load_dwordx4 v[80:83], v4, s[32:35], s56 offen offset:3072
    s_add_u32 s56, s59, 4096
    buffer_load_dwordx4 v[84:87], v4, s[32:35], s56 offen offset:3072
    s_add_u32 s56, s60, 4096
    buffer_load_dwordx4 v[88:91], v4, s[32:35], s56 offen offset:3072
    s_add_u32 s56, s61, 4096
    buffer_load_dwordx4 v[92:95], v4, s[32:35], s56 offen offset:3072
    s_waitcnt vmcnt(20)
    v_mfma_f32_32x32x16_bf16 v[128:143], v[104:107], v[96:99], v[128:143]
    v_mfma_f32_32x32x16_bf16 v[144:159], v[108:111], v[96:99], v[144:159]
    v_mfma_f32_32x32x16_bf16 v[160:175], v[104:107], v[100:103], v[160:175]
    v_mfma_f32_32x32x16_bf16 v[176:191], v[108:111], v[100:103], v[176:191]
    s_add_u32 s56, s58, 8192
    buffer_load_dwordx4 v[96:99], v4, s[32:35], s56 offen offset:0
    s_add_u32 s56, s59, 8192
    buffer_load_dwordx4 v[100:103], v4, s[32:35], s56 offen offset:0
    s_add_u32 s56, s60, 8192
    buffer_load_dwordx4 v[104:107], v4, s[32:35], s56 offen offset:0
    s_add_u32 s56, s61, 8192
    buffer_load_dwordx4 v[108:111], v4, s[32:35], s56 offen offset:0
    s_waitcnt vmcnt(20)
    v_mfma_f32_32x32x16_bf16 v[128:143], v[120:123], v[112:115], v[128:143]
    v_mfma_f32_32x32x16_bf16 v[144:159], v[124:127], v[112:115], v[144:159]
    v_mfma_f32_32x32x16_bf16 v[160:175], v[120:123], v[116:119], v[160:175]
    v_mfma_f32_32x32x16_bf16 v[176:191], v[124:127], v[116:119], v[176:191]
    s_add_u32 s56, s58, 8192
    buffer_load_dwordx4 v[112:115], v4, s[32:35], s56 offen offset:1024
    s_add_u32 s56, s59, 8192
    buffer_load_dwordx4 v[116:119], v4, s[32:35], s56 offen offset:1024
    s_add_u32 s56, s60, 8192
    buffer_load_dwordx4 v[120:123], v4, s[32:35], s56 offen offset:1024
    s_add_u32 s56, s61, 8192
    buffer_load_dwordx4 v[124:127], v4, s[32:35], s56 offen offset:1024
    v_xor_b32 v14, 0x0, v15
    ds_write_b128 v14, v[192:195] offset:0
    v_xor_b32 v14, 0x20, v15
    ds_write_b128 v14, v[196:199] offset:1024
    v_xor_b32 v14, 0x40, v15
    ds_write_b128 v14, v[200:203] offset:2048
    v_xor_b32 v14, 0x60, v15
    ds_write_b128 v14, v[204:207] offset:3072
    v_xor_b32 v14, 0x80, v15
    ds_write_b128 v14, v[208:211] offset:4096
    v_xor_b32 v14, 0xa0, v15
    ds_write_b128 v14, v[212:215] offset:5120
    v_xor_b32 v14, 0xc0, v15
    ds_write_b128 v14, v[216:219] offset:6144
    v_xor_b32 v14, 0xe0, v15
    ds_write_b128 v14, v[220:223] offset:7168
    v_xor_b32 v14, 0x0, v15
    ds_write_b128 v14, v[224:227] offset:8192
    v_xor_b32 v14, 0x20, v15
    ds_write_b128 v14, v[228:231] offset:9216
    v_xor_b32 v14, 0x40, v15
    ds_write_b128 v14, v[232:235] offset:10240
    v_xor_b32 v14, 0x60, v15
    ds_write_b128 v14, v[236:239] offset:11264
    v_xor_b32 v14, 0x80, v15
    ds_write_b128 v14, v[240:243] offset:12288
    v_xor_b32 v14, 0xa0, v15
    ds_write_b128 v14, v[244:247] offset:13312
    v_xor_b32 v14, 0xc0, v15
    ds_write_b128 v14, v[248:251] offset:14336
    v_xor_b32 v14, 0xe0, v15
    ds_write_b128 v14, v[252:255] offset:15360
    s_waitcnt lgkmcnt(0)
    s_waitcnt vmcnt(20)
    v_mfma_f32_32x32x16_bf16 v[128:143], v[40:43], v[32:35], v[128:143]
    v_mfma_f32_32x32x16_bf16 v[144:159], v[44:47], v[32:35], v[144:159]
    v_mfma_f32_32x32x16_bf16 v[160:175], v[40:43], v[36:39], v[160:175]
    v_mfma_f32_32x32x16_bf16 v[176:191], v[44:47], v[36:39], v[176:191]
    s_add_u32 s56, s58, 8192
    buffer_load_dwordx4 v[32:35], v4, s[32:35], s56 offen offset:2048
    s_add_u32 s56, s59, 8192
    buffer_load_dwordx4 v[36:39], v4, s[32:35], s56 offen offset:2048
    s_add_u32 s56, s60, 8192
    buffer_load_dwordx4 v[40:43], v4, s[32:35], s56 offen offset:2048
    s_add_u32 s56, s61, 8192
    buffer_load_dwordx4 v[44:47], v4, s[32:35], s56 offen offset:2048
    s_waitcnt vmcnt(20)
    v_mfma_f32_32x32x16_bf16 v[128:143], v[56:59], v[48:51], v[128:143]
    v_mfma_f32_32x32x16_bf16 v[144:159], v[60:63], v[48:51], v[144:159]
    v_mfma_f32_32x32x16_bf16 v[160:175], v[56:59], v[52:55], v[160:175]
    v_mfma_f32_32x32x16_bf16 v[176:191], v[60:63], v[52:55], v[176:191]
    s_add_u32 s56, s58, 8192
    buffer_load_dwordx4 v[48:51], v4, s[32:35], s56 offen offset:3072
    s_add_u32 s56, s59, 8192
    buffer_load_dwordx4 v[52:55], v4, s[32:35], s56 offen offset:3072
    s_add_u32 s56, s60, 8192
    buffer_load_dwordx4 v[56:59], v4, s[32:35], s56 offen offset:3072
    s_add_u32 s56, s61, 8192
    buffer_load_dwordx4 v[60:63], v4, s[32:35], s56 offen offset:3072
    s_waitcnt vmcnt(20)
    v_mfma_f32_32x32x16_bf16 v[128:143], v[72:75], v[64:67], v[128:143]
    v_mfma_f32_32x32x16_bf16 v[144:159], v[76:79], v[64:67], v[144:159]
    v_mfma_f32_32x32x16_bf16 v[160:175], v[72:75], v[68:71], v[160:175]
    v_mfma_f32_32x32x16_bf16 v[176:191], v[76:79], v[68:71], v[176:191]
    s_add_u32 s56, s58, 12288
    buffer_load_dwordx4 v[64:67], v4, s[32:35], s56 offen offset:0
    s_add_u32 s56, s59, 12288
    buffer_load_dwordx4 v[68:71], v4, s[32:35], s56 offen offset:0
    s_add_u32 s56, s60, 12288
    buffer_load_dwordx4 v[72:75], v4, s[32:35], s56 offen offset:0
    s_add_u32 s56, s61, 12288
    buffer_load_dwordx4 v[76:79], v4, s[32:35], s56 offen offset:0
    s_waitcnt vmcnt(20)
    v_mfma_f32_32x32x16_bf16 v[128:143], v[88:91], v[80:83], v[128:143]
    v_mfma_f32_32x32x16_bf16 v[144:159], v[92:95], v[80:83], v[144:159]
    v_mfma_f32_32x32x16_bf16 v[160:175], v[88:91], v[84:87], v[160:175]
    v_mfma_f32_32x32x16_bf16 v[176:191], v[92:95], v[84:87], v[176:191]
    s_add_u32 s56, s58, 12288
    buffer_load_dwordx4 v[80:83], v4, s[32:35], s56 offen offset:1024
    s_add_u32 s56, s59, 12288
    buffer_load_dwordx4 v[84:87], v4, s[32:35], s56 offen offset:1024
    s_add_u32 s56, s60, 12288
    buffer_load_dwordx4 v[88:91], v4, s[32:35], s56 offen offset:1024
    s_add_u32 s56, s61, 12288
    buffer_load_dwordx4 v[92:95], v4, s[32:35], s56 offen offset:1024
    s_waitcnt vmcnt(20)
    v_mfma_f32_32x32x16_bf16 v[128:143], v[104:107], v[96:99], v[128:143]
    v_mfma_f32_32x32x16_bf16 v[144:159], v[108:111], v[96:99], v[144:159]
    v_mfma_f32_32x32x16_bf16 v[160:175], v[104:107], v[100:103], v[160:175]
    v_mfma_f32_32x32x16_bf16 v[176:191], v[108:111], v[100:103], v[176:191]
    s_add_u32 s56, s58, 12288
    buffer_load_dwordx4 v[96:99], v4, s[32:35], s56 offen offset:2048
    s_add_u32 s56, s59, 12288
    buffer_load_dwordx4 v[100:103], v4, s[32:35], s56 offen offset:2048
    s_add_u32 s56, s60, 12288
    buffer_load_dwordx4 v[104:107], v4, s[32:35], s56 offen offset:2048
    s_add_u32 s56, s61, 12288
    buffer_load_dwordx4 v[108:111], v4, s[32:35], s56 offen offset:2048
    s_waitcnt vmcnt(20)
    v_mfma_f32_32x32x16_bf16 v[128:143], v[120:123], v[112:115], v[128:143]
    v_mfma_f32_32x32x16_bf16 v[144:159], v[124:127], v[112:115], v[144:159]
    v_mfma_f32_32x32x16_bf16 v[160:175], v[120:123], v[116:119], v[160:175]
    v_mfma_f32_32x32x16_bf16 v[176:191], v[124:127], v[116:119], v[176:191]
    s_add_u32 s56, s58, 12288
    buffer_load_dwordx4 v[112:115], v4, s[32:35], s56 offen offset:3072
    s_add_u32 s56, s59, 12288
    buffer_load_dwordx4 v[116:119], v4, s[32:35], s56 offen offset:3072
    s_add_u32 s56, s60, 12288
    buffer_load_dwordx4 v[120:123], v4, s[32:35], s56 offen offset:3072
    s_add_u32 s56, s61, 12288
    buffer_load_dwordx4 v[124:127], v4, s[32:35], s56 offen offset:3072
    s_barrier
    ds_read_b128 v[192:195], v10 offset:0
    ds_read_b128 v[196:199], v12 offset:0
    ds_read_b128 v[200:203], v10 offset:16384
    ds_read_b128 v[204:207], v12 offset:16384
    ds_read_b128 v[208:211], v10 offset:32768
    ds_read_b128 v[212:215], v12 offset:32768
    ds_read_b128 v[216:219], v10 offset:49152
    ds_read_b128 v[220:223], v12 offset:49152
    ds_read_b128 v[224:227], v11 offset:0
    ds_read_b128 v[228:231], v13 offset:0
    ds_read_b128 v[232:235], v11 offset:16384
    ds_read_b128 v[236:239], v13 offset:16384
    ds_read_b128 v[240:243], v11 offset:32768
    ds_read_b128 v[244:247], v13 offset:32768
    ds_read_b128 v[248:251], v11 offset:49152
    ds_read_b128 v[252:255], v13 offset:49152
    s_waitcnt lgkmcnt(12)
    v_add_f32 v192, v192, v200
    v_add_f32 v193, v193, v201
    v_add_f32 v194, v194, v202
    v_add_f32 v195, v195, v203
    v_add_f32 v196, v196, v204
    v_add_f32 v197, v197, v205
    v_add_f32 v198, v198, v206
    v_add_f32 v199, v199, v207
    s_waitcnt lgkmcnt(10)
    v_add_f32 v192, v192, v208
    v_add_f32 v193, v193, v209
    v_add_f32 v194, v194, v210
    v_add_f32 v195, v195, v211
    v_add_f32 v196, v196, v212
    v_add_f32 v197, v197, v213
    v_add_f32 v198, v198, v214
    v_add_f32 v199, v199, v215
    s_waitcnt lgkmcnt(8)
    v_add_f32 v192, v192, v216
    v_add_f32 v193, v193, v217
    v_add_f32 v194, v194, v218
    v_add_f32 v195, v195, v219
    v_add_f32 v196, v196, v220
    v_add_f32 v197, v197, v221
    v_add_f32 v198, v198, v222
    v_add_f32 v199, v199, v223
    s_waitcnt lgkmcnt(6)
    v_add_f32 v192, v192, v224
    v_add_f32 v193, v193, v225
    v_add_f32 v194, v194, v226
    v_add_f32 v195, v195, v227
    v_add_f32 v196, v196, v228
    v_add_f32 v197, v197, v229
    v_add_f32 v198, v198, v230
    v_add_f32 v199, v199, v231
    s_waitcnt lgkmcnt(4)
    v_add_f32 v192, v192, v232
    v_add_f32 v193, v193, v233
    v_add_f32 v194, v194, v234
    v_add_f32 v195, v195, v235
    v_add_f32 v196, v196, v236
    v_add_f32 v197, v197, v237
    v_add_f32 v198, v198, v238
    v_add_f32 v199, v199, v239
    s_waitcnt lgkmcnt(2)
    v_add_f32 v192, v192, v240
    v_add_f32 v193, v193, v241
    v_add_f32 v194, v194, v242
    v_add_f32 v195, v195, v243
    v_add_f32 v196, v196, v244
    v_add_f32 v197, v197, v245
    v_add_f32 v198, v198, v246
    v_add_f32 v199, v199, v247
    s_waitcnt lgkmcnt(0)
    v_add_f32 v192, v192, v248
    v_add_f32 v193, v193, v249
    v_add_f32 v194, v194, v250
    v_add_f32 v195, v195, v251
    v_add_f32 v196, v196, v252
    v_add_f32 v197, v197, v253
    v_add_f32 v198, v198, v254
    v_add_f32 v199, v199, v255
    v_lshlrev_b32 v200, 16, v16
    v_and_b32 v201, 0xffff0000, v16
    v_lshlrev_b32 v202, 16, v20
    v_and_b32 v203, 0xffff0000, v20
    v_mul_f32 v200, v200, v202
    v_mul_f32 v201, v201, v203
    v_cvt_pk_bf16_f32 v200, v200, v201
    v_and_b32 v201, 0xffff0000, v200
    v_lshlrev_b32 v200, 16, v200
    v_fma_f32 v192, 2.0, v192, v200
    v_fma_f32 v193, 2.0, v193, v201
    v_lshlrev_b32 v200, 16, v17
    v_and_b32 v201, 0xffff0000, v17
    v_lshlrev_b32 v202, 16, v21
    v_and_b32 v203, 0xffff0000, v21
    v_mul_f32 v200, v200, v202
    v_mul_f32 v201, v201, v203
    v_cvt_pk_bf16_f32 v200, v200, v201
    v_and_b32 v201, 0xffff0000, v200
    v_lshlrev_b32 v200, 16, v200
    v_fma_f32 v194, 2.0, v194, v200
    v_fma_f32 v195, 2.0, v195, v201
    v_lshlrev_b32 v200, 16, v18
    v_and_b32 v201, 0xffff0000, v18
    v_lshlrev_b32 v202, 16, v20
    v_and_b32 v203, 0xffff0000, v20
    v_mul_f32 v200, v200, v202
    v_mul_f32 v201, v201, v203
    v_cvt_pk_bf16_f32 v200, v200, v201
    v_and_b32 v201, 0xffff0000, v200
    v_lshlrev_b32 v200, 16, v200
    v_fma_f32 v196, 2.0, v196, v200
    v_fma_f32 v197, 2.0, v197, v201
    v_lshlrev_b32 v200, 16, v19
    v_and_b32 v201, 0xffff0000, v19
    v_lshlrev_b32 v202, 16, v21
    v_and_b32 v203, 0xffff0000, v21
    v_mul_f32 v200, v200, v202
    v_mul_f32 v201, v201, v203
    v_cvt_pk_bf16_f32 v200, v200, v201
    v_and_b32 v201, 0xffff0000, v200
    v_lshlrev_b32 v200, 16, v200
    v_fma_f32 v198, 2.0, v198, v200
    v_fma_f32 v199, 2.0, v199, v201
    buffer_store_dwordx4 v[192:195], v5, s[52:55], s67 offen offset:2048 sc1
    buffer_store_dwordx4 v[196:199], v5, s[52:55], s68 offen offset:2048 sc1
    s_waitcnt vmcnt(22)
    v_mfma_f32_32x32x16_bf16 v[128:143], v[40:43], v[32:35], v[128:143]
    v_mfma_f32_32x32x16_bf16 v[144:159], v[44:47], v[32:35], v[144:159]
    v_mfma_f32_32x32x16_bf16 v[160:175], v[40:43], v[36:39], v[160:175]
    v_mfma_f32_32x32x16_bf16 v[176:191], v[44:47], v[36:39], v[176:191]
    s_add_u32 s56, s58, 16384
    buffer_load_dwordx4 v[32:35], v4, s[32:35], s56 offen offset:0
    s_add_u32 s56, s59, 16384
    buffer_load_dwordx4 v[36:39], v4, s[32:35], s56 offen offset:0
    s_add_u32 s56, s60, 16384
    buffer_load_dwordx4 v[40:43], v4, s[32:35], s56 offen offset:0
    s_add_u32 s56, s61, 16384
    buffer_load_dwordx4 v[44:47], v4, s[32:35], s56 offen offset:0
    s_waitcnt vmcnt(22)
    v_mfma_f32_32x32x16_bf16 v[128:143], v[56:59], v[48:51], v[128:143]
    v_mfma_f32_32x32x16_bf16 v[144:159], v[60:63], v[48:51], v[144:159]
    v_mfma_f32_32x32x16_bf16 v[160:175], v[56:59], v[52:55], v[160:175]
    v_mfma_f32_32x32x16_bf16 v[176:191], v[60:63], v[52:55], v[176:191]
    s_add_u32 s56, s58, 16384
    buffer_load_dwordx4 v[48:51], v4, s[32:35], s56 offen offset:1024
    s_add_u32 s56, s59, 16384
    buffer_load_dwordx4 v[52:55], v4, s[32:35], s56 offen offset:1024
    s_add_u32 s56, s60, 16384
    buffer_load_dwordx4 v[56:59], v4, s[32:35], s56 offen offset:1024
    s_add_u32 s56, s61, 16384
    buffer_load_dwordx4 v[60:63], v4, s[32:35], s56 offen offset:1024
    s_waitcnt vmcnt(22)
    v_mfma_f32_32x32x16_bf16 v[128:143], v[72:75], v[64:67], v[128:143]
    v_mfma_f32_32x32x16_bf16 v[144:159], v[76:79], v[64:67], v[144:159]
    v_mfma_f32_32x32x16_bf16 v[160:175], v[72:75], v[68:71], v[160:175]
    v_mfma_f32_32x32x16_bf16 v[176:191], v[76:79], v[68:71], v[176:191]
    s_add_u32 s56, s58, 16384
    buffer_load_dwordx4 v[64:67], v4, s[32:35], s56 offen offset:2048
    s_add_u32 s56, s59, 16384
    buffer_load_dwordx4 v[68:71], v4, s[32:35], s56 offen offset:2048
    s_add_u32 s56, s60, 16384
    buffer_load_dwordx4 v[72:75], v4, s[32:35], s56 offen offset:2048
    s_add_u32 s56, s61, 16384
    buffer_load_dwordx4 v[76:79], v4, s[32:35], s56 offen offset:2048
    s_waitcnt vmcnt(22)
    v_mfma_f32_32x32x16_bf16 v[128:143], v[88:91], v[80:83], v[128:143]
    v_mfma_f32_32x32x16_bf16 v[144:159], v[92:95], v[80:83], v[144:159]
    v_mfma_f32_32x32x16_bf16 v[160:175], v[88:91], v[84:87], v[160:175]
    v_mfma_f32_32x32x16_bf16 v[176:191], v[92:95], v[84:87], v[176:191]
    s_add_u32 s56, s58, 16384
    buffer_load_dwordx4 v[80:83], v4, s[32:35], s56 offen offset:3072
    s_add_u32 s56, s59, 16384
    buffer_load_dwordx4 v[84:87], v4, s[32:35], s56 offen offset:3072
    s_add_u32 s56, s60, 16384
    buffer_load_dwordx4 v[88:91], v4, s[32:35], s56 offen offset:3072
    s_add_u32 s56, s61, 16384
    buffer_load_dwordx4 v[92:95], v4, s[32:35], s56 offen offset:3072
    s_waitcnt vmcnt(22)
    v_mfma_f32_32x32x16_bf16 v[128:143], v[104:107], v[96:99], v[128:143]
    v_mfma_f32_32x32x16_bf16 v[144:159], v[108:111], v[96:99], v[144:159]
    v_mfma_f32_32x32x16_bf16 v[160:175], v[104:107], v[100:103], v[160:175]
    v_mfma_f32_32x32x16_bf16 v[176:191], v[108:111], v[100:103], v[176:191]
    s_add_u32 s56, s58, 20480
    buffer_load_dwordx4 v[96:99], v4, s[32:35], s56 offen offset:0
    s_add_u32 s56, s59, 20480
    buffer_load_dwordx4 v[100:103], v4, s[32:35], s56 offen offset:0
    s_add_u32 s56, s60, 20480
    buffer_load_dwordx4 v[104:107], v4, s[32:35], s56 offen offset:0
    s_add_u32 s56, s61, 20480
    buffer_load_dwordx4 v[108:111], v4, s[32:35], s56 offen offset:0
    s_waitcnt vmcnt(22)
    v_mfma_f32_32x32x16_bf16 v[128:143], v[120:123], v[112:115], v[128:143]
    v_mfma_f32_32x32x16_bf16 v[144:159], v[124:127], v[112:115], v[144:159]
    v_mfma_f32_32x32x16_bf16 v[160:175], v[120:123], v[116:119], v[160:175]
    v_mfma_f32_32x32x16_bf16 v[176:191], v[124:127], v[116:119], v[176:191]
    s_add_u32 s56, s58, 20480
    buffer_load_dwordx4 v[112:115], v4, s[32:35], s56 offen offset:1024
    s_add_u32 s56, s59, 20480
    buffer_load_dwordx4 v[116:119], v4, s[32:35], s56 offen offset:1024
    s_add_u32 s56, s60, 20480
    buffer_load_dwordx4 v[120:123], v4, s[32:35], s56 offen offset:1024
    s_add_u32 s56, s61, 20480
    buffer_load_dwordx4 v[124:127], v4, s[32:35], s56 offen offset:1024
    s_waitcnt vmcnt(20)
    v_mfma_f32_32x32x16_bf16 v[128:143], v[40:43], v[32:35], v[128:143]
    v_mfma_f32_32x32x16_bf16 v[144:159], v[44:47], v[32:35], v[144:159]
    v_mfma_f32_32x32x16_bf16 v[160:175], v[40:43], v[36:39], v[160:175]
    v_mfma_f32_32x32x16_bf16 v[176:191], v[44:47], v[36:39], v[176:191]
    s_add_u32 s56, s58, 20480
    buffer_load_dwordx4 v[32:35], v4, s[32:35], s56 offen offset:2048
    s_add_u32 s56, s59, 20480
    buffer_load_dwordx4 v[36:39], v4, s[32:35], s56 offen offset:2048
    s_add_u32 s56, s60, 20480
    buffer_load_dwordx4 v[40:43], v4, s[32:35], s56 offen offset:2048
    s_add_u32 s56, s61, 20480
    buffer_load_dwordx4 v[44:47], v4, s[32:35], s56 offen offset:2048
    s_waitcnt vmcnt(20)
    v_mfma_f32_32x32x16_bf16 v[128:143], v[56:59], v[48:51], v[128:143]
    v_mfma_f32_32x32x16_bf16 v[144:159], v[60:63], v[48:51], v[144:159]
    v_mfma_f32_32x32x16_bf16 v[160:175], v[56:59], v[52:55], v[160:175]
    v_mfma_f32_32x32x16_bf16 v[176:191], v[60:63], v[52:55], v[176:191]
    s_add_u32 s56, s58, 20480
    buffer_load_dwordx4 v[48:51], v4, s[32:35], s56 offen offset:3072
    s_add_u32 s56, s59, 20480
    buffer_load_dwordx4 v[52:55], v4, s[32:35], s56 offen offset:3072
    s_add_u32 s56, s60, 20480
    buffer_load_dwordx4 v[56:59], v4, s[32:35], s56 offen offset:3072
    s_add_u32 s56, s61, 20480
    buffer_load_dwordx4 v[60:63], v4, s[32:35], s56 offen offset:3072
    s_waitcnt vmcnt(20)
    v_mfma_f32_32x32x16_bf16 v[128:143], v[72:75], v[64:67], v[128:143]
    v_mfma_f32_32x32x16_bf16 v[144:159], v[76:79], v[64:67], v[144:159]
    v_mfma_f32_32x32x16_bf16 v[160:175], v[72:75], v[68:71], v[160:175]
    v_mfma_f32_32x32x16_bf16 v[176:191], v[76:79], v[68:71], v[176:191]
    s_add_u32 s56, s58, 24576
    buffer_load_dwordx4 v[64:67], v4, s[32:35], s56 offen offset:0
    s_add_u32 s56, s59, 24576
    buffer_load_dwordx4 v[68:71], v4, s[32:35], s56 offen offset:0
    s_add_u32 s56, s60, 24576
    buffer_load_dwordx4 v[72:75], v4, s[32:35], s56 offen offset:0
    s_add_u32 s56, s61, 24576
    buffer_load_dwordx4 v[76:79], v4, s[32:35], s56 offen offset:0
    s_waitcnt vmcnt(20)
    v_mfma_f32_32x32x16_bf16 v[128:143], v[88:91], v[80:83], v[128:143]
    v_mfma_f32_32x32x16_bf16 v[144:159], v[92:95], v[80:83], v[144:159]
    v_mfma_f32_32x32x16_bf16 v[160:175], v[88:91], v[84:87], v[160:175]
    v_mfma_f32_32x32x16_bf16 v[176:191], v[92:95], v[84:87], v[176:191]
    s_add_u32 s56, s58, 24576
    buffer_load_dwordx4 v[80:83], v4, s[32:35], s56 offen offset:1024
    s_add_u32 s56, s59, 24576
    buffer_load_dwordx4 v[84:87], v4, s[32:35], s56 offen offset:1024
    s_add_u32 s56, s60, 24576
    buffer_load_dwordx4 v[88:91], v4, s[32:35], s56 offen offset:1024
    s_add_u32 s56, s61, 24576
    buffer_load_dwordx4 v[92:95], v4, s[32:35], s56 offen offset:1024
    s_barrier
    s_waitcnt vmcnt(20)
    v_mfma_f32_32x32x16_bf16 v[128:143], v[104:107], v[96:99], v[128:143]
    v_mfma_f32_32x32x16_bf16 v[144:159], v[108:111], v[96:99], v[144:159]
    v_mfma_f32_32x32x16_bf16 v[160:175], v[104:107], v[100:103], v[160:175]
    v_mfma_f32_32x32x16_bf16 v[176:191], v[108:111], v[100:103], v[176:191]
    s_add_u32 s56, s58, 24576
    buffer_load_dwordx4 v[96:99], v4, s[32:35], s56 offen offset:2048
    s_add_u32 s56, s59, 24576
    buffer_load_dwordx4 v[100:103], v4, s[32:35], s56 offen offset:2048
    s_add_u32 s56, s60, 24576
    buffer_load_dwordx4 v[104:107], v4, s[32:35], s56 offen offset:2048
    s_add_u32 s56, s61, 24576
    buffer_load_dwordx4 v[108:111], v4, s[32:35], s56 offen offset:2048
    s_waitcnt vmcnt(20)
    v_mfma_f32_32x32x16_bf16 v[128:143], v[120:123], v[112:115], v[128:143]
    v_mfma_f32_32x32x16_bf16 v[144:159], v[124:127], v[112:115], v[144:159]
    v_mfma_f32_32x32x16_bf16 v[160:175], v[120:123], v[116:119], v[160:175]
    v_mfma_f32_32x32x16_bf16 v[176:191], v[124:127], v[116:119], v[176:191]
    s_add_u32 s56, s58, 24576
    buffer_load_dwordx4 v[112:115], v4, s[32:35], s56 offen offset:3072
    s_add_u32 s56, s59, 24576
    buffer_load_dwordx4 v[116:119], v4, s[32:35], s56 offen offset:3072
    s_add_u32 s56, s60, 24576
    buffer_load_dwordx4 v[120:123], v4, s[32:35], s56 offen offset:3072
    s_add_u32 s56, s61, 24576
    buffer_load_dwordx4 v[124:127], v4, s[32:35], s56 offen offset:3072
    s_waitcnt vmcnt(20)
    v_mfma_f32_32x32x16_bf16 v[128:143], v[40:43], v[32:35], v[128:143]
    v_mfma_f32_32x32x16_bf16 v[144:159], v[44:47], v[32:35], v[144:159]
    v_mfma_f32_32x32x16_bf16 v[160:175], v[40:43], v[36:39], v[160:175]
    v_mfma_f32_32x32x16_bf16 v[176:191], v[44:47], v[36:39], v[176:191]
    s_add_u32 s56, s58, 28672
    buffer_load_dwordx4 v[32:35], v4, s[32:35], s56 offen offset:0
    s_add_u32 s56, s59, 28672
    buffer_load_dwordx4 v[36:39], v4, s[32:35], s56 offen offset:0
    s_add_u32 s56, s60, 28672
    buffer_load_dwordx4 v[40:43], v4, s[32:35], s56 offen offset:0
    s_add_u32 s56, s61, 28672
    buffer_load_dwordx4 v[44:47], v4, s[32:35], s56 offen offset:0
    s_waitcnt vmcnt(20)
    v_mfma_f32_32x32x16_bf16 v[128:143], v[56:59], v[48:51], v[128:143]
    v_mfma_f32_32x32x16_bf16 v[144:159], v[60:63], v[48:51], v[144:159]
    v_mfma_f32_32x32x16_bf16 v[160:175], v[56:59], v[52:55], v[160:175]
    v_mfma_f32_32x32x16_bf16 v[176:191], v[60:63], v[52:55], v[176:191]
    s_add_u32 s56, s58, 28672
    buffer_load_dwordx4 v[48:51], v4, s[32:35], s56 offen offset:1024
    s_add_u32 s56, s59, 28672
    buffer_load_dwordx4 v[52:55], v4, s[32:35], s56 offen offset:1024
    s_add_u32 s56, s60, 28672
    buffer_load_dwordx4 v[56:59], v4, s[32:35], s56 offen offset:1024
    s_add_u32 s56, s61, 28672
    buffer_load_dwordx4 v[60:63], v4, s[32:35], s56 offen offset:1024
    s_waitcnt vmcnt(20)
    v_mfma_f32_32x32x16_bf16 v[128:143], v[72:75], v[64:67], v[128:143]
    v_mfma_f32_32x32x16_bf16 v[144:159], v[76:79], v[64:67], v[144:159]
    v_mfma_f32_32x32x16_bf16 v[160:175], v[72:75], v[68:71], v[160:175]
    v_mfma_f32_32x32x16_bf16 v[176:191], v[76:79], v[68:71], v[176:191]
    s_add_u32 s56, s58, 28672
    buffer_load_dwordx4 v[64:67], v4, s[32:35], s56 offen offset:2048
    s_add_u32 s56, s59, 28672
    buffer_load_dwordx4 v[68:71], v4, s[32:35], s56 offen offset:2048
    s_add_u32 s56, s60, 28672
    buffer_load_dwordx4 v[72:75], v4, s[32:35], s56 offen offset:2048
    s_add_u32 s56, s61, 28672
    buffer_load_dwordx4 v[76:79], v4, s[32:35], s56 offen offset:2048
    s_waitcnt vmcnt(20)
    v_mfma_f32_32x32x16_bf16 v[128:143], v[88:91], v[80:83], v[128:143]
    v_mfma_f32_32x32x16_bf16 v[144:159], v[92:95], v[80:83], v[144:159]
    v_mfma_f32_32x32x16_bf16 v[160:175], v[88:91], v[84:87], v[160:175]
    v_mfma_f32_32x32x16_bf16 v[176:191], v[92:95], v[84:87], v[176:191]
    s_add_u32 s56, s58, 28672
    buffer_load_dwordx4 v[80:83], v4, s[32:35], s56 offen offset:3072
    s_add_u32 s56, s59, 28672
    buffer_load_dwordx4 v[84:87], v4, s[32:35], s56 offen offset:3072
    s_add_u32 s56, s60, 28672
    buffer_load_dwordx4 v[88:91], v4, s[32:35], s56 offen offset:3072
    s_add_u32 s56, s61, 28672
    buffer_load_dwordx4 v[92:95], v4, s[32:35], s56 offen offset:3072
    s_waitcnt vmcnt(20)
    v_mfma_f32_32x32x16_bf16 v[128:143], v[104:107], v[96:99], v[128:143]
    v_mfma_f32_32x32x16_bf16 v[144:159], v[108:111], v[96:99], v[144:159]
    v_mfma_f32_32x32x16_bf16 v[160:175], v[104:107], v[100:103], v[160:175]
    v_mfma_f32_32x32x16_bf16 v[176:191], v[108:111], v[100:103], v[176:191]
    s_waitcnt vmcnt(16)
    v_mfma_f32_32x32x16_bf16 v[128:143], v[120:123], v[112:115], v[128:143]
    v_mfma_f32_32x32x16_bf16 v[144:159], v[124:127], v[112:115], v[144:159]
    v_mfma_f32_32x32x16_bf16 v[160:175], v[120:123], v[116:119], v[160:175]
    v_mfma_f32_32x32x16_bf16 v[176:191], v[124:127], v[116:119], v[176:191]
    s_waitcnt vmcnt(12)
    v_mfma_f32_32x32x16_bf16 v[128:143], v[40:43], v[32:35], v[128:143]
    v_mfma_f32_32x32x16_bf16 v[144:159], v[44:47], v[32:35], v[144:159]
    v_mfma_f32_32x32x16_bf16 v[160:175], v[40:43], v[36:39], v[160:175]
    v_mfma_f32_32x32x16_bf16 v[176:191], v[44:47], v[36:39], v[176:191]
    s_waitcnt vmcnt(8)
    v_mfma_f32_32x32x16_bf16 v[128:143], v[56:59], v[48:51], v[128:143]
    v_mfma_f32_32x32x16_bf16 v[144:159], v[60:63], v[48:51], v[144:159]
    v_mfma_f32_32x32x16_bf16 v[160:175], v[56:59], v[52:55], v[160:175]
    v_mfma_f32_32x32x16_bf16 v[176:191], v[60:63], v[52:55], v[176:191]
    s_waitcnt vmcnt(4)
    v_mfma_f32_32x32x16_bf16 v[128:143], v[72:75], v[64:67], v[128:143]
    v_mfma_f32_32x32x16_bf16 v[144:159], v[76:79], v[64:67], v[144:159]
    v_mfma_f32_32x32x16_bf16 v[160:175], v[72:75], v[68:71], v[160:175]
    v_mfma_f32_32x32x16_bf16 v[176:191], v[76:79], v[68:71], v[176:191]
    s_waitcnt vmcnt(0)
    v_mfma_f32_32x32x16_bf16 v[128:143], v[88:91], v[80:83], v[128:143]
    v_mfma_f32_32x32x16_bf16 v[144:159], v[92:95], v[80:83], v[144:159]
    v_mfma_f32_32x32x16_bf16 v[160:175], v[88:91], v[84:87], v[160:175]
    v_mfma_f32_32x32x16_bf16 v[176:191], v[92:95], v[84:87], v[176:191]
    s_nop 15
    v_xor_b32 v14, 0x0, v15
    ds_write_b128 v14, v[128:131] offset:0
    v_xor_b32 v14, 0x20, v15
    ds_write_b128 v14, v[132:135] offset:1024
    v_xor_b32 v14, 0x40, v15
    ds_write_b128 v14, v[136:139] offset:2048
    v_xor_b32 v14, 0x60, v15
    ds_write_b128 v14, v[140:143] offset:3072
    v_xor_b32 v14, 0x80, v15
    ds_write_b128 v14, v[144:147] offset:4096
    v_xor_b32 v14, 0xa0, v15
    ds_write_b128 v14, v[148:151] offset:5120
    v_xor_b32 v14, 0xc0, v15
    ds_write_b128 v14, v[152:155] offset:6144
    v_xor_b32 v14, 0xe0, v15
    ds_write_b128 v14, v[156:159] offset:7168
    v_xor_b32 v14, 0x0, v15
    ds_write_b128 v14, v[160:163] offset:8192
    v_xor_b32 v14, 0x20, v15
    ds_write_b128 v14, v[164:167] offset:9216
    v_xor_b32 v14, 0x40, v15
    ds_write_b128 v14, v[168:171] offset:10240
    v_xor_b32 v14, 0x60, v15
    ds_write_b128 v14, v[172:175] offset:11264
    v_xor_b32 v14, 0x80, v15
    ds_write_b128 v14, v[176:179] offset:12288
    v_xor_b32 v14, 0xa0, v15
    ds_write_b128 v14, v[180:183] offset:13312
    v_xor_b32 v14, 0xc0, v15
    ds_write_b128 v14, v[184:187] offset:14336
    v_xor_b32 v14, 0xe0, v15
    ds_write_b128 v14, v[188:191] offset:15360
    s_waitcnt lgkmcnt(0)
    s_barrier
    ds_read_b128 v[192:195], v10 offset:0
    ds_read_b128 v[196:199], v12 offset:0
    ds_read_b128 v[200:203], v10 offset:16384
    ds_read_b128 v[204:207], v12 offset:16384
    ds_read_b128 v[208:211], v10 offset:32768
    ds_read_b128 v[212:215], v12 offset:32768
    ds_read_b128 v[216:219], v10 offset:49152
    ds_read_b128 v[220:223], v12 offset:49152
    ds_read_b128 v[224:227], v11 offset:0
    ds_read_b128 v[228:231], v13 offset:0
    ds_read_b128 v[232:235], v11 offset:16384
    ds_read_b128 v[236:239], v13 offset:16384
    ds_read_b128 v[240:243], v11 offset:32768
    ds_read_b128 v[244:247], v13 offset:32768
    ds_read_b128 v[248:251], v11 offset:49152
    ds_read_b128 v[252:255], v13 offset:49152
    s_waitcnt lgkmcnt(12)
    v_add_f32 v192, v192, v200
    v_add_f32 v193, v193, v201
    v_add_f32 v194, v194, v202
    v_add_f32 v195, v195, v203
    v_add_f32 v196, v196, v204
    v_add_f32 v197, v197, v205
    v_add_f32 v198, v198, v206
    v_add_f32 v199, v199, v207
    s_waitcnt lgkmcnt(10)
    v_add_f32 v192, v192, v208
    v_add_f32 v193, v193, v209
    v_add_f32 v194, v194, v210
    v_add_f32 v195, v195, v211
    v_add_f32 v196, v196, v212
    v_add_f32 v197, v197, v213
    v_add_f32 v198, v198, v214
    v_add_f32 v199, v199, v215
    s_waitcnt lgkmcnt(8)
    v_add_f32 v192, v192, v216
    v_add_f32 v193, v193, v217
    v_add_f32 v194, v194, v218
    v_add_f32 v195, v195, v219
    v_add_f32 v196, v196, v220
    v_add_f32 v197, v197, v221
    v_add_f32 v198, v198, v222
    v_add_f32 v199, v199, v223
    s_waitcnt lgkmcnt(6)
    v_add_f32 v192, v192, v224
    v_add_f32 v193, v193, v225
    v_add_f32 v194, v194, v226
    v_add_f32 v195, v195, v227
    v_add_f32 v196, v196, v228
    v_add_f32 v197, v197, v229
    v_add_f32 v198, v198, v230
    v_add_f32 v199, v199, v231
    s_waitcnt lgkmcnt(4)
    v_add_f32 v192, v192, v232
    v_add_f32 v193, v193, v233
    v_add_f32 v194, v194, v234
    v_add_f32 v195, v195, v235
    v_add_f32 v196, v196, v236
    v_add_f32 v197, v197, v237
    v_add_f32 v198, v198, v238
    v_add_f32 v199, v199, v239
    s_waitcnt lgkmcnt(2)
    v_add_f32 v192, v192, v240
    v_add_f32 v193, v193, v241
    v_add_f32 v194, v194, v242
    v_add_f32 v195, v195, v243
    v_add_f32 v196, v196, v244
    v_add_f32 v197, v197, v245
    v_add_f32 v198, v198, v246
    v_add_f32 v199, v199, v247
    s_waitcnt lgkmcnt(0)
    v_add_f32 v192, v192, v248
    v_add_f32 v193, v193, v249
    v_add_f32 v194, v194, v250
    v_add_f32 v195, v195, v251
    v_add_f32 v196, v196, v252
    v_add_f32 v197, v197, v253
    v_add_f32 v198, v198, v254
    v_add_f32 v199, v199, v255
    v_cvt_pk_bf16_f32 v200, v192, v193
    v_cvt_pk_bf16_f32 v201, v194, v195
    v_cvt_pk_bf16_f32 v202, v196, v197
    v_cvt_pk_bf16_f32 v203, v198, v199
    v_lshlrev_b32 v192, 16, v200
    v_and_b32 v193, 0xffff0000, v200
    v_lshlrev_b32 v194, 16, v201
    v_and_b32 v195, 0xffff0000, v201
    v_lshlrev_b32 v196, 16, v202
    v_and_b32 v197, 0xffff0000, v202
    v_lshlrev_b32 v198, 16, v203
    v_and_b32 v199, 0xffff0000, v203
    buffer_store_dwordx4 v[192:195], v5, s[52:55], s67 offen offset:0 sc1
    buffer_store_dwordx4 v[196:199], v5, s[52:55], s68 offen offset:0 sc1
L_k3_end:
    s_endpgm
.section .rodata,"a"
.p2align 6
.amdhsa_kernel proj_kernel
  .amdhsa_next_free_vgpr 256
  .amdhsa_next_free_sgpr 102
  .amdhsa_accum_offset 256
  .amdhsa_group_segment_fixed_size 0
  .amdhsa_kernarg_size 144
  .amdhsa_user_sgpr_count 2
  .amdhsa_user_sgpr_kernarg_segment_ptr 1
  .amdhsa_system_sgpr_workgroup_id_x 1
.end_amdhsa_kernel
.p2align 6
.amdhsa_kernel attn_kernel
  .amdhsa_next_free_vgpr 256
  .amdhsa_next_free_sgpr 102
  .amdhsa_accum_offset 256
  .amdhsa_group_segment_fixed_size 0
  .amdhsa_kernarg_size 144
  .amdhsa_user_sgpr_count 2
  .amdhsa_user_sgpr_kernarg_segment_ptr 1
  .amdhsa_system_sgpr_workgroup_id_x 1
.end_amdhsa_kernel
.p2align 6
.amdhsa_kernel outp_kernel
  .amdhsa_next_free_vgpr 256
  .amdhsa_next_free_sgpr 102
  .amdhsa_accum_offset 256
  .amdhsa_group_segment_fixed_size 0
  .amdhsa_kernarg_size 144
  .amdhsa_user_sgpr_count 2
  .amdhsa_user_sgpr_kernarg_segment_ptr 1
  .amdhsa_system_sgpr_workgroup_id_x 1
.end_amdhsa_kernel
```
